```python
import torch

def _softmax(x, axis=-1):
    return torch.softmax(x, dim=axis)
def _gelu(x):
    return torch.nn.functional.gelu(x, approximate="tanh")
def _silu(x):
    return torch.nn.functional.silu(x)
def _sigmoid(x):
    return torch.sigmoid(x)
def _layernorm(x, axis=-1, eps=1e-5):
    m = x.mean(dim=axis, keepdim=True)
    v = x.var(dim=axis, keepdim=True, unbiased=False)
    return (x - m) / torch.sqrt(v + eps)
def _scatter_add(tgt, idx, src, axis=0):
    return tgt.clone().index_add_(axis, idx, src)
def _segment_sum(src, seg, n):
    out = torch.zeros((n,) + src.shape[1:], dtype=src.dtype)
    return out.index_add_(0, seg, src)
def _pad(x, pw):
    flat = tuple(v for pair in reversed(pw) for v in pair)
    return torch.nn.functional.pad(x, flat)

kernel_name = 'parallel_sum__softmax_full_mha__glu_gated_glu__prompt'

def setup_inputs():

    _w = (lambda a: (lambda t: t.to(torch.bfloat16) if t.is_floating_point() else t)(torch.as_tensor(a)))
    def _A_setup():
        B, S, D = 1, 2048, 512
        return {
            "x": _w((lambda *s: torch.randn(*s, dtype=torch.bfloat16) * 0.05)(B, S, D)),
            "wqkv": _w((lambda *s: torch.randn(*s, dtype=torch.bfloat16) * 0.2)(D, 3 * D)),
            "wo": _w((lambda *s: torch.randn(*s, dtype=torch.bfloat16) * 0.1)(D, D)),
        }
    _A_in = _A_setup()

    def _B_setup():
        B, S, D, F = 1, 2048, 512, 1792
        return {
            "x": _w((lambda *s: torch.randn(*s, dtype=torch.bfloat16) * 0.05)(B, S, D)),
            "w_gate": _w((lambda *s: torch.randn(*s, dtype=torch.bfloat16) * 0.8)(D, F)),
            "w_up": _w((lambda *s: torch.randn(*s, dtype=torch.bfloat16) * 0.2)(D, F)),
            "w_down": _w((lambda *s: torch.randn(*s, dtype=torch.bfloat16) * 0.2)(F, D)),
        }
    _B_in = _B_setup()

    return {
        "A_x": _A_in["x"],
        "A_wqkv": _A_in["wqkv"],
        "A_wo": _A_in["wo"],
        "B_x": _B_in["x"],
        "B_w_gate": _B_in["w_gate"],
        "B_w_up": _B_in["w_up"],
        "B_w_down": _B_in["w_down"],
    }

def reference(A_x, A_wqkv, A_wo, B_x, B_w_gate, B_w_up, B_w_down):
    def _A_ref(x, wqkv, wo):
        B, S, D = x.shape
        H = 32; Dh = D // H
        qkv = (lambda x, *d: x.permute(*d))((x @ wqkv).reshape(B, S, 3, H, Dh), 2, 0, 3, 1, 4)
        q, k, v = qkv[0], qkv[1], qkv[2]
        scale = Dh ** -0.5
        scores = torch.einsum("bhqd,bhkd->bhqk", q, k) * scale
        p = _softmax(scores, axis=-1)
        o = torch.einsum("bhqk,bhkd->bhqd", p, v)
        return (lambda x, *d: x.permute(*d))(o, 0, 2, 1, 3).reshape(B, S, D) @ wo

    def _B_ref(x, w_gate, w_up, w_down):
        g = torch.einsum("bsd,df->bsf", x, w_gate)
        u = torch.einsum("bsd,df->bsf", x, w_up)
        h = _sigmoid(g) * u
        return torch.einsum("bsf,fd->bsd", h, w_down)

    x = A_x
    xn = _layernorm(x, axis=-1)
    return x + _A_ref(xn, A_wqkv, A_wo) + _B_ref(xn, B_w_gate, B_w_up, B_w_down)
```

```asm
; @launch kernel=parallel_sum__softmax_full_mha__glu_gated_glu__prompt_kernel grid=(256,1,1) block=(512,1,1) lds=163840
.amdgcn_target "amdgcn-amd-amdhsa--gfx950"
.text
.globl parallel_sum__softmax_full_mha__glu_gated_glu__prompt_kernel
.p2align 8
.type parallel_sum__softmax_full_mha__glu_gated_glu__prompt_kernel,@function
parallel_sum__softmax_full_mha__glu_gated_glu__prompt_kernel:
    s_cmp_ge_u32 s2, 256
    s_cbranch_scc1 Y_END
    s_load_dwordx2 s[24:25], s[0:1], 0
    s_mov_b32 s26, 2097152
    s_mov_b32 s27, 0x00020000
    s_load_dwordx2 s[4:5], s[0:1], 8
    s_mov_b32 s6, 1572864
    s_mov_b32 s7, 0x00020000
    s_load_dwordx2 s[8:9], s[0:1], 32
    s_mov_b32 s10, 1835008
    s_mov_b32 s11, 0x00020000
    s_load_dwordx2 s[12:13], s[0:1], 40
    s_mov_b32 s14, 1835008
    s_mov_b32 s15, 0x00020000
    s_load_dwordx2 s[32:33], s[0:1], 48
    s_mov_b32 s34, 1835008
    s_mov_b32 s35, 0x00020000
    s_load_dwordx2 s[36:37], s[0:1], 16
    s_mov_b32 s38, 524288
    s_mov_b32 s39, 0x00020000
    s_load_dwordx2 s[40:41], s[0:1], 72
    s_mov_b32 s42, 268435456
    s_mov_b32 s43, 0x00020000
    s_load_dwordx2 s[44:45], s[0:1], 64
    s_mov_b32 s98, s2
    v_and_b32 v1, 63, v0
    v_lshrrev_b32 v2, 6, v0
    s_nop 0
    v_readfirstlane_b32 s16, v2
    s_and_b32 s20, s2, 7
    s_lshr_b32 s21, s2, 3
    s_lshr_b32 s19, s21, 1
    s_lshr_b32 s17, s20, 2
    s_lshl_b32 s17, s17, 4
    s_add_u32 s17, s17, s19
    s_and_b32 s18, s20, 3
    s_lshl_b32 s18, s18, 1
    s_and_b32 s21, s21, 1
    s_add_u32 s18, s18, s21
    v_lshrrev_b32 v98, 3, v1
    v_and_b32 v99, 7, v1
    v_lshlrev_b32 v96, 10, v98
    v_lshl_add_u32 v96, v99, 4, v96
    s_lshl_b32 s23, s17, 16
    s_lshl_b32 s22, s16, 13
    s_add_u32 s23, s23, s22
    s_waitcnt lgkmcnt(0)
    buffer_load_dwordx4 v[64:67], v96, s[24:27], s23 offen offset:0
    buffer_load_dwordx4 v[68:71], v96, s[24:27], s23 offen offset:128
    buffer_load_dwordx4 v[72:75], v96, s[24:27], s23 offen offset:256
    buffer_load_dwordx4 v[76:79], v96, s[24:27], s23 offen offset:384
    buffer_load_dwordx4 v[80:83], v96, s[24:27], s23 offen offset:512
    buffer_load_dwordx4 v[84:87], v96, s[24:27], s23 offen offset:640
    buffer_load_dwordx4 v[88:91], v96, s[24:27], s23 offen offset:768
    buffer_load_dwordx4 v[92:95], v96, s[24:27], s23 offen offset:896
    s_barrier
    v_lshrrev_b32 v100, 1, v99
    v_lshlrev_b32 v100, 10, v100
    v_and_b32 v101, 1, v99
    v_lshl_add_u32 v100, v101, 9, v100
    s_and_b32 s21, s16, 3
    s_lshl_b32 s21, s21, 7
    s_lshr_b32 s22, s16, 2
    s_lshl_b32 s22, s22, 15
    s_add_u32 s22, s22, s21
    v_xor_b32 v101, v98, v99
    v_lshl_add_u32 v97, v101, 4, v100
    v_add_u32 v97, s22, v97
    v_lshrrev_b32 v100, 5, v1
    v_add_u32 v101, 0, v100
    v_xor_b32 v101, v101, v1
    v_lshlrev_b32 v16, 4, v101
    v_add_u32 v101, 2, v100
    v_xor_b32 v101, v101, v1
    v_lshlrev_b32 v17, 4, v101
    v_add_u32 v101, 4, v100
    v_xor_b32 v101, v101, v1
    v_lshlrev_b32 v18, 4, v101
    v_add_u32 v101, 6, v100
    v_xor_b32 v101, v101, v1
    v_lshlrev_b32 v19, 4, v101
    v_lshlrev_b32 v20, 4, v1
    s_mul_i32 s21, s16, 8192
    s_add_u32 s21, s21, 65536
    s_mul_i32 s22, s16, 16384
    s_add_u32 s22, s22, 24576
    s_cmp_lt_u32 s16, 4
    s_cselect_b32 s28, s21, s22
    v_lshrrev_b32 v2, 3, v1
    v_mul_u32_u24 v10, 3072, v2
    v_bfe_u32 v2, v1, 4, 1
    v_lshlrev_b32 v2, 2, v2
    v_and_b32 v3, 7, v1
    v_xor_b32 v2, v2, v3
    v_lshl_add_u32 v10, v2, 4, v10
    v_lshrrev_b32 v2, 3, v1
    v_mul_u32_u24 v11, 3584, v2
    v_bfe_u32 v2, v1, 4, 1
    v_lshlrev_b32 v2, 2, v2
    v_and_b32 v3, 7, v1
    v_xor_b32 v2, v2, v3
    v_lshl_add_u32 v11, v2, 4, v11
    s_add_u32 s21, s16, 1
    s_cmp_eq_u32 s21, 3
    s_cselect_b32 s21, 0, s21
    s_lshl_b32 s29, s21, 10
    s_lshl_b32 s21, s18, 7
    s_add_u32 s29, s29, s21
    s_lshr_b32 s21, s18, 1
    s_mul_i32 s30, s21, 896
    s_and_b32 s21, s18, 1
    s_lshl_b32 s21, s21, 9
    s_sub_u32 s22, s16, 4
    s_lshl_b32 s22, s22, 7
    s_add_u32 s21, s21, s22
    s_cmp_eq_u32 s16, 7
    s_cselect_b32 s21, 384, s21
    s_add_u32 s30, s30, s21
    v_lshrrev_b32 v2, 5, v1
    v_lshlrev_b32 v12, 10, v2
    v_bfe_u32 v2, v1, 2, 2
    v_lshl_add_u32 v12, v2, 7, v12
    v_bfe_u32 v2, v1, 3, 1
    v_lshl_add_u32 v12, v2, 6, v12
    v_bfe_u32 v2, v1, 4, 1
    v_lshl_add_u32 v12, v2, 5, v12
    v_and_b32 v2, 3, v1
    v_lshl_add_u32 v12, v2, 3, v12
    v_add_u32 v12, s28, v12
    v_xor_b32 v13, 64, v12
    v_add_u32 v2, s17, v1
    v_and_b32 v2, 15, v2
    v_xor_b32 v3, s17, v1
    v_and_b32 v3, 16, v3
    v_or_b32 v8, v2, v3
    v_lshlrev_b32 v8, 7, v8
    s_lshl_b32 s99, s18, 12
    s_add_u32 s99, s99, 50331648
    s_lshl_b32 s21, s17, 13
    s_mul_i32 s22, s18, 3968
    s_sub_u32 s21, s21, s22
    s_add_u32 s21, s21, 72704
    v_mov_b32 v2, s21
    v_cmp_lt_u32 vcc, 31, v1
    s_nop 1
    v_cndmask_b32 v8, v8, v2, vcc
    v_mov_b32 v2, 0
    v_lshlrev_b32 v3, 2, v1
    v_add_u32 v3, 159744, v3
    ds_write_b32 v3, v2
    s_cmp_ge_u32 s16, 4
    s_cbranch_scc1 Y_EG
    s_cmp_eq_u32 s16, 3
    s_cbranch_scc1 Y_E3
    s_add_u32 m0, s28, 0
    s_nop 0
    buffer_load_dwordx4 v10, s[4:7], s29 offen lds
    s_add_u32 s29, s29, 24576
    s_add_u32 m0, s28, 1024
    s_nop 0
    buffer_load_dwordx4 v10, s[4:7], s29 offen lds
    s_add_u32 s29, s29, 24576
    s_add_u32 m0, s28, 2048
    s_nop 0
    buffer_load_dwordx4 v10, s[4:7], s29 offen lds
    s_add_u32 s29, s29, 24576
    s_add_u32 m0, s28, 3072
    s_nop 0
    buffer_load_dwordx4 v10, s[4:7], s29 offen lds
    s_add_u32 s29, s29, 24576
    s_add_u32 m0, s28, 4096
    s_nop 0
    buffer_load_dwordx4 v10, s[4:7], s29 offen lds
    s_add_u32 s29, s29, 24576
    s_add_u32 m0, s28, 5120
    s_nop 0
    buffer_load_dwordx4 v10, s[4:7], s29 offen lds
    s_add_u32 s29, s29, 24576
    s_add_u32 m0, s28, 6144
    s_nop 0
    buffer_load_dwordx4 v10, s[4:7], s29 offen lds
    s_add_u32 s29, s29, 24576
    s_add_u32 m0, s28, 7168
    s_nop 0
    buffer_load_dwordx4 v10, s[4:7], s29 offen lds
    s_add_u32 s29, s29, 24576
    v_mov_b32 v104, 0x3f803f80
    v_mov_b32 v105, 0
    v_mov_b32 v106, 0
    v_mov_b32 v107, 0
    v_mov_b32 v108, 0
    s_waitcnt vmcnt(15)
    v_dot2c_f32_bf16 v105, v64, v104
    v_dot2c_f32_bf16 v107, v64, v64
    v_dot2c_f32_bf16 v106, v65, v104
    v_dot2c_f32_bf16 v108, v65, v65
    v_dot2c_f32_bf16 v105, v66, v104
    v_dot2c_f32_bf16 v107, v66, v66
    v_dot2c_f32_bf16 v106, v67, v104
    v_dot2c_f32_bf16 v108, v67, v67
    s_waitcnt vmcnt(14)
    v_dot2c_f32_bf16 v105, v68, v104
    v_dot2c_f32_bf16 v107, v68, v68
    v_dot2c_f32_bf16 v106, v69, v104
    v_dot2c_f32_bf16 v108, v69, v69
    v_dot2c_f32_bf16 v105, v70, v104
    v_dot2c_f32_bf16 v107, v70, v70
    v_dot2c_f32_bf16 v106, v71, v104
    v_dot2c_f32_bf16 v108, v71, v71
    s_waitcnt vmcnt(13)
    v_dot2c_f32_bf16 v105, v72, v104
    v_dot2c_f32_bf16 v107, v72, v72
    v_dot2c_f32_bf16 v106, v73, v104
    v_dot2c_f32_bf16 v108, v73, v73
    v_dot2c_f32_bf16 v105, v74, v104
    v_dot2c_f32_bf16 v107, v74, v74
    v_dot2c_f32_bf16 v106, v75, v104
    v_dot2c_f32_bf16 v108, v75, v75
    s_waitcnt vmcnt(12)
    v_dot2c_f32_bf16 v105, v76, v104
    v_dot2c_f32_bf16 v107, v76, v76
    v_dot2c_f32_bf16 v106, v77, v104
    v_dot2c_f32_bf16 v108, v77, v77
    v_dot2c_f32_bf16 v105, v78, v104
    v_dot2c_f32_bf16 v107, v78, v78
    v_dot2c_f32_bf16 v106, v79, v104
    v_dot2c_f32_bf16 v108, v79, v79
    s_waitcnt vmcnt(11)
    v_dot2c_f32_bf16 v105, v80, v104
    v_dot2c_f32_bf16 v107, v80, v80
    v_dot2c_f32_bf16 v106, v81, v104
    v_dot2c_f32_bf16 v108, v81, v81
    v_dot2c_f32_bf16 v105, v82, v104
    v_dot2c_f32_bf16 v107, v82, v82
    v_dot2c_f32_bf16 v106, v83, v104
    v_dot2c_f32_bf16 v108, v83, v83
    s_waitcnt vmcnt(10)
    v_dot2c_f32_bf16 v105, v84, v104
    v_dot2c_f32_bf16 v107, v84, v84
    v_dot2c_f32_bf16 v106, v85, v104
    v_dot2c_f32_bf16 v108, v85, v85
    v_dot2c_f32_bf16 v105, v86, v104
    v_dot2c_f32_bf16 v107, v86, v86
    v_dot2c_f32_bf16 v106, v87, v104
    v_dot2c_f32_bf16 v108, v87, v87
    s_waitcnt vmcnt(9)
    v_dot2c_f32_bf16 v105, v88, v104
    v_dot2c_f32_bf16 v107, v88, v88
    v_dot2c_f32_bf16 v106, v89, v104
    v_dot2c_f32_bf16 v108, v89, v89
    v_dot2c_f32_bf16 v105, v90, v104
    v_dot2c_f32_bf16 v107, v90, v90
    v_dot2c_f32_bf16 v106, v91, v104
    v_dot2c_f32_bf16 v108, v91, v91
    s_waitcnt vmcnt(8)
    v_dot2c_f32_bf16 v105, v92, v104
    v_dot2c_f32_bf16 v107, v92, v92
    v_dot2c_f32_bf16 v106, v93, v104
    v_dot2c_f32_bf16 v108, v93, v93
    v_dot2c_f32_bf16 v105, v94, v104
    v_dot2c_f32_bf16 v107, v94, v94
    v_dot2c_f32_bf16 v106, v95, v104
    v_dot2c_f32_bf16 v108, v95, v95
    s_nop 2
    s_branch Y_PRIMED
Y_E3:
    v_and_b32 v2, 31, v1
    v_mul_u32_u24 v120, 3072, v2
    v_lshrrev_b32 v2, 5, v1
    v_lshl_add_u32 v121, v2, 10, v120
    s_lshl_b32 s21, s19, 5
    s_mul_i32 s48, s21, 3072
    s_lshl_b32 s22, s18, 7
    s_add_u32 s48, s48, s22
    buffer_load_dword v122, v121, s[4:7], s48 offen offset:1024
    s_mov_b32 exec_hi, 0
    buffer_load_dword v123, v120, s[4:7], s48 offen
    s_mov_b32 exec_hi, -1
    v_lshrrev_b32 v2, 2, v1
    v_and_b32 v3, 3, v1
    v_mul_u32_u24 v120, 3584, v2
    v_lshl_add_u32 v120, v3, 7, v120
    s_mul_i32 s47, s21, 3584
    s_mul_i32 s22, s18, 448
    s_add_u32 s47, s47, s22
    s_add_u32 s48, s47, 57344
    v_mov_b32 v104, 0x3f803f80
    v_mov_b32 v105, 0
    v_mov_b32 v106, 0
    v_mov_b32 v107, 0
    v_mov_b32 v108, 0
    s_waitcnt vmcnt(9)
    v_dot2c_f32_bf16 v105, v64, v104
    v_dot2c_f32_bf16 v107, v64, v64
    v_dot2c_f32_bf16 v106, v65, v104
    v_dot2c_f32_bf16 v108, v65, v65
    v_dot2c_f32_bf16 v105, v66, v104
    v_dot2c_f32_bf16 v107, v66, v66
    v_dot2c_f32_bf16 v106, v67, v104
    v_dot2c_f32_bf16 v108, v67, v67
    s_waitcnt vmcnt(8)
    v_dot2c_f32_bf16 v105, v68, v104
    v_dot2c_f32_bf16 v107, v68, v68
    v_dot2c_f32_bf16 v106, v69, v104
    v_dot2c_f32_bf16 v108, v69, v69
    v_dot2c_f32_bf16 v105, v70, v104
    v_dot2c_f32_bf16 v107, v70, v70
    v_dot2c_f32_bf16 v106, v71, v104
    v_dot2c_f32_bf16 v108, v71, v71
    s_waitcnt vmcnt(7)
    v_dot2c_f32_bf16 v105, v72, v104
    v_dot2c_f32_bf16 v107, v72, v72
    v_dot2c_f32_bf16 v106, v73, v104
    v_dot2c_f32_bf16 v108, v73, v73
    v_dot2c_f32_bf16 v105, v74, v104
    v_dot2c_f32_bf16 v107, v74, v74
    v_dot2c_f32_bf16 v106, v75, v104
    v_dot2c_f32_bf16 v108, v75, v75
    s_waitcnt vmcnt(6)
    v_dot2c_f32_bf16 v105, v76, v104
    v_dot2c_f32_bf16 v107, v76, v76
    v_dot2c_f32_bf16 v106, v77, v104
    v_dot2c_f32_bf16 v108, v77, v77
    v_dot2c_f32_bf16 v105, v78, v104
    v_dot2c_f32_bf16 v107, v78, v78
    v_dot2c_f32_bf16 v106, v79, v104
    v_dot2c_f32_bf16 v108, v79, v79
    s_waitcnt vmcnt(5)
    v_dot2c_f32_bf16 v105, v80, v104
    v_dot2c_f32_bf16 v107, v80, v80
    v_dot2c_f32_bf16 v106, v81, v104
    v_dot2c_f32_bf16 v108, v81, v81
    v_dot2c_f32_bf16 v105, v82, v104
    v_dot2c_f32_bf16 v107, v82, v82
    v_dot2c_f32_bf16 v106, v83, v104
    v_dot2c_f32_bf16 v108, v83, v83
    s_waitcnt vmcnt(4)
    v_dot2c_f32_bf16 v105, v84, v104
    v_dot2c_f32_bf16 v107, v84, v84
    v_dot2c_f32_bf16 v106, v85, v104
    v_dot2c_f32_bf16 v108, v85, v85
    v_dot2c_f32_bf16 v105, v86, v104
    v_dot2c_f32_bf16 v107, v86, v86
    v_dot2c_f32_bf16 v106, v87, v104
    v_dot2c_f32_bf16 v108, v87, v87
    s_waitcnt vmcnt(3)
    v_dot2c_f32_bf16 v105, v88, v104
    v_dot2c_f32_bf16 v107, v88, v88
    v_dot2c_f32_bf16 v106, v89, v104
    v_dot2c_f32_bf16 v108, v89, v89
    v_dot2c_f32_bf16 v105, v90, v104
    v_dot2c_f32_bf16 v107, v90, v90
    v_dot2c_f32_bf16 v106, v91, v104
    v_dot2c_f32_bf16 v108, v91, v91
    s_waitcnt vmcnt(2)
    v_dot2c_f32_bf16 v105, v92, v104
    v_dot2c_f32_bf16 v107, v92, v92
    v_dot2c_f32_bf16 v106, v93, v104
    v_dot2c_f32_bf16 v108, v93, v93
    v_dot2c_f32_bf16 v105, v94, v104
    v_dot2c_f32_bf16 v107, v94, v94
    v_dot2c_f32_bf16 v106, v95, v104
    v_dot2c_f32_bf16 v108, v95, v95
    s_nop 2
    buffer_load_dword v124, v120, s[8:11], s47 offen
    buffer_load_dword v125, v120, s[12:15], s47 offen
    buffer_load_dword v126, v120, s[8:11], s48 offen
    buffer_load_dword v127, v120, s[12:15], s48 offen
    s_branch Y_PRIMED
Y_EG:
    v_lshlrev_b32 v8, 7, v1
    s_lshl_b32 s99, s17, 13
    s_add_u32 s99, s99, 50397184
    v_mov_b32 v104, 0x3f803f80
    v_mov_b32 v105, 0
    v_mov_b32 v106, 0
    v_mov_b32 v107, 0
    v_mov_b32 v108, 0
    s_waitcnt vmcnt(7)
    v_dot2c_f32_bf16 v105, v64, v104
    v_dot2c_f32_bf16 v107, v64, v64
    v_dot2c_f32_bf16 v106, v65, v104
    v_dot2c_f32_bf16 v108, v65, v65
    v_dot2c_f32_bf16 v105, v66, v104
    v_dot2c_f32_bf16 v107, v66, v66
    v_dot2c_f32_bf16 v106, v67, v104
    v_dot2c_f32_bf16 v108, v67, v67
    s_waitcnt vmcnt(6)
    v_dot2c_f32_bf16 v105, v68, v104
    v_dot2c_f32_bf16 v107, v68, v68
    v_dot2c_f32_bf16 v106, v69, v104
    v_dot2c_f32_bf16 v108, v69, v69
    v_dot2c_f32_bf16 v105, v70, v104
    v_dot2c_f32_bf16 v107, v70, v70
    v_dot2c_f32_bf16 v106, v71, v104
    v_dot2c_f32_bf16 v108, v71, v71
    s_waitcnt vmcnt(5)
    v_dot2c_f32_bf16 v105, v72, v104
    v_dot2c_f32_bf16 v107, v72, v72
    v_dot2c_f32_bf16 v106, v73, v104
    v_dot2c_f32_bf16 v108, v73, v73
    v_dot2c_f32_bf16 v105, v74, v104
    v_dot2c_f32_bf16 v107, v74, v74
    v_dot2c_f32_bf16 v106, v75, v104
    v_dot2c_f32_bf16 v108, v75, v75
    s_waitcnt vmcnt(4)
    v_dot2c_f32_bf16 v105, v76, v104
    v_dot2c_f32_bf16 v107, v76, v76
    v_dot2c_f32_bf16 v106, v77, v104
    v_dot2c_f32_bf16 v108, v77, v77
    v_dot2c_f32_bf16 v105, v78, v104
    v_dot2c_f32_bf16 v107, v78, v78
    v_dot2c_f32_bf16 v106, v79, v104
    v_dot2c_f32_bf16 v108, v79, v79
    s_waitcnt vmcnt(3)
    v_dot2c_f32_bf16 v105, v80, v104
    v_dot2c_f32_bf16 v107, v80, v80
    v_dot2c_f32_bf16 v106, v81, v104
    v_dot2c_f32_bf16 v108, v81, v81
    v_dot2c_f32_bf16 v105, v82, v104
    v_dot2c_f32_bf16 v107, v82, v82
    v_dot2c_f32_bf16 v106, v83, v104
    v_dot2c_f32_bf16 v108, v83, v83
    s_waitcnt vmcnt(2)
    v_dot2c_f32_bf16 v105, v84, v104
    v_dot2c_f32_bf16 v107, v84, v84
    v_dot2c_f32_bf16 v106, v85, v104
    v_dot2c_f32_bf16 v108, v85, v85
    v_dot2c_f32_bf16 v105, v86, v104
    v_dot2c_f32_bf16 v107, v86, v86
    v_dot2c_f32_bf16 v106, v87, v104
    v_dot2c_f32_bf16 v108, v87, v87
    s_waitcnt vmcnt(1)
    v_dot2c_f32_bf16 v105, v88, v104
    v_dot2c_f32_bf16 v107, v88, v88
    v_dot2c_f32_bf16 v106, v89, v104
    v_dot2c_f32_bf16 v108, v89, v89
    v_dot2c_f32_bf16 v105, v90, v104
    v_dot2c_f32_bf16 v107, v90, v90
    v_dot2c_f32_bf16 v106, v91, v104
    v_dot2c_f32_bf16 v108, v91, v91
    s_waitcnt vmcnt(0)
    v_dot2c_f32_bf16 v105, v92, v104
    v_dot2c_f32_bf16 v107, v92, v92
    v_dot2c_f32_bf16 v106, v93, v104
    v_dot2c_f32_bf16 v108, v93, v93
    v_dot2c_f32_bf16 v105, v94, v104
    v_dot2c_f32_bf16 v107, v94, v94
    v_dot2c_f32_bf16 v106, v95, v104
    v_dot2c_f32_bf16 v108, v95, v95
    s_nop 2
    s_cmp_eq_u32 s98, 0
    s_cbranch_scc0 Y_PRIMED
    s_cmp_eq_u32 s16, 7
    s_cbranch_scc0 Y_PRIMED
    s_memrealtime s[46:47]
    s_mov_b64 exec, 1
    v_mov_b32 v2, 0
    s_waitcnt lgkmcnt(0)
    s_or_b32 s46, s46, 1
    v_mov_b32 v4, s46
    v_mov_b32 v5, s47
    global_store_dwordx2 v2, v[4:5], s[44:45] sc0 sc1
    s_mov_b64 exec, -1
Y_PRIMED:
    v_add_f32 v105, v105, v106
    v_add_f32 v107, v107, v108
    s_nop 0
    v_add_f32_dpp v105, v105, v105 quad_perm:[1,0,3,2] row_mask:0xf bank_mask:0xf
    v_add_f32_dpp v107, v107, v107 quad_perm:[1,0,3,2] row_mask:0xf bank_mask:0xf
    s_nop 0
    v_add_f32_dpp v105, v105, v105 quad_perm:[2,3,0,1] row_mask:0xf bank_mask:0xf
    v_add_f32_dpp v107, v107, v107 quad_perm:[2,3,0,1] row_mask:0xf bank_mask:0xf
    s_nop 0
    v_add_f32_dpp v105, v105, v105 row_half_mirror row_mask:0xf bank_mask:0xf
    v_add_f32_dpp v107, v107, v107 row_half_mirror row_mask:0xf bank_mask:0xf
    v_mul_f32 v105, 0x3b000000, v105
    v_mul_f32 v107, 0x3b000000, v107
    v_fma_f32 v107, -v105, v105, v107
    v_max_f32 v107, 0, v107
    v_add_f32 v107, 0x3727c5ac, v107
    v_rsq_f32 v110, v107
    s_nop 0
    v_mul_f32 v108, v105, v110
    v_sub_f32 v108, 0, v108
    v_lshlrev_b32 v112, 16, v64
    v_and_b32 v113, 0xffff0000, v64
    v_pk_fma_f32 v[112:113], v[112:113], v[110:111], v[108:109] op_sel_hi:[1,0,0]
    v_cvt_pk_bf16_f32 v64, v112, v113
    v_lshlrev_b32 v114, 16, v65
    v_and_b32 v115, 0xffff0000, v65
    v_pk_fma_f32 v[114:115], v[114:115], v[110:111], v[108:109] op_sel_hi:[1,0,0]
    v_cvt_pk_bf16_f32 v65, v114, v115
    v_lshlrev_b32 v116, 16, v66
    v_and_b32 v117, 0xffff0000, v66
    v_pk_fma_f32 v[116:117], v[116:117], v[110:111], v[108:109] op_sel_hi:[1,0,0]
    v_cvt_pk_bf16_f32 v66, v116, v117
    v_lshlrev_b32 v118, 16, v67
    v_and_b32 v119, 0xffff0000, v67
    v_pk_fma_f32 v[118:119], v[118:119], v[110:111], v[108:109] op_sel_hi:[1,0,0]
    v_cvt_pk_bf16_f32 v67, v118, v119
    ds_write_b128 v97, v[64:67] offset:0
    v_lshlrev_b32 v112, 16, v68
    v_and_b32 v113, 0xffff0000, v68
    v_pk_fma_f32 v[112:113], v[112:113], v[110:111], v[108:109] op_sel_hi:[1,0,0]
    v_cvt_pk_bf16_f32 v68, v112, v113
    v_lshlrev_b32 v114, 16, v69
    v_and_b32 v115, 0xffff0000, v69
    v_pk_fma_f32 v[114:115], v[114:115], v[110:111], v[108:109] op_sel_hi:[1,0,0]
    v_cvt_pk_bf16_f32 v69, v114, v115
    v_lshlrev_b32 v116, 16, v70
    v_and_b32 v117, 0xffff0000, v70
    v_pk_fma_f32 v[116:117], v[116:117], v[110:111], v[108:109] op_sel_hi:[1,0,0]
    v_cvt_pk_bf16_f32 v70, v116, v117
    v_lshlrev_b32 v118, 16, v71
    v_and_b32 v119, 0xffff0000, v71
    v_pk_fma_f32 v[118:119], v[118:119], v[110:111], v[108:109] op_sel_hi:[1,0,0]
    v_cvt_pk_bf16_f32 v71, v118, v119
    ds_write_b128 v97, v[68:71] offset:4096
    v_lshlrev_b32 v112, 16, v72
    v_and_b32 v113, 0xffff0000, v72
    v_pk_fma_f32 v[112:113], v[112:113], v[110:111], v[108:109] op_sel_hi:[1,0,0]
    v_cvt_pk_bf16_f32 v72, v112, v113
    v_lshlrev_b32 v114, 16, v73
    v_and_b32 v115, 0xffff0000, v73
    v_pk_fma_f32 v[114:115], v[114:115], v[110:111], v[108:109] op_sel_hi:[1,0,0]
    v_cvt_pk_bf16_f32 v73, v114, v115
    v_lshlrev_b32 v116, 16, v74
    v_and_b32 v117, 0xffff0000, v74
    v_pk_fma_f32 v[116:117], v[116:117], v[110:111], v[108:109] op_sel_hi:[1,0,0]
    v_cvt_pk_bf16_f32 v74, v116, v117
    v_lshlrev_b32 v118, 16, v75
    v_and_b32 v119, 0xffff0000, v75
    v_pk_fma_f32 v[118:119], v[118:119], v[110:111], v[108:109] op_sel_hi:[1,0,0]
    v_cvt_pk_bf16_f32 v75, v118, v119
    ds_write_b128 v97, v[72:75] offset:8192
    v_lshlrev_b32 v112, 16, v76
    v_and_b32 v113, 0xffff0000, v76
    v_pk_fma_f32 v[112:113], v[112:113], v[110:111], v[108:109] op_sel_hi:[1,0,0]
    v_cvt_pk_bf16_f32 v76, v112, v113
    v_lshlrev_b32 v114, 16, v77
    v_and_b32 v115, 0xffff0000, v77
    v_pk_fma_f32 v[114:115], v[114:115], v[110:111], v[108:109] op_sel_hi:[1,0,0]
    v_cvt_pk_bf16_f32 v77, v114, v115
    v_lshlrev_b32 v116, 16, v78
    v_and_b32 v117, 0xffff0000, v78
    v_pk_fma_f32 v[116:117], v[116:117], v[110:111], v[108:109] op_sel_hi:[1,0,0]
    v_cvt_pk_bf16_f32 v78, v116, v117
    v_lshlrev_b32 v118, 16, v79
    v_and_b32 v119, 0xffff0000, v79
    v_pk_fma_f32 v[118:119], v[118:119], v[110:111], v[108:109] op_sel_hi:[1,0,0]
    v_cvt_pk_bf16_f32 v79, v118, v119
    ds_write_b128 v97, v[76:79] offset:12288
    v_lshlrev_b32 v112, 16, v80
    v_and_b32 v113, 0xffff0000, v80
    v_pk_fma_f32 v[112:113], v[112:113], v[110:111], v[108:109] op_sel_hi:[1,0,0]
    v_cvt_pk_bf16_f32 v80, v112, v113
    v_lshlrev_b32 v114, 16, v81
    v_and_b32 v115, 0xffff0000, v81
    v_pk_fma_f32 v[114:115], v[114:115], v[110:111], v[108:109] op_sel_hi:[1,0,0]
    v_cvt_pk_bf16_f32 v81, v114, v115
    v_lshlrev_b32 v116, 16, v82
    v_and_b32 v117, 0xffff0000, v82
    v_pk_fma_f32 v[116:117], v[116:117], v[110:111], v[108:109] op_sel_hi:[1,0,0]
    v_cvt_pk_bf16_f32 v82, v116, v117
    v_lshlrev_b32 v118, 16, v83
    v_and_b32 v119, 0xffff0000, v83
    v_pk_fma_f32 v[118:119], v[118:119], v[110:111], v[108:109] op_sel_hi:[1,0,0]
    v_cvt_pk_bf16_f32 v83, v118, v119
    ds_write_b128 v97, v[80:83] offset:16384
    v_lshlrev_b32 v112, 16, v84
    v_and_b32 v113, 0xffff0000, v84
    v_pk_fma_f32 v[112:113], v[112:113], v[110:111], v[108:109] op_sel_hi:[1,0,0]
    v_cvt_pk_bf16_f32 v84, v112, v113
    v_lshlrev_b32 v114, 16, v85
    v_and_b32 v115, 0xffff0000, v85
    v_pk_fma_f32 v[114:115], v[114:115], v[110:111], v[108:109] op_sel_hi:[1,0,0]
    v_cvt_pk_bf16_f32 v85, v114, v115
    v_lshlrev_b32 v116, 16, v86
    v_and_b32 v117, 0xffff0000, v86
    v_pk_fma_f32 v[116:117], v[116:117], v[110:111], v[108:109] op_sel_hi:[1,0,0]
    v_cvt_pk_bf16_f32 v86, v116, v117
    v_lshlrev_b32 v118, 16, v87
    v_and_b32 v119, 0xffff0000, v87
    v_pk_fma_f32 v[118:119], v[118:119], v[110:111], v[108:109] op_sel_hi:[1,0,0]
    v_cvt_pk_bf16_f32 v87, v118, v119
    ds_write_b128 v97, v[84:87] offset:20480
    v_lshlrev_b32 v112, 16, v88
    v_and_b32 v113, 0xffff0000, v88
    v_pk_fma_f32 v[112:113], v[112:113], v[110:111], v[108:109] op_sel_hi:[1,0,0]
    v_cvt_pk_bf16_f32 v88, v112, v113
    v_lshlrev_b32 v114, 16, v89
    v_and_b32 v115, 0xffff0000, v89
    v_pk_fma_f32 v[114:115], v[114:115], v[110:111], v[108:109] op_sel_hi:[1,0,0]
    v_cvt_pk_bf16_f32 v89, v114, v115
    v_lshlrev_b32 v116, 16, v90
    v_and_b32 v117, 0xffff0000, v90
    v_pk_fma_f32 v[116:117], v[116:117], v[110:111], v[108:109] op_sel_hi:[1,0,0]
    v_cvt_pk_bf16_f32 v90, v116, v117
    v_lshlrev_b32 v118, 16, v91
    v_and_b32 v119, 0xffff0000, v91
    v_pk_fma_f32 v[118:119], v[118:119], v[110:111], v[108:109] op_sel_hi:[1,0,0]
    v_cvt_pk_bf16_f32 v91, v118, v119
    ds_write_b128 v97, v[88:91] offset:24576
    v_lshlrev_b32 v112, 16, v92
    v_and_b32 v113, 0xffff0000, v92
    v_pk_fma_f32 v[112:113], v[112:113], v[110:111], v[108:109] op_sel_hi:[1,0,0]
    v_cvt_pk_bf16_f32 v92, v112, v113
    v_lshlrev_b32 v114, 16, v93
    v_and_b32 v115, 0xffff0000, v93
    v_pk_fma_f32 v[114:115], v[114:115], v[110:111], v[108:109] op_sel_hi:[1,0,0]
    v_cvt_pk_bf16_f32 v93, v114, v115
    v_lshlrev_b32 v116, 16, v94
    v_and_b32 v117, 0xffff0000, v94
    v_pk_fma_f32 v[116:117], v[116:117], v[110:111], v[108:109] op_sel_hi:[1,0,0]
    v_cvt_pk_bf16_f32 v94, v116, v117
    v_lshlrev_b32 v118, 16, v95
    v_and_b32 v119, 0xffff0000, v95
    v_pk_fma_f32 v[118:119], v[118:119], v[110:111], v[108:109] op_sel_hi:[1,0,0]
    v_cvt_pk_bf16_f32 v95, v118, v119
    ds_write_b128 v97, v[92:95] offset:28672
    s_waitcnt lgkmcnt(0)
    s_barrier
    s_cmp_ge_u32 s16, 4
    s_cbranch_scc1 Y_G
    s_cmp_eq_u32 s16, 1
    s_cbranch_scc1 Y_V
    s_cmp_eq_u32 s16, 2
    s_cbranch_scc1 Y_Q
    s_cmp_eq_u32 s16, 3
    s_cbranch_scc1 Y_POLLER
Y_K:
    s_setprio 3
    s_waitcnt vmcnt(6)
    ds_read_b64_tr_b16 v[192:193], v12 offset:0
    ds_read_b64_tr_b16 v[194:195], v12 offset:512
    ds_read_b64_tr_b16 v[196:197], v13 offset:0
    ds_read_b64_tr_b16 v[198:199], v13 offset:512
    ds_read_b128 v[208:211], v16 offset:0
    ds_read_b128 v[212:215], v16 offset:32768
    s_waitcnt lgkmcnt(0)
    ds_read_b128 v[216:219], v17 offset:1024
    ds_read_b128 v[220:223], v17 offset:33792
    v_mfma_f32_32x32x16_bf16 v[128:143], v[192:195], v[208:211], 0
    s_waitcnt vmcnt(4)
    ds_read_b64_tr_b16 v[200:201], v12 offset:2048
    ds_read_b64_tr_b16 v[202:203], v12 offset:2560
    ds_read_b64_tr_b16 v[204:205], v13 offset:2048
    ds_read_b64_tr_b16 v[206:207], v13 offset:2560
    v_mfma_f32_32x32x16_bf16 v[144:159], v[196:199], v[208:211], 0
    s_add_u32 m0, s28, 0
    s_nop 0
    buffer_load_dwordx4 v10, s[4:7], s29 offen lds
    s_add_u32 s29, s29, 24576
    v_mfma_f32_32x32x16_bf16 v[160:175], v[192:195], v[212:215], 0
    s_add_u32 m0, s28, 1024
    s_nop 0
    buffer_load_dwordx4 v10, s[4:7], s29 offen lds
    s_add_u32 s29, s29, 24576
    v_mfma_f32_32x32x16_bf16 v[176:191], v[196:199], v[212:215], 0
    s_waitcnt lgkmcnt(0)
    ds_read_b128 v[208:211], v18 offset:2048
    ds_read_b128 v[212:215], v18 offset:34816
    v_mfma_f32_32x32x16_bf16 v[128:143], v[200:203], v[216:219], v[128:143]
    s_waitcnt vmcnt(4)
    ds_read_b64_tr_b16 v[192:193], v12 offset:4096
    ds_read_b64_tr_b16 v[194:195], v12 offset:4608
    ds_read_b64_tr_b16 v[196:197], v13 offset:4096
    ds_read_b64_tr_b16 v[198:199], v13 offset:4608
    v_mfma_f32_32x32x16_bf16 v[144:159], v[204:207], v[216:219], v[144:159]
    s_add_u32 m0, s28, 2048
    s_nop 0
    buffer_load_dwordx4 v10, s[4:7], s29 offen lds
    s_add_u32 s29, s29, 24576
    v_mfma_f32_32x32x16_bf16 v[160:175], v[200:203], v[220:223], v[160:175]
    s_add_u32 m0, s28, 3072
    s_nop 0
    buffer_load_dwordx4 v10, s[4:7], s29 offen lds
    s_add_u32 s29, s29, 24576
    v_mfma_f32_32x32x16_bf16 v[176:191], v[204:207], v[220:223], v[176:191]
    s_waitcnt lgkmcnt(0)
    ds_read_b128 v[216:219], v19 offset:3072
    ds_read_b128 v[220:223], v19 offset:35840
    v_mfma_f32_32x32x16_bf16 v[128:143], v[192:195], v[208:211], v[128:143]
    s_waitcnt vmcnt(4)
    ds_read_b64_tr_b16 v[200:201], v12 offset:6144
    ds_read_b64_tr_b16 v[202:203], v12 offset:6656
    ds_read_b64_tr_b16 v[204:205], v13 offset:6144
    ds_read_b64_tr_b16 v[206:207], v13 offset:6656
    v_mfma_f32_32x32x16_bf16 v[144:159], v[196:199], v[208:211], v[144:159]
    s_add_u32 m0, s28, 4096
    s_nop 0
    buffer_load_dwordx4 v10, s[4:7], s29 offen lds
    s_add_u32 s29, s29, 24576
    v_mfma_f32_32x32x16_bf16 v[160:175], v[192:195], v[212:215], v[160:175]
    s_add_u32 m0, s28, 5120
    s_nop 0
    buffer_load_dwordx4 v10, s[4:7], s29 offen lds
    s_add_u32 s29, s29, 24576
    v_mfma_f32_32x32x16_bf16 v[176:191], v[196:199], v[212:215], v[176:191]
    s_waitcnt lgkmcnt(0)
    ds_read_b128 v[208:211], v16 offset:4096
    ds_read_b128 v[212:215], v16 offset:36864
    v_mfma_f32_32x32x16_bf16 v[128:143], v[200:203], v[216:219], v[128:143]
    s_waitcnt vmcnt(4)
    ds_read_b64_tr_b16 v[192:193], v12 offset:0
    ds_read_b64_tr_b16 v[194:195], v12 offset:512
    ds_read_b64_tr_b16 v[196:197], v13 offset:0
    ds_read_b64_tr_b16 v[198:199], v13 offset:512
    v_mfma_f32_32x32x16_bf16 v[144:159], v[204:207], v[216:219], v[144:159]
    s_add_u32 m0, s28, 6144
    s_nop 0
    buffer_load_dwordx4 v10, s[4:7], s29 offen lds
    s_add_u32 s29, s29, 24576
    v_mfma_f32_32x32x16_bf16 v[160:175], v[200:203], v[220:223], v[160:175]
    s_add_u32 m0, s28, 7168
    s_nop 0
    buffer_load_dwordx4 v10, s[4:7], s29 offen lds
    s_add_u32 s29, s29, 24576
    v_mfma_f32_32x32x16_bf16 v[176:191], v[204:207], v[220:223], v[176:191]
    s_waitcnt lgkmcnt(0)
    ds_read_b128 v[216:219], v17 offset:5120
    ds_read_b128 v[220:223], v17 offset:37888
    v_mfma_f32_32x32x16_bf16 v[128:143], v[192:195], v[208:211], v[128:143]
    s_waitcnt vmcnt(4)
    ds_read_b64_tr_b16 v[200:201], v12 offset:2048
    ds_read_b64_tr_b16 v[202:203], v12 offset:2560
    ds_read_b64_tr_b16 v[204:205], v13 offset:2048
    ds_read_b64_tr_b16 v[206:207], v13 offset:2560
    v_mfma_f32_32x32x16_bf16 v[144:159], v[196:199], v[208:211], v[144:159]
    s_add_u32 m0, s28, 0
    s_nop 0
    buffer_load_dwordx4 v10, s[4:7], s29 offen lds
    s_add_u32 s29, s29, 24576
    v_mfma_f32_32x32x16_bf16 v[160:175], v[192:195], v[212:215], v[160:175]
    s_add_u32 m0, s28, 1024
    s_nop 0
    buffer_load_dwordx4 v10, s[4:7], s29 offen lds
    s_add_u32 s29, s29, 24576
    v_mfma_f32_32x32x16_bf16 v[176:191], v[196:199], v[212:215], v[176:191]
    s_waitcnt lgkmcnt(0)
    ds_read_b128 v[208:211], v18 offset:6144
    ds_read_b128 v[212:215], v18 offset:38912
    v_mfma_f32_32x32x16_bf16 v[128:143], v[200:203], v[216:219], v[128:143]
    s_waitcnt vmcnt(4)
    ds_read_b64_tr_b16 v[192:193], v12 offset:4096
    ds_read_b64_tr_b16 v[194:195], v12 offset:4608
    ds_read_b64_tr_b16 v[196:197], v13 offset:4096
    ds_read_b64_tr_b16 v[198:199], v13 offset:4608
    v_mfma_f32_32x32x16_bf16 v[144:159], v[204:207], v[216:219], v[144:159]
    s_add_u32 m0, s28, 2048
    s_nop 0
    buffer_load_dwordx4 v10, s[4:7], s29 offen lds
    s_add_u32 s29, s29, 24576
    v_mfma_f32_32x32x16_bf16 v[160:175], v[200:203], v[220:223], v[160:175]
    s_add_u32 m0, s28, 3072
    s_nop 0
    buffer_load_dwordx4 v10, s[4:7], s29 offen lds
    s_add_u32 s29, s29, 24576
    v_mfma_f32_32x32x16_bf16 v[176:191], v[204:207], v[220:223], v[176:191]
    s_waitcnt lgkmcnt(0)
    ds_read_b128 v[216:219], v19 offset:7168
    ds_read_b128 v[220:223], v19 offset:39936
    v_mfma_f32_32x32x16_bf16 v[128:143], v[192:195], v[208:211], v[128:143]
    s_waitcnt vmcnt(4)
    ds_read_b64_tr_b16 v[200:201], v12 offset:6144
    ds_read_b64_tr_b16 v[202:203], v12 offset:6656
    ds_read_b64_tr_b16 v[204:205], v13 offset:6144
    ds_read_b64_tr_b16 v[206:207], v13 offset:6656
    v_mfma_f32_32x32x16_bf16 v[144:159], v[196:199], v[208:211], v[144:159]
    s_add_u32 m0, s28, 4096
    s_nop 0
    buffer_load_dwordx4 v10, s[4:7], s29 offen lds
    s_add_u32 s29, s29, 24576
    v_mfma_f32_32x32x16_bf16 v[160:175], v[192:195], v[212:215], v[160:175]
    s_add_u32 m0, s28, 5120
    s_nop 0
    buffer_load_dwordx4 v10, s[4:7], s29 offen lds
    s_add_u32 s29, s29, 24576
    v_mfma_f32_32x32x16_bf16 v[176:191], v[196:199], v[212:215], v[176:191]
    s_waitcnt lgkmcnt(0)
    ds_read_b128 v[208:211], v16 offset:8192
    ds_read_b128 v[212:215], v16 offset:40960
    v_mfma_f32_32x32x16_bf16 v[128:143], v[200:203], v[216:219], v[128:143]
    s_waitcnt vmcnt(4)
    ds_read_b64_tr_b16 v[192:193], v12 offset:0
    ds_read_b64_tr_b16 v[194:195], v12 offset:512
    ds_read_b64_tr_b16 v[196:197], v13 offset:0
    ds_read_b64_tr_b16 v[198:199], v13 offset:512
    v_mfma_f32_32x32x16_bf16 v[144:159], v[204:207], v[216:219], v[144:159]
    s_add_u32 m0, s28, 6144
    s_nop 0
    buffer_load_dwordx4 v10, s[4:7], s29 offen lds
    s_add_u32 s29, s29, 24576
    v_mfma_f32_32x32x16_bf16 v[160:175], v[200:203], v[220:223], v[160:175]
    s_add_u32 m0, s28, 7168
    s_nop 0
    buffer_load_dwordx4 v10, s[4:7], s29 offen lds
    s_add_u32 s29, s29, 24576
    v_mfma_f32_32x32x16_bf16 v[176:191], v[204:207], v[220:223], v[176:191]
    s_waitcnt lgkmcnt(0)
    ds_read_b128 v[216:219], v17 offset:9216
    ds_read_b128 v[220:223], v17 offset:41984
    v_mfma_f32_32x32x16_bf16 v[128:143], v[192:195], v[208:211], v[128:143]
    s_waitcnt vmcnt(4)
    ds_read_b64_tr_b16 v[200:201], v12 offset:2048
    ds_read_b64_tr_b16 v[202:203], v12 offset:2560
    ds_read_b64_tr_b16 v[204:205], v13 offset:2048
    ds_read_b64_tr_b16 v[206:207], v13 offset:2560
    v_mfma_f32_32x32x16_bf16 v[144:159], v[196:199], v[208:211], v[144:159]
    s_add_u32 m0, s28, 0
    s_nop 0
    buffer_load_dwordx4 v10, s[4:7], s29 offen lds
    s_add_u32 s29, s29, 24576
    v_mfma_f32_32x32x16_bf16 v[160:175], v[192:195], v[212:215], v[160:175]
    s_add_u32 m0, s28, 1024
    s_nop 0
    buffer_load_dwordx4 v10, s[4:7], s29 offen lds
    s_add_u32 s29, s29, 24576
    v_mfma_f32_32x32x16_bf16 v[176:191], v[196:199], v[212:215], v[176:191]
    s_waitcnt lgkmcnt(0)
    ds_read_b128 v[208:211], v18 offset:10240
    ds_read_b128 v[212:215], v18 offset:43008
    v_mfma_f32_32x32x16_bf16 v[128:143], v[200:203], v[216:219], v[128:143]
    s_waitcnt vmcnt(4)
    ds_read_b64_tr_b16 v[192:193], v12 offset:4096
    ds_read_b64_tr_b16 v[194:195], v12 offset:4608
    ds_read_b64_tr_b16 v[196:197], v13 offset:4096
    ds_read_b64_tr_b16 v[198:199], v13 offset:4608
    v_mfma_f32_32x32x16_bf16 v[144:159], v[204:207], v[216:219], v[144:159]
    s_add_u32 m0, s28, 2048
    s_nop 0
    buffer_load_dwordx4 v10, s[4:7], s29 offen lds
    s_add_u32 s29, s29, 24576
    v_mfma_f32_32x32x16_bf16 v[160:175], v[200:203], v[220:223], v[160:175]
    s_add_u32 m0, s28, 3072
    s_nop 0
    buffer_load_dwordx4 v10, s[4:7], s29 offen lds
    s_add_u32 s29, s29, 24576
    v_mfma_f32_32x32x16_bf16 v[176:191], v[204:207], v[220:223], v[176:191]
    s_waitcnt lgkmcnt(0)
    ds_read_b128 v[216:219], v19 offset:11264
    ds_read_b128 v[220:223], v19 offset:44032
    v_mfma_f32_32x32x16_bf16 v[128:143], v[192:195], v[208:211], v[128:143]
    s_waitcnt vmcnt(4)
    ds_read_b64_tr_b16 v[200:201], v12 offset:6144
    ds_read_b64_tr_b16 v[202:203], v12 offset:6656
    ds_read_b64_tr_b16 v[204:205], v13 offset:6144
    ds_read_b64_tr_b16 v[206:207], v13 offset:6656
    v_mfma_f32_32x32x16_bf16 v[144:159], v[196:199], v[208:211], v[144:159]
    s_add_u32 m0, s28, 4096
    s_nop 0
    buffer_load_dwordx4 v10, s[4:7], s29 offen lds
    s_add_u32 s29, s29, 24576
    v_mfma_f32_32x32x16_bf16 v[160:175], v[192:195], v[212:215], v[160:175]
    s_add_u32 m0, s28, 5120
    s_nop 0
    buffer_load_dwordx4 v10, s[4:7], s29 offen lds
    s_add_u32 s29, s29, 24576
    v_mfma_f32_32x32x16_bf16 v[176:191], v[196:199], v[212:215], v[176:191]
    s_waitcnt lgkmcnt(0)
    ds_read_b128 v[208:211], v16 offset:12288
    ds_read_b128 v[212:215], v16 offset:45056
    v_mfma_f32_32x32x16_bf16 v[128:143], v[200:203], v[216:219], v[128:143]
    s_waitcnt vmcnt(4)
    ds_read_b64_tr_b16 v[192:193], v12 offset:0
    ds_read_b64_tr_b16 v[194:195], v12 offset:512
    ds_read_b64_tr_b16 v[196:197], v13 offset:0
    ds_read_b64_tr_b16 v[198:199], v13 offset:512
    v_mfma_f32_32x32x16_bf16 v[144:159], v[204:207], v[216:219], v[144:159]
    s_add_u32 m0, s28, 6144
    s_nop 0
    buffer_load_dwordx4 v10, s[4:7], s29 offen lds
    s_add_u32 s29, s29, 24576
    v_mfma_f32_32x32x16_bf16 v[160:175], v[200:203], v[220:223], v[160:175]
    s_add_u32 m0, s28, 7168
    s_nop 0
    buffer_load_dwordx4 v10, s[4:7], s29 offen lds
    s_add_u32 s29, s29, 24576
    v_mfma_f32_32x32x16_bf16 v[176:191], v[204:207], v[220:223], v[176:191]
    s_waitcnt lgkmcnt(0)
    ds_read_b128 v[216:219], v17 offset:13312
    ds_read_b128 v[220:223], v17 offset:46080
    v_mfma_f32_32x32x16_bf16 v[128:143], v[192:195], v[208:211], v[128:143]
    s_waitcnt vmcnt(4)
    ds_read_b64_tr_b16 v[200:201], v12 offset:2048
    ds_read_b64_tr_b16 v[202:203], v12 offset:2560
    ds_read_b64_tr_b16 v[204:205], v13 offset:2048
    ds_read_b64_tr_b16 v[206:207], v13 offset:2560
    v_mfma_f32_32x32x16_bf16 v[144:159], v[196:199], v[208:211], v[144:159]
    s_add_u32 m0, s28, 0
    s_nop 0
    buffer_load_dwordx4 v10, s[4:7], s29 offen lds
    s_add_u32 s29, s29, 24576
    v_mfma_f32_32x32x16_bf16 v[160:175], v[192:195], v[212:215], v[160:175]
    s_add_u32 m0, s28, 1024
    s_nop 0
    buffer_load_dwordx4 v10, s[4:7], s29 offen lds
    s_add_u32 s29, s29, 24576
    v_mfma_f32_32x32x16_bf16 v[176:191], v[196:199], v[212:215], v[176:191]
    s_waitcnt lgkmcnt(0)
    ds_read_b128 v[208:211], v18 offset:14336
    ds_read_b128 v[212:215], v18 offset:47104
    v_mfma_f32_32x32x16_bf16 v[128:143], v[200:203], v[216:219], v[128:143]
    s_waitcnt vmcnt(4)
    ds_read_b64_tr_b16 v[192:193], v12 offset:4096
    ds_read_b64_tr_b16 v[194:195], v12 offset:4608
    ds_read_b64_tr_b16 v[196:197], v13 offset:4096
    ds_read_b64_tr_b16 v[198:199], v13 offset:4608
    v_mfma_f32_32x32x16_bf16 v[144:159], v[204:207], v[216:219], v[144:159]
    s_add_u32 m0, s28, 2048
    s_nop 0
    buffer_load_dwordx4 v10, s[4:7], s29 offen lds
    s_add_u32 s29, s29, 24576
    v_mfma_f32_32x32x16_bf16 v[160:175], v[200:203], v[220:223], v[160:175]
    s_add_u32 m0, s28, 3072
    s_nop 0
    buffer_load_dwordx4 v10, s[4:7], s29 offen lds
    s_add_u32 s29, s29, 24576
    v_mfma_f32_32x32x16_bf16 v[176:191], v[204:207], v[220:223], v[176:191]
    s_waitcnt lgkmcnt(0)
    ds_read_b128 v[216:219], v19 offset:15360
    ds_read_b128 v[220:223], v19 offset:48128
    v_mfma_f32_32x32x16_bf16 v[128:143], v[192:195], v[208:211], v[128:143]
    s_waitcnt vmcnt(4)
    ds_read_b64_tr_b16 v[200:201], v12 offset:6144
    ds_read_b64_tr_b16 v[202:203], v12 offset:6656
    ds_read_b64_tr_b16 v[204:205], v13 offset:6144
    ds_read_b64_tr_b16 v[206:207], v13 offset:6656
    v_mfma_f32_32x32x16_bf16 v[144:159], v[196:199], v[208:211], v[144:159]
    s_add_u32 m0, s28, 4096
    s_nop 0
    buffer_load_dwordx4 v10, s[4:7], s29 offen lds
    s_add_u32 s29, s29, 24576
    v_mfma_f32_32x32x16_bf16 v[160:175], v[192:195], v[212:215], v[160:175]
    s_add_u32 m0, s28, 5120
    s_nop 0
    buffer_load_dwordx4 v10, s[4:7], s29 offen lds
    s_add_u32 s29, s29, 24576
    v_mfma_f32_32x32x16_bf16 v[176:191], v[196:199], v[212:215], v[176:191]
    s_waitcnt lgkmcnt(0)
    ds_read_b128 v[208:211], v16 offset:16384
    ds_read_b128 v[212:215], v16 offset:49152
    v_mfma_f32_32x32x16_bf16 v[128:143], v[200:203], v[216:219], v[128:143]
    s_waitcnt vmcnt(4)
    ds_read_b64_tr_b16 v[192:193], v12 offset:0
    ds_read_b64_tr_b16 v[194:195], v12 offset:512
    ds_read_b64_tr_b16 v[196:197], v13 offset:0
    ds_read_b64_tr_b16 v[198:199], v13 offset:512
    v_mfma_f32_32x32x16_bf16 v[144:159], v[204:207], v[216:219], v[144:159]
    s_add_u32 m0, s28, 6144
    s_nop 0
    buffer_load_dwordx4 v10, s[4:7], s29 offen lds
    s_add_u32 s29, s29, 24576
    v_mfma_f32_32x32x16_bf16 v[160:175], v[200:203], v[220:223], v[160:175]
    s_add_u32 m0, s28, 7168
    s_nop 0
    buffer_load_dwordx4 v10, s[4:7], s29 offen lds
    s_add_u32 s29, s29, 24576
    v_mfma_f32_32x32x16_bf16 v[176:191], v[204:207], v[220:223], v[176:191]
    s_waitcnt lgkmcnt(0)
    ds_read_b128 v[216:219], v17 offset:17408
    ds_read_b128 v[220:223], v17 offset:50176
    v_mfma_f32_32x32x16_bf16 v[128:143], v[192:195], v[208:211], v[128:143]
    s_waitcnt vmcnt(4)
    ds_read_b64_tr_b16 v[200:201], v12 offset:2048
    ds_read_b64_tr_b16 v[202:203], v12 offset:2560
    ds_read_b64_tr_b16 v[204:205], v13 offset:2048
    ds_read_b64_tr_b16 v[206:207], v13 offset:2560
    v_mfma_f32_32x32x16_bf16 v[144:159], v[196:199], v[208:211], v[144:159]
    s_add_u32 m0, s28, 0
    s_nop 0
    buffer_load_dwordx4 v10, s[4:7], s29 offen lds
    s_add_u32 s29, s29, 24576
    v_mfma_f32_32x32x16_bf16 v[160:175], v[192:195], v[212:215], v[160:175]
    s_add_u32 m0, s28, 1024
    s_nop 0
    buffer_load_dwordx4 v10, s[4:7], s29 offen lds
    s_add_u32 s29, s29, 24576
    v_mfma_f32_32x32x16_bf16 v[176:191], v[196:199], v[212:215], v[176:191]
    s_waitcnt lgkmcnt(0)
    ds_read_b128 v[208:211], v18 offset:18432
    ds_read_b128 v[212:215], v18 offset:51200
    v_mfma_f32_32x32x16_bf16 v[128:143], v[200:203], v[216:219], v[128:143]
    s_waitcnt vmcnt(4)
    ds_read_b64_tr_b16 v[192:193], v12 offset:4096
    ds_read_b64_tr_b16 v[194:195], v12 offset:4608
    ds_read_b64_tr_b16 v[196:197], v13 offset:4096
    ds_read_b64_tr_b16 v[198:199], v13 offset:4608
    v_mfma_f32_32x32x16_bf16 v[144:159], v[204:207], v[216:219], v[144:159]
    s_add_u32 m0, s28, 2048
    s_nop 0
    buffer_load_dwordx4 v10, s[4:7], s29 offen lds
    s_add_u32 s29, s29, 24576
    v_mfma_f32_32x32x16_bf16 v[160:175], v[200:203], v[220:223], v[160:175]
    s_add_u32 m0, s28, 3072
    s_nop 0
    buffer_load_dwordx4 v10, s[4:7], s29 offen lds
    s_add_u32 s29, s29, 24576
    v_mfma_f32_32x32x16_bf16 v[176:191], v[204:207], v[220:223], v[176:191]
    s_waitcnt lgkmcnt(0)
    ds_read_b128 v[216:219], v19 offset:19456
    ds_read_b128 v[220:223], v19 offset:52224
    v_mfma_f32_32x32x16_bf16 v[128:143], v[192:195], v[208:211], v[128:143]
    s_waitcnt vmcnt(4)
    ds_read_b64_tr_b16 v[200:201], v12 offset:6144
    ds_read_b64_tr_b16 v[202:203], v12 offset:6656
    ds_read_b64_tr_b16 v[204:205], v13 offset:6144
    ds_read_b64_tr_b16 v[206:207], v13 offset:6656
    v_mfma_f32_32x32x16_bf16 v[144:159], v[196:199], v[208:211], v[144:159]
    s_add_u32 m0, s28, 4096
    s_nop 0
    buffer_load_dwordx4 v10, s[4:7], s29 offen lds
    s_add_u32 s29, s29, 24576
    v_mfma_f32_32x32x16_bf16 v[160:175], v[192:195], v[212:215], v[160:175]
    s_add_u32 m0, s28, 5120
    s_nop 0
    buffer_load_dwordx4 v10, s[4:7], s29 offen lds
    s_add_u32 s29, s29, 24576
    v_mfma_f32_32x32x16_bf16 v[176:191], v[196:199], v[212:215], v[176:191]
    s_waitcnt lgkmcnt(0)
    ds_read_b128 v[208:211], v16 offset:20480
    ds_read_b128 v[212:215], v16 offset:53248
    v_mfma_f32_32x32x16_bf16 v[128:143], v[200:203], v[216:219], v[128:143]
    s_waitcnt vmcnt(4)
    ds_read_b64_tr_b16 v[192:193], v12 offset:0
    ds_read_b64_tr_b16 v[194:195], v12 offset:512
    ds_read_b64_tr_b16 v[196:197], v13 offset:0
    ds_read_b64_tr_b16 v[198:199], v13 offset:512
    v_mfma_f32_32x32x16_bf16 v[144:159], v[204:207], v[216:219], v[144:159]
    s_add_u32 m0, s28, 6144
    s_nop 0
    buffer_load_dwordx4 v10, s[4:7], s29 offen lds
    s_add_u32 s29, s29, 24576
    v_mfma_f32_32x32x16_bf16 v[160:175], v[200:203], v[220:223], v[160:175]
    s_add_u32 m0, s28, 7168
    s_nop 0
    buffer_load_dwordx4 v10, s[4:7], s29 offen lds
    s_add_u32 s29, s29, 24576
    v_mfma_f32_32x32x16_bf16 v[176:191], v[204:207], v[220:223], v[176:191]
    s_waitcnt lgkmcnt(0)
    ds_read_b128 v[216:219], v17 offset:21504
    ds_read_b128 v[220:223], v17 offset:54272
    v_mfma_f32_32x32x16_bf16 v[128:143], v[192:195], v[208:211], v[128:143]
    s_waitcnt vmcnt(4)
    ds_read_b64_tr_b16 v[200:201], v12 offset:2048
    ds_read_b64_tr_b16 v[202:203], v12 offset:2560
    ds_read_b64_tr_b16 v[204:205], v13 offset:2048
    ds_read_b64_tr_b16 v[206:207], v13 offset:2560
    v_mfma_f32_32x32x16_bf16 v[144:159], v[196:199], v[208:211], v[144:159]
    s_add_u32 m0, s28, 0
    s_nop 0
    buffer_load_dwordx4 v10, s[4:7], s29 offen lds
    s_add_u32 s29, s29, 24576
    v_mfma_f32_32x32x16_bf16 v[160:175], v[192:195], v[212:215], v[160:175]
    s_add_u32 m0, s28, 1024
    s_nop 0
    buffer_load_dwordx4 v10, s[4:7], s29 offen lds
    s_add_u32 s29, s29, 24576
    v_mfma_f32_32x32x16_bf16 v[176:191], v[196:199], v[212:215], v[176:191]
    s_waitcnt lgkmcnt(0)
    ds_read_b128 v[208:211], v18 offset:22528
    ds_read_b128 v[212:215], v18 offset:55296
    v_mfma_f32_32x32x16_bf16 v[128:143], v[200:203], v[216:219], v[128:143]
    s_waitcnt vmcnt(4)
    ds_read_b64_tr_b16 v[192:193], v12 offset:4096
    ds_read_b64_tr_b16 v[194:195], v12 offset:4608
    ds_read_b64_tr_b16 v[196:197], v13 offset:4096
    ds_read_b64_tr_b16 v[198:199], v13 offset:4608
    v_mfma_f32_32x32x16_bf16 v[144:159], v[204:207], v[216:219], v[144:159]
    s_add_u32 m0, s28, 2048
    s_nop 0
    buffer_load_dwordx4 v10, s[4:7], s29 offen lds
    s_add_u32 s29, s29, 24576
    v_mfma_f32_32x32x16_bf16 v[160:175], v[200:203], v[220:223], v[160:175]
    s_add_u32 m0, s28, 3072
    s_nop 0
    buffer_load_dwordx4 v10, s[4:7], s29 offen lds
    s_add_u32 s29, s29, 24576
    v_mfma_f32_32x32x16_bf16 v[176:191], v[204:207], v[220:223], v[176:191]
    s_waitcnt lgkmcnt(0)
    ds_read_b128 v[216:219], v19 offset:23552
    ds_read_b128 v[220:223], v19 offset:56320
    v_mfma_f32_32x32x16_bf16 v[128:143], v[192:195], v[208:211], v[128:143]
    s_waitcnt vmcnt(4)
    ds_read_b64_tr_b16 v[200:201], v12 offset:6144
    ds_read_b64_tr_b16 v[202:203], v12 offset:6656
    ds_read_b64_tr_b16 v[204:205], v13 offset:6144
    ds_read_b64_tr_b16 v[206:207], v13 offset:6656
    v_mfma_f32_32x32x16_bf16 v[144:159], v[196:199], v[208:211], v[144:159]
    s_add_u32 m0, s28, 4096
    s_nop 0
    buffer_load_dwordx4 v10, s[4:7], s29 offen lds
    s_add_u32 s29, s29, 24576
    v_mfma_f32_32x32x16_bf16 v[160:175], v[192:195], v[212:215], v[160:175]
    s_add_u32 m0, s28, 5120
    s_nop 0
    buffer_load_dwordx4 v10, s[4:7], s29 offen lds
    s_add_u32 s29, s29, 24576
    v_mfma_f32_32x32x16_bf16 v[176:191], v[196:199], v[212:215], v[176:191]
    s_waitcnt lgkmcnt(0)
    ds_read_b128 v[208:211], v16 offset:24576
    ds_read_b128 v[212:215], v16 offset:57344
    v_mfma_f32_32x32x16_bf16 v[128:143], v[200:203], v[216:219], v[128:143]
    s_waitcnt vmcnt(4)
    ds_read_b64_tr_b16 v[192:193], v12 offset:0
    ds_read_b64_tr_b16 v[194:195], v12 offset:512
    ds_read_b64_tr_b16 v[196:197], v13 offset:0
    ds_read_b64_tr_b16 v[198:199], v13 offset:512
    v_mfma_f32_32x32x16_bf16 v[144:159], v[204:207], v[216:219], v[144:159]
    s_add_u32 m0, s28, 6144
    s_nop 0
    buffer_load_dwordx4 v10, s[4:7], s29 offen lds
    s_add_u32 s29, s29, 24576
    v_mfma_f32_32x32x16_bf16 v[160:175], v[200:203], v[220:223], v[160:175]
    s_add_u32 m0, s28, 7168
    s_nop 0
    buffer_load_dwordx4 v10, s[4:7], s29 offen lds
    s_add_u32 s29, s29, 24576
    v_mfma_f32_32x32x16_bf16 v[176:191], v[204:207], v[220:223], v[176:191]
    s_waitcnt lgkmcnt(0)
    ds_read_b128 v[216:219], v17 offset:25600
    ds_read_b128 v[220:223], v17 offset:58368
    v_mfma_f32_32x32x16_bf16 v[128:143], v[192:195], v[208:211], v[128:143]
    s_waitcnt vmcnt(4)
    ds_read_b64_tr_b16 v[200:201], v12 offset:2048
    ds_read_b64_tr_b16 v[202:203], v12 offset:2560
    ds_read_b64_tr_b16 v[204:205], v13 offset:2048
    ds_read_b64_tr_b16 v[206:207], v13 offset:2560
    v_mfma_f32_32x32x16_bf16 v[144:159], v[196:199], v[208:211], v[144:159]
    s_add_u32 m0, s28, 0
    s_nop 0
    buffer_load_dwordx4 v10, s[4:7], s29 offen lds
    s_add_u32 s29, s29, 24576
    v_mfma_f32_32x32x16_bf16 v[160:175], v[192:195], v[212:215], v[160:175]
    s_add_u32 m0, s28, 1024
    s_nop 0
    buffer_load_dwordx4 v10, s[4:7], s29 offen lds
    s_add_u32 s29, s29, 24576
    v_mfma_f32_32x32x16_bf16 v[176:191], v[196:199], v[212:215], v[176:191]
    s_waitcnt lgkmcnt(0)
    ds_read_b128 v[208:211], v18 offset:26624
    ds_read_b128 v[212:215], v18 offset:59392
    v_mfma_f32_32x32x16_bf16 v[128:143], v[200:203], v[216:219], v[128:143]
    s_waitcnt vmcnt(4)
    ds_read_b64_tr_b16 v[192:193], v12 offset:4096
    ds_read_b64_tr_b16 v[194:195], v12 offset:4608
    ds_read_b64_tr_b16 v[196:197], v13 offset:4096
    ds_read_b64_tr_b16 v[198:199], v13 offset:4608
    v_mfma_f32_32x32x16_bf16 v[144:159], v[204:207], v[216:219], v[144:159]
    s_add_u32 m0, s28, 2048
    s_nop 0
    buffer_load_dwordx4 v10, s[4:7], s29 offen lds
    s_add_u32 s29, s29, 24576
    v_mfma_f32_32x32x16_bf16 v[160:175], v[200:203], v[220:223], v[160:175]
    s_add_u32 m0, s28, 3072
    s_nop 0
    buffer_load_dwordx4 v10, s[4:7], s29 offen lds
    s_add_u32 s29, s29, 24576
    v_mfma_f32_32x32x16_bf16 v[176:191], v[204:207], v[220:223], v[176:191]
    s_waitcnt lgkmcnt(0)
    ds_read_b128 v[216:219], v19 offset:27648
    ds_read_b128 v[220:223], v19 offset:60416
    v_mfma_f32_32x32x16_bf16 v[128:143], v[192:195], v[208:211], v[128:143]
    s_waitcnt vmcnt(4)
    ds_read_b64_tr_b16 v[200:201], v12 offset:6144
    ds_read_b64_tr_b16 v[202:203], v12 offset:6656
    ds_read_b64_tr_b16 v[204:205], v13 offset:6144
    ds_read_b64_tr_b16 v[206:207], v13 offset:6656
    v_mfma_f32_32x32x16_bf16 v[144:159], v[196:199], v[208:211], v[144:159]
    s_add_u32 m0, s28, 4096
    s_nop 0
    buffer_load_dwordx4 v10, s[4:7], s29 offen lds
    s_add_u32 s29, s29, 24576
    v_mfma_f32_32x32x16_bf16 v[160:175], v[192:195], v[212:215], v[160:175]
    s_add_u32 m0, s28, 5120
    s_nop 0
    buffer_load_dwordx4 v10, s[4:7], s29 offen lds
    s_add_u32 s29, s29, 24576
    v_mfma_f32_32x32x16_bf16 v[176:191], v[196:199], v[212:215], v[176:191]
    s_waitcnt lgkmcnt(0)
    ds_read_b128 v[208:211], v16 offset:28672
    ds_read_b128 v[212:215], v16 offset:61440
    v_mfma_f32_32x32x16_bf16 v[128:143], v[200:203], v[216:219], v[128:143]
    s_waitcnt vmcnt(4)
    ds_read_b64_tr_b16 v[192:193], v12 offset:0
    ds_read_b64_tr_b16 v[194:195], v12 offset:512
    ds_read_b64_tr_b16 v[196:197], v13 offset:0
    ds_read_b64_tr_b16 v[198:199], v13 offset:512
    v_mfma_f32_32x32x16_bf16 v[144:159], v[204:207], v[216:219], v[144:159]
    s_add_u32 m0, s28, 6144
    s_nop 0
    buffer_load_dwordx4 v10, s[4:7], s29 offen lds
    s_add_u32 s29, s29, 24576
    v_mfma_f32_32x32x16_bf16 v[160:175], v[200:203], v[220:223], v[160:175]
    s_add_u32 m0, s28, 7168
    s_nop 0
    buffer_load_dwordx4 v10, s[4:7], s29 offen lds
    s_add_u32 s29, s29, 24576
    v_mfma_f32_32x32x16_bf16 v[176:191], v[204:207], v[220:223], v[176:191]
    s_waitcnt lgkmcnt(0)
    ds_read_b128 v[216:219], v17 offset:29696
    ds_read_b128 v[220:223], v17 offset:62464
    v_mfma_f32_32x32x16_bf16 v[128:143], v[192:195], v[208:211], v[128:143]
    s_waitcnt vmcnt(4)
    ds_read_b64_tr_b16 v[200:201], v12 offset:2048
    ds_read_b64_tr_b16 v[202:203], v12 offset:2560
    ds_read_b64_tr_b16 v[204:205], v13 offset:2048
    ds_read_b64_tr_b16 v[206:207], v13 offset:2560
    v_mfma_f32_32x32x16_bf16 v[144:159], v[196:199], v[208:211], v[144:159]
    v_mfma_f32_32x32x16_bf16 v[160:175], v[192:195], v[212:215], v[160:175]
    v_mfma_f32_32x32x16_bf16 v[176:191], v[196:199], v[212:215], v[176:191]
    s_waitcnt lgkmcnt(0)
    ds_read_b128 v[208:211], v18 offset:30720
    ds_read_b128 v[212:215], v18 offset:63488
    v_mfma_f32_32x32x16_bf16 v[128:143], v[200:203], v[216:219], v[128:143]
    s_waitcnt vmcnt(2)
    ds_read_b64_tr_b16 v[192:193], v12 offset:4096
    ds_read_b64_tr_b16 v[194:195], v12 offset:4608
    ds_read_b64_tr_b16 v[196:197], v13 offset:4096
    ds_read_b64_tr_b16 v[198:199], v13 offset:4608
    v_mfma_f32_32x32x16_bf16 v[144:159], v[204:207], v[216:219], v[144:159]
    v_mfma_f32_32x32x16_bf16 v[160:175], v[200:203], v[220:223], v[160:175]
    v_mfma_f32_32x32x16_bf16 v[176:191], v[204:207], v[220:223], v[176:191]
    s_waitcnt lgkmcnt(0)
    ds_read_b128 v[216:219], v19 offset:31744
    ds_read_b128 v[220:223], v19 offset:64512
    v_mfma_f32_32x32x16_bf16 v[128:143], v[192:195], v[208:211], v[128:143]
    s_waitcnt vmcnt(0)
    ds_read_b64_tr_b16 v[200:201], v12 offset:6144
    ds_read_b64_tr_b16 v[202:203], v12 offset:6656
    ds_read_b64_tr_b16 v[204:205], v13 offset:6144
    ds_read_b64_tr_b16 v[206:207], v13 offset:6656
    v_mfma_f32_32x32x16_bf16 v[144:159], v[196:199], v[208:211], v[144:159]
    v_mfma_f32_32x32x16_bf16 v[160:175], v[192:195], v[212:215], v[160:175]
    v_mfma_f32_32x32x16_bf16 v[176:191], v[196:199], v[212:215], v[176:191]
    v_mov_b32 v2, 159756
    v_mov_b32 v3, 1
    ds_write_b32 v2, v3
    s_waitcnt lgkmcnt(1)
    v_mfma_f32_32x32x16_bf16 v[128:143], v[200:203], v[216:219], v[128:143]
    v_mfma_f32_32x32x16_bf16 v[144:159], v[204:207], v[216:219], v[144:159]
    v_mfma_f32_32x32x16_bf16 v[160:175], v[200:203], v[220:223], v[160:175]
    v_mfma_f32_32x32x16_bf16 v[176:191], v[204:207], v[220:223], v[176:191]
    v_add_u32 v5, s28, v20
    s_lshl_b32 s46, s18, 18
    s_lshl_b32 s47, s17, 11
    s_add_u32 s46, s46, s47
    s_add_u32 s46, s46, 4194304
    s_nop 3
    v_cvt_pk_bf16_f32 v224, v128, v129
    v_cvt_pk_bf16_f32 v225, v130, v131
    v_cvt_pk_bf16_f32 v226, v132, v133
    v_cvt_pk_bf16_f32 v227, v134, v135
    buffer_store_dwordx4 v[224:227], v20, s[40:43], s46 offen offset:0 sc1
    v_cvt_pk_bf16_f32 v228, v160, v161
    v_cvt_pk_bf16_f32 v229, v162, v163
    v_cvt_pk_bf16_f32 v230, v164, v165
    v_cvt_pk_bf16_f32 v231, v166, v167
    buffer_store_dwordx4 v[228:231], v20, s[40:43], s46 offen offset:1024 sc1
    s_add_u32 s46, s46, 65536
    v_cvt_pk_bf16_f32 v232, v136, v137
    v_cvt_pk_bf16_f32 v233, v138, v139
    v_cvt_pk_bf16_f32 v234, v140, v141
    v_cvt_pk_bf16_f32 v235, v142, v143
    buffer_store_dwordx4 v[232:235], v20, s[40:43], s46 offen offset:0 sc1
    v_cvt_pk_bf16_f32 v236, v168, v169
    v_cvt_pk_bf16_f32 v237, v170, v171
    v_cvt_pk_bf16_f32 v238, v172, v173
    v_cvt_pk_bf16_f32 v239, v174, v175
    buffer_store_dwordx4 v[236:239], v20, s[40:43], s46 offen offset:1024 sc1
    s_add_u32 s46, s46, 65536
    v_cvt_pk_bf16_f32 v240, v144, v145
    v_cvt_pk_bf16_f32 v241, v146, v147
    v_cvt_pk_bf16_f32 v242, v148, v149
    v_cvt_pk_bf16_f32 v243, v150, v151
    buffer_store_dwordx4 v[240:243], v20, s[40:43], s46 offen offset:0 sc1
    v_cvt_pk_bf16_f32 v244, v176, v177
    v_cvt_pk_bf16_f32 v245, v178, v179
    v_cvt_pk_bf16_f32 v246, v180, v181
    v_cvt_pk_bf16_f32 v247, v182, v183
    buffer_store_dwordx4 v[244:247], v20, s[40:43], s46 offen offset:1024 sc1
    s_add_u32 s46, s46, 65536
    v_cvt_pk_bf16_f32 v248, v152, v153
    v_cvt_pk_bf16_f32 v249, v154, v155
    v_cvt_pk_bf16_f32 v250, v156, v157
    v_cvt_pk_bf16_f32 v251, v158, v159
    buffer_store_dwordx4 v[248:251], v20, s[40:43], s46 offen offset:0 sc1
    v_cvt_pk_bf16_f32 v252, v184, v185
    v_cvt_pk_bf16_f32 v253, v186, v187
    v_cvt_pk_bf16_f32 v254, v188, v189
    v_cvt_pk_bf16_f32 v255, v190, v191
    buffer_store_dwordx4 v[252:255], v20, s[40:43], s46 offen offset:1024 sc1
    s_add_u32 s46, s46, 65536
    ds_write_b128 v5, v[224:227] offset:0
    ds_write_b128 v5, v[228:231] offset:1024
    ds_write_b128 v5, v[232:235] offset:2048
    ds_write_b128 v5, v[236:239] offset:3072
    ds_write_b128 v5, v[240:243] offset:4096
    ds_write_b128 v5, v[244:247] offset:5120
    ds_write_b128 v5, v[248:251] offset:6144
    ds_write_b128 v5, v[252:255] offset:7168
    s_waitcnt lgkmcnt(0)
    s_mov_b64 exec, 1
    v_mov_b32 v2, 159748
    v_mov_b32 v3, 1
    ds_add_u32 v2, v3
    s_mov_b64 exec, -1
    s_mov_b64 exec, 1
    v_mov_b32 v2, 159760
    v_mov_b32 v3, 1
    ds_add_u32 v2, v3
    s_mov_b64 exec, -1
    v_mov_b32 v2, 159800
Y_K_NC:
    ds_read_b64 v[4:5], v2
    s_waitcnt lgkmcnt(0)
    v_readfirstlane_b32 s2, v4
    v_readfirstlane_b32 s3, v5
    s_cmp_lg_u32 s2, 0
    s_cbranch_scc1 Y_K_NC_OK
    s_sleep 1
    s_branch Y_K_NC
Y_K_NC_OK:
    s_waitcnt vmcnt(0)
    s_mov_b64 exec, 1
    v_mov_b32 v2, 159744
    v_mov_b32 v3, 1
    ds_add_rtn_u32 v4, v2, v3
    s_waitcnt lgkmcnt(0)
    v_readfirstlane_b32 s46, v4
    s_nop 0
    s_cmp_eq_u32 s46, 1
    s_cbranch_scc0 Y_K_PB_NOPUB
    v_mov_b32 v4, s2
    v_mov_b32 v5, s3
    buffer_store_dwordx2 v[4:5], v8, s[40:43], s99 offen sc1
Y_K_PB_NOPUB:
    s_mov_b64 exec, -1
    s_branch Y_AWAIT
Y_V:
    s_setprio 3
    s_waitcnt vmcnt(6)
    ds_read_b64_tr_b16 v[192:193], v12 offset:0
    ds_read_b64_tr_b16 v[194:195], v12 offset:512
    ds_read_b64_tr_b16 v[196:197], v13 offset:0
    ds_read_b64_tr_b16 v[198:199], v13 offset:512
    ds_read_b128 v[208:211], v16 offset:0
    ds_read_b128 v[212:215], v16 offset:32768
    s_waitcnt lgkmcnt(0)
    ds_read_b128 v[216:219], v17 offset:1024
    ds_read_b128 v[220:223], v17 offset:33792
    v_mfma_f32_32x32x16_bf16 v[128:143], v[208:211], v[192:195], 0
    s_waitcnt vmcnt(4)
    ds_read_b64_tr_b16 v[200:201], v12 offset:2048
    ds_read_b64_tr_b16 v[202:203], v12 offset:2560
    ds_read_b64_tr_b16 v[204:205], v13 offset:2048
    ds_read_b64_tr_b16 v[206:207], v13 offset:2560
    v_mfma_f32_32x32x16_bf16 v[144:159], v[208:211], v[196:199], 0
    s_add_u32 m0, s28, 0
    s_nop 0
    buffer_load_dwordx4 v10, s[4:7], s29 offen lds
    s_add_u32 s29, s29, 24576
    v_mfma_f32_32x32x16_bf16 v[160:175], v[212:215], v[192:195], 0
    s_add_u32 m0, s28, 1024
    s_nop 0
    buffer_load_dwordx4 v10, s[4:7], s29 offen lds
    s_add_u32 s29, s29, 24576
    v_mfma_f32_32x32x16_bf16 v[176:191], v[212:215], v[196:199], 0
    s_waitcnt lgkmcnt(0)
    ds_read_b128 v[208:211], v18 offset:2048
    ds_read_b128 v[212:215], v18 offset:34816
    v_mfma_f32_32x32x16_bf16 v[128:143], v[216:219], v[200:203], v[128:143]
    s_waitcnt vmcnt(4)
    ds_read_b64_tr_b16 v[192:193], v12 offset:4096
    ds_read_b64_tr_b16 v[194:195], v12 offset:4608
    ds_read_b64_tr_b16 v[196:197], v13 offset:4096
    ds_read_b64_tr_b16 v[198:199], v13 offset:4608
    v_mfma_f32_32x32x16_bf16 v[144:159], v[216:219], v[204:207], v[144:159]
    s_add_u32 m0, s28, 2048
    s_nop 0
    buffer_load_dwordx4 v10, s[4:7], s29 offen lds
    s_add_u32 s29, s29, 24576
    v_mfma_f32_32x32x16_bf16 v[160:175], v[220:223], v[200:203], v[160:175]
    s_add_u32 m0, s28, 3072
    s_nop 0
    buffer_load_dwordx4 v10, s[4:7], s29 offen lds
    s_add_u32 s29, s29, 24576
    v_mfma_f32_32x32x16_bf16 v[176:191], v[220:223], v[204:207], v[176:191]
    s_waitcnt lgkmcnt(0)
    ds_read_b128 v[216:219], v19 offset:3072
    ds_read_b128 v[220:223], v19 offset:35840
    v_mfma_f32_32x32x16_bf16 v[128:143], v[208:211], v[192:195], v[128:143]
    s_waitcnt vmcnt(4)
    ds_read_b64_tr_b16 v[200:201], v12 offset:6144
    ds_read_b64_tr_b16 v[202:203], v12 offset:6656
    ds_read_b64_tr_b16 v[204:205], v13 offset:6144
    ds_read_b64_tr_b16 v[206:207], v13 offset:6656
    v_mfma_f32_32x32x16_bf16 v[144:159], v[208:211], v[196:199], v[144:159]
    s_add_u32 m0, s28, 4096
    s_nop 0
    buffer_load_dwordx4 v10, s[4:7], s29 offen lds
    s_add_u32 s29, s29, 24576
    v_mfma_f32_32x32x16_bf16 v[160:175], v[212:215], v[192:195], v[160:175]
    s_add_u32 m0, s28, 5120
    s_nop 0
    buffer_load_dwordx4 v10, s[4:7], s29 offen lds
    s_add_u32 s29, s29, 24576
    v_mfma_f32_32x32x16_bf16 v[176:191], v[212:215], v[196:199], v[176:191]
    s_waitcnt lgkmcnt(0)
    ds_read_b128 v[208:211], v16 offset:4096
    ds_read_b128 v[212:215], v16 offset:36864
    v_mfma_f32_32x32x16_bf16 v[128:143], v[216:219], v[200:203], v[128:143]
    s_waitcnt vmcnt(4)
    ds_read_b64_tr_b16 v[192:193], v12 offset:0
    ds_read_b64_tr_b16 v[194:195], v12 offset:512
    ds_read_b64_tr_b16 v[196:197], v13 offset:0
    ds_read_b64_tr_b16 v[198:199], v13 offset:512
    v_mfma_f32_32x32x16_bf16 v[144:159], v[216:219], v[204:207], v[144:159]
    s_add_u32 m0, s28, 6144
    s_nop 0
    buffer_load_dwordx4 v10, s[4:7], s29 offen lds
    s_add_u32 s29, s29, 24576
    v_mfma_f32_32x32x16_bf16 v[160:175], v[220:223], v[200:203], v[160:175]
    s_add_u32 m0, s28, 7168
    s_nop 0
    buffer_load_dwordx4 v10, s[4:7], s29 offen lds
    s_add_u32 s29, s29, 24576
    v_mfma_f32_32x32x16_bf16 v[176:191], v[220:223], v[204:207], v[176:191]
    s_waitcnt lgkmcnt(0)
    ds_read_b128 v[216:219], v17 offset:5120
    ds_read_b128 v[220:223], v17 offset:37888
    v_mfma_f32_32x32x16_bf16 v[128:143], v[208:211], v[192:195], v[128:143]
    s_waitcnt vmcnt(4)
    ds_read_b64_tr_b16 v[200:201], v12 offset:2048
    ds_read_b64_tr_b16 v[202:203], v12 offset:2560
    ds_read_b64_tr_b16 v[204:205], v13 offset:2048
    ds_read_b64_tr_b16 v[206:207], v13 offset:2560
    v_mfma_f32_32x32x16_bf16 v[144:159], v[208:211], v[196:199], v[144:159]
    s_add_u32 m0, s28, 0
    s_nop 0
    buffer_load_dwordx4 v10, s[4:7], s29 offen lds
    s_add_u32 s29, s29, 24576
    v_mfma_f32_32x32x16_bf16 v[160:175], v[212:215], v[192:195], v[160:175]
    s_add_u32 m0, s28, 1024
    s_nop 0
    buffer_load_dwordx4 v10, s[4:7], s29 offen lds
    s_add_u32 s29, s29, 24576
    v_mfma_f32_32x32x16_bf16 v[176:191], v[212:215], v[196:199], v[176:191]
    s_waitcnt lgkmcnt(0)
    ds_read_b128 v[208:211], v18 offset:6144
    ds_read_b128 v[212:215], v18 offset:38912
    v_mfma_f32_32x32x16_bf16 v[128:143], v[216:219], v[200:203], v[128:143]
    s_waitcnt vmcnt(4)
    ds_read_b64_tr_b16 v[192:193], v12 offset:4096
    ds_read_b64_tr_b16 v[194:195], v12 offset:4608
    ds_read_b64_tr_b16 v[196:197], v13 offset:4096
    ds_read_b64_tr_b16 v[198:199], v13 offset:4608
    v_mfma_f32_32x32x16_bf16 v[144:159], v[216:219], v[204:207], v[144:159]
    s_add_u32 m0, s28, 2048
    s_nop 0
    buffer_load_dwordx4 v10, s[4:7], s29 offen lds
    s_add_u32 s29, s29, 24576
    v_mfma_f32_32x32x16_bf16 v[160:175], v[220:223], v[200:203], v[160:175]
    s_add_u32 m0, s28, 3072
    s_nop 0
    buffer_load_dwordx4 v10, s[4:7], s29 offen lds
    s_add_u32 s29, s29, 24576
    v_mfma_f32_32x32x16_bf16 v[176:191], v[220:223], v[204:207], v[176:191]
    s_waitcnt lgkmcnt(0)
    ds_read_b128 v[216:219], v19 offset:7168
    ds_read_b128 v[220:223], v19 offset:39936
    v_mfma_f32_32x32x16_bf16 v[128:143], v[208:211], v[192:195], v[128:143]
    s_waitcnt vmcnt(4)
    ds_read_b64_tr_b16 v[200:201], v12 offset:6144
    ds_read_b64_tr_b16 v[202:203], v12 offset:6656
    ds_read_b64_tr_b16 v[204:205], v13 offset:6144
    ds_read_b64_tr_b16 v[206:207], v13 offset:6656
    v_mfma_f32_32x32x16_bf16 v[144:159], v[208:211], v[196:199], v[144:159]
    s_add_u32 m0, s28, 4096
    s_nop 0
    buffer_load_dwordx4 v10, s[4:7], s29 offen lds
    s_add_u32 s29, s29, 24576
    v_mfma_f32_32x32x16_bf16 v[160:175], v[212:215], v[192:195], v[160:175]
    s_add_u32 m0, s28, 5120
    s_nop 0
    buffer_load_dwordx4 v10, s[4:7], s29 offen lds
    s_add_u32 s29, s29, 24576
    v_mfma_f32_32x32x16_bf16 v[176:191], v[212:215], v[196:199], v[176:191]
    s_waitcnt lgkmcnt(0)
    ds_read_b128 v[208:211], v16 offset:8192
    ds_read_b128 v[212:215], v16 offset:40960
    v_mfma_f32_32x32x16_bf16 v[128:143], v[216:219], v[200:203], v[128:143]
    s_waitcnt vmcnt(4)
    ds_read_b64_tr_b16 v[192:193], v12 offset:0
    ds_read_b64_tr_b16 v[194:195], v12 offset:512
    ds_read_b64_tr_b16 v[196:197], v13 offset:0
    ds_read_b64_tr_b16 v[198:199], v13 offset:512
    v_mfma_f32_32x32x16_bf16 v[144:159], v[216:219], v[204:207], v[144:159]
    s_add_u32 m0, s28, 6144
    s_nop 0
    buffer_load_dwordx4 v10, s[4:7], s29 offen lds
    s_add_u32 s29, s29, 24576
    v_mfma_f32_32x32x16_bf16 v[160:175], v[220:223], v[200:203], v[160:175]
    s_add_u32 m0, s28, 7168
    s_nop 0
    buffer_load_dwordx4 v10, s[4:7], s29 offen lds
    s_add_u32 s29, s29, 24576
    v_mfma_f32_32x32x16_bf16 v[176:191], v[220:223], v[204:207], v[176:191]
    s_waitcnt lgkmcnt(0)
    ds_read_b128 v[216:219], v17 offset:9216
    ds_read_b128 v[220:223], v17 offset:41984
    v_mfma_f32_32x32x16_bf16 v[128:143], v[208:211], v[192:195], v[128:143]
    s_waitcnt vmcnt(4)
    ds_read_b64_tr_b16 v[200:201], v12 offset:2048
    ds_read_b64_tr_b16 v[202:203], v12 offset:2560
    ds_read_b64_tr_b16 v[204:205], v13 offset:2048
    ds_read_b64_tr_b16 v[206:207], v13 offset:2560
    v_mfma_f32_32x32x16_bf16 v[144:159], v[208:211], v[196:199], v[144:159]
    s_add_u32 m0, s28, 0
    s_nop 0
    buffer_load_dwordx4 v10, s[4:7], s29 offen lds
    s_add_u32 s29, s29, 24576
    v_mfma_f32_32x32x16_bf16 v[160:175], v[212:215], v[192:195], v[160:175]
    s_add_u32 m0, s28, 1024
    s_nop 0
    buffer_load_dwordx4 v10, s[4:7], s29 offen lds
    s_add_u32 s29, s29, 24576
    v_mfma_f32_32x32x16_bf16 v[176:191], v[212:215], v[196:199], v[176:191]
    s_waitcnt lgkmcnt(0)
    ds_read_b128 v[208:211], v18 offset:10240
    ds_read_b128 v[212:215], v18 offset:43008
    v_mfma_f32_32x32x16_bf16 v[128:143], v[216:219], v[200:203], v[128:143]
    s_waitcnt vmcnt(4)
    ds_read_b64_tr_b16 v[192:193], v12 offset:4096
    ds_read_b64_tr_b16 v[194:195], v12 offset:4608
    ds_read_b64_tr_b16 v[196:197], v13 offset:4096
    ds_read_b64_tr_b16 v[198:199], v13 offset:4608
    v_mfma_f32_32x32x16_bf16 v[144:159], v[216:219], v[204:207], v[144:159]
    s_add_u32 m0, s28, 2048
    s_nop 0
    buffer_load_dwordx4 v10, s[4:7], s29 offen lds
    s_add_u32 s29, s29, 24576
    v_mfma_f32_32x32x16_bf16 v[160:175], v[220:223], v[200:203], v[160:175]
    s_add_u32 m0, s28, 3072
    s_nop 0
    buffer_load_dwordx4 v10, s[4:7], s29 offen lds
    s_add_u32 s29, s29, 24576
    v_mfma_f32_32x32x16_bf16 v[176:191], v[220:223], v[204:207], v[176:191]
    s_waitcnt lgkmcnt(0)
    ds_read_b128 v[216:219], v19 offset:11264
    ds_read_b128 v[220:223], v19 offset:44032
    v_mfma_f32_32x32x16_bf16 v[128:143], v[208:211], v[192:195], v[128:143]
    s_waitcnt vmcnt(4)
    ds_read_b64_tr_b16 v[200:201], v12 offset:6144
    ds_read_b64_tr_b16 v[202:203], v12 offset:6656
    ds_read_b64_tr_b16 v[204:205], v13 offset:6144
    ds_read_b64_tr_b16 v[206:207], v13 offset:6656
    v_mfma_f32_32x32x16_bf16 v[144:159], v[208:211], v[196:199], v[144:159]
    s_add_u32 m0, s28, 4096
    s_nop 0
    buffer_load_dwordx4 v10, s[4:7], s29 offen lds
    s_add_u32 s29, s29, 24576
    v_mfma_f32_32x32x16_bf16 v[160:175], v[212:215], v[192:195], v[160:175]
    s_add_u32 m0, s28, 5120
    s_nop 0
    buffer_load_dwordx4 v10, s[4:7], s29 offen lds
    s_add_u32 s29, s29, 24576
    v_mfma_f32_32x32x16_bf16 v[176:191], v[212:215], v[196:199], v[176:191]
    s_waitcnt lgkmcnt(0)
    ds_read_b128 v[208:211], v16 offset:12288
    ds_read_b128 v[212:215], v16 offset:45056
    v_mfma_f32_32x32x16_bf16 v[128:143], v[216:219], v[200:203], v[128:143]
    s_waitcnt vmcnt(4)
    ds_read_b64_tr_b16 v[192:193], v12 offset:0
    ds_read_b64_tr_b16 v[194:195], v12 offset:512
    ds_read_b64_tr_b16 v[196:197], v13 offset:0
    ds_read_b64_tr_b16 v[198:199], v13 offset:512
    v_mfma_f32_32x32x16_bf16 v[144:159], v[216:219], v[204:207], v[144:159]
    s_add_u32 m0, s28, 6144
    s_nop 0
    buffer_load_dwordx4 v10, s[4:7], s29 offen lds
    s_add_u32 s29, s29, 24576
    v_mfma_f32_32x32x16_bf16 v[160:175], v[220:223], v[200:203], v[160:175]
    s_add_u32 m0, s28, 7168
    s_nop 0
    buffer_load_dwordx4 v10, s[4:7], s29 offen lds
    s_add_u32 s29, s29, 24576
    v_mfma_f32_32x32x16_bf16 v[176:191], v[220:223], v[204:207], v[176:191]
    s_waitcnt lgkmcnt(0)
    ds_read_b128 v[216:219], v17 offset:13312
    ds_read_b128 v[220:223], v17 offset:46080
    v_mfma_f32_32x32x16_bf16 v[128:143], v[208:211], v[192:195], v[128:143]
    s_waitcnt vmcnt(4)
    ds_read_b64_tr_b16 v[200:201], v12 offset:2048
    ds_read_b64_tr_b16 v[202:203], v12 offset:2560
    ds_read_b64_tr_b16 v[204:205], v13 offset:2048
    ds_read_b64_tr_b16 v[206:207], v13 offset:2560
    v_mfma_f32_32x32x16_bf16 v[144:159], v[208:211], v[196:199], v[144:159]
    s_add_u32 m0, s28, 0
    s_nop 0
    buffer_load_dwordx4 v10, s[4:7], s29 offen lds
    s_add_u32 s29, s29, 24576
    v_mfma_f32_32x32x16_bf16 v[160:175], v[212:215], v[192:195], v[160:175]
    s_add_u32 m0, s28, 1024
    s_nop 0
    buffer_load_dwordx4 v10, s[4:7], s29 offen lds
    s_add_u32 s29, s29, 24576
    v_mfma_f32_32x32x16_bf16 v[176:191], v[212:215], v[196:199], v[176:191]
    s_waitcnt lgkmcnt(0)
    ds_read_b128 v[208:211], v18 offset:14336
    ds_read_b128 v[212:215], v18 offset:47104
    v_mfma_f32_32x32x16_bf16 v[128:143], v[216:219], v[200:203], v[128:143]
    s_waitcnt vmcnt(4)
    ds_read_b64_tr_b16 v[192:193], v12 offset:4096
    ds_read_b64_tr_b16 v[194:195], v12 offset:4608
    ds_read_b64_tr_b16 v[196:197], v13 offset:4096
    ds_read_b64_tr_b16 v[198:199], v13 offset:4608
    v_mfma_f32_32x32x16_bf16 v[144:159], v[216:219], v[204:207], v[144:159]
    s_add_u32 m0, s28, 2048
    s_nop 0
    buffer_load_dwordx4 v10, s[4:7], s29 offen lds
    s_add_u32 s29, s29, 24576
    v_mfma_f32_32x32x16_bf16 v[160:175], v[220:223], v[200:203], v[160:175]
    s_add_u32 m0, s28, 3072
    s_nop 0
    buffer_load_dwordx4 v10, s[4:7], s29 offen lds
    s_add_u32 s29, s29, 24576
    v_mfma_f32_32x32x16_bf16 v[176:191], v[220:223], v[204:207], v[176:191]
    s_waitcnt lgkmcnt(0)
    ds_read_b128 v[216:219], v19 offset:15360
    ds_read_b128 v[220:223], v19 offset:48128
    v_mfma_f32_32x32x16_bf16 v[128:143], v[208:211], v[192:195], v[128:143]
    s_waitcnt vmcnt(4)
    ds_read_b64_tr_b16 v[200:201], v12 offset:6144
    ds_read_b64_tr_b16 v[202:203], v12 offset:6656
    ds_read_b64_tr_b16 v[204:205], v13 offset:6144
    ds_read_b64_tr_b16 v[206:207], v13 offset:6656
    v_mfma_f32_32x32x16_bf16 v[144:159], v[208:211], v[196:199], v[144:159]
    s_add_u32 m0, s28, 4096
    s_nop 0
    buffer_load_dwordx4 v10, s[4:7], s29 offen lds
    s_add_u32 s29, s29, 24576
    v_mfma_f32_32x32x16_bf16 v[160:175], v[212:215], v[192:195], v[160:175]
    s_add_u32 m0, s28, 5120
    s_nop 0
    buffer_load_dwordx4 v10, s[4:7], s29 offen lds
    s_add_u32 s29, s29, 24576
    v_mfma_f32_32x32x16_bf16 v[176:191], v[212:215], v[196:199], v[176:191]
    s_waitcnt lgkmcnt(0)
    ds_read_b128 v[208:211], v16 offset:16384
    ds_read_b128 v[212:215], v16 offset:49152
    v_mfma_f32_32x32x16_bf16 v[128:143], v[216:219], v[200:203], v[128:143]
    s_waitcnt vmcnt(4)
    ds_read_b64_tr_b16 v[192:193], v12 offset:0
    ds_read_b64_tr_b16 v[194:195], v12 offset:512
    ds_read_b64_tr_b16 v[196:197], v13 offset:0
    ds_read_b64_tr_b16 v[198:199], v13 offset:512
    v_mfma_f32_32x32x16_bf16 v[144:159], v[216:219], v[204:207], v[144:159]
    s_add_u32 m0, s28, 6144
    s_nop 0
    buffer_load_dwordx4 v10, s[4:7], s29 offen lds
    s_add_u32 s29, s29, 24576
    v_mfma_f32_32x32x16_bf16 v[160:175], v[220:223], v[200:203], v[160:175]
    s_add_u32 m0, s28, 7168
    s_nop 0
    buffer_load_dwordx4 v10, s[4:7], s29 offen lds
    s_add_u32 s29, s29, 24576
    v_mfma_f32_32x32x16_bf16 v[176:191], v[220:223], v[204:207], v[176:191]
    s_waitcnt lgkmcnt(0)
    ds_read_b128 v[216:219], v17 offset:17408
    ds_read_b128 v[220:223], v17 offset:50176
    v_mfma_f32_32x32x16_bf16 v[128:143], v[208:211], v[192:195], v[128:143]
    s_waitcnt vmcnt(4)
    ds_read_b64_tr_b16 v[200:201], v12 offset:2048
    ds_read_b64_tr_b16 v[202:203], v12 offset:2560
    ds_read_b64_tr_b16 v[204:205], v13 offset:2048
    ds_read_b64_tr_b16 v[206:207], v13 offset:2560
    v_mfma_f32_32x32x16_bf16 v[144:159], v[208:211], v[196:199], v[144:159]
    s_add_u32 m0, s28, 0
    s_nop 0
    buffer_load_dwordx4 v10, s[4:7], s29 offen lds
    s_add_u32 s29, s29, 24576
    v_mfma_f32_32x32x16_bf16 v[160:175], v[212:215], v[192:195], v[160:175]
    s_add_u32 m0, s28, 1024
    s_nop 0
    buffer_load_dwordx4 v10, s[4:7], s29 offen lds
    s_add_u32 s29, s29, 24576
    v_mfma_f32_32x32x16_bf16 v[176:191], v[212:215], v[196:199], v[176:191]
    s_waitcnt lgkmcnt(0)
    ds_read_b128 v[208:211], v18 offset:18432
    ds_read_b128 v[212:215], v18 offset:51200
    v_mfma_f32_32x32x16_bf16 v[128:143], v[216:219], v[200:203], v[128:143]
    s_waitcnt vmcnt(4)
    ds_read_b64_tr_b16 v[192:193], v12 offset:4096
    ds_read_b64_tr_b16 v[194:195], v12 offset:4608
    ds_read_b64_tr_b16 v[196:197], v13 offset:4096
    ds_read_b64_tr_b16 v[198:199], v13 offset:4608
    v_mfma_f32_32x32x16_bf16 v[144:159], v[216:219], v[204:207], v[144:159]
    s_add_u32 m0, s28, 2048
    s_nop 0
    buffer_load_dwordx4 v10, s[4:7], s29 offen lds
    s_add_u32 s29, s29, 24576
    v_mfma_f32_32x32x16_bf16 v[160:175], v[220:223], v[200:203], v[160:175]
    s_add_u32 m0, s28, 3072
    s_nop 0
    buffer_load_dwordx4 v10, s[4:7], s29 offen lds
    s_add_u32 s29, s29, 24576
    v_mfma_f32_32x32x16_bf16 v[176:191], v[220:223], v[204:207], v[176:191]
    s_waitcnt lgkmcnt(0)
    ds_read_b128 v[216:219], v19 offset:19456
    ds_read_b128 v[220:223], v19 offset:52224
    v_mfma_f32_32x32x16_bf16 v[128:143], v[208:211], v[192:195], v[128:143]
    s_waitcnt vmcnt(4)
    ds_read_b64_tr_b16 v[200:201], v12 offset:6144
    ds_read_b64_tr_b16 v[202:203], v12 offset:6656
    ds_read_b64_tr_b16 v[204:205], v13 offset:6144
    ds_read_b64_tr_b16 v[206:207], v13 offset:6656
    v_mfma_f32_32x32x16_bf16 v[144:159], v[208:211], v[196:199], v[144:159]
    s_add_u32 m0, s28, 4096
    s_nop 0
    buffer_load_dwordx4 v10, s[4:7], s29 offen lds
    s_add_u32 s29, s29, 24576
    v_mfma_f32_32x32x16_bf16 v[160:175], v[212:215], v[192:195], v[160:175]
    s_add_u32 m0, s28, 5120
    s_nop 0
    buffer_load_dwordx4 v10, s[4:7], s29 offen lds
    s_add_u32 s29, s29, 24576
    v_mfma_f32_32x32x16_bf16 v[176:191], v[212:215], v[196:199], v[176:191]
    s_waitcnt lgkmcnt(0)
    ds_read_b128 v[208:211], v16 offset:20480
    ds_read_b128 v[212:215], v16 offset:53248
    v_mfma_f32_32x32x16_bf16 v[128:143], v[216:219], v[200:203], v[128:143]
    s_waitcnt vmcnt(4)
    ds_read_b64_tr_b16 v[192:193], v12 offset:0
    ds_read_b64_tr_b16 v[194:195], v12 offset:512
    ds_read_b64_tr_b16 v[196:197], v13 offset:0
    ds_read_b64_tr_b16 v[198:199], v13 offset:512
    v_mfma_f32_32x32x16_bf16 v[144:159], v[216:219], v[204:207], v[144:159]
    s_add_u32 m0, s28, 6144
    s_nop 0
    buffer_load_dwordx4 v10, s[4:7], s29 offen lds
    s_add_u32 s29, s29, 24576
    v_mfma_f32_32x32x16_bf16 v[160:175], v[220:223], v[200:203], v[160:175]
    s_add_u32 m0, s28, 7168
    s_nop 0
    buffer_load_dwordx4 v10, s[4:7], s29 offen lds
    s_add_u32 s29, s29, 24576
    v_mfma_f32_32x32x16_bf16 v[176:191], v[220:223], v[204:207], v[176:191]
    s_waitcnt lgkmcnt(0)
    ds_read_b128 v[216:219], v17 offset:21504
    ds_read_b128 v[220:223], v17 offset:54272
    v_mfma_f32_32x32x16_bf16 v[128:143], v[208:211], v[192:195], v[128:143]
    s_waitcnt vmcnt(4)
    ds_read_b64_tr_b16 v[200:201], v12 offset:2048
    ds_read_b64_tr_b16 v[202:203], v12 offset:2560
    ds_read_b64_tr_b16 v[204:205], v13 offset:2048
    ds_read_b64_tr_b16 v[206:207], v13 offset:2560
    v_mfma_f32_32x32x16_bf16 v[144:159], v[208:211], v[196:199], v[144:159]
    s_add_u32 m0, s28, 0
    s_nop 0
    buffer_load_dwordx4 v10, s[4:7], s29 offen lds
    s_add_u32 s29, s29, 24576
    v_mfma_f32_32x32x16_bf16 v[160:175], v[212:215], v[192:195], v[160:175]
    s_add_u32 m0, s28, 1024
    s_nop 0
    buffer_load_dwordx4 v10, s[4:7], s29 offen lds
    s_add_u32 s29, s29, 24576
    v_mfma_f32_32x32x16_bf16 v[176:191], v[212:215], v[196:199], v[176:191]
    s_waitcnt lgkmcnt(0)
    ds_read_b128 v[208:211], v18 offset:22528
    ds_read_b128 v[212:215], v18 offset:55296
    v_mfma_f32_32x32x16_bf16 v[128:143], v[216:219], v[200:203], v[128:143]
    s_waitcnt vmcnt(4)
    ds_read_b64_tr_b16 v[192:193], v12 offset:4096
    ds_read_b64_tr_b16 v[194:195], v12 offset:4608
    ds_read_b64_tr_b16 v[196:197], v13 offset:4096
    ds_read_b64_tr_b16 v[198:199], v13 offset:4608
    v_mfma_f32_32x32x16_bf16 v[144:159], v[216:219], v[204:207], v[144:159]
    s_add_u32 m0, s28, 2048
    s_nop 0
    buffer_load_dwordx4 v10, s[4:7], s29 offen lds
    s_add_u32 s29, s29, 24576
    v_mfma_f32_32x32x16_bf16 v[160:175], v[220:223], v[200:203], v[160:175]
    s_add_u32 m0, s28, 3072
    s_nop 0
    buffer_load_dwordx4 v10, s[4:7], s29 offen lds
    s_add_u32 s29, s29, 24576
    v_mfma_f32_32x32x16_bf16 v[176:191], v[220:223], v[204:207], v[176:191]
    s_waitcnt lgkmcnt(0)
    ds_read_b128 v[216:219], v19 offset:23552
    ds_read_b128 v[220:223], v19 offset:56320
    v_mfma_f32_32x32x16_bf16 v[128:143], v[208:211], v[192:195], v[128:143]
    s_waitcnt vmcnt(4)
    ds_read_b64_tr_b16 v[200:201], v12 offset:6144
    ds_read_b64_tr_b16 v[202:203], v12 offset:6656
    ds_read_b64_tr_b16 v[204:205], v13 offset:6144
    ds_read_b64_tr_b16 v[206:207], v13 offset:6656
    v_mfma_f32_32x32x16_bf16 v[144:159], v[208:211], v[196:199], v[144:159]
    s_add_u32 m0, s28, 4096
    s_nop 0
    buffer_load_dwordx4 v10, s[4:7], s29 offen lds
    s_add_u32 s29, s29, 24576
    v_mfma_f32_32x32x16_bf16 v[160:175], v[212:215], v[192:195], v[160:175]
    s_add_u32 m0, s28, 5120
    s_nop 0
    buffer_load_dwordx4 v10, s[4:7], s29 offen lds
    s_add_u32 s29, s29, 24576
    v_mfma_f32_32x32x16_bf16 v[176:191], v[212:215], v[196:199], v[176:191]
    s_waitcnt lgkmcnt(0)
    ds_read_b128 v[208:211], v16 offset:24576
    ds_read_b128 v[212:215], v16 offset:57344
    v_mfma_f32_32x32x16_bf16 v[128:143], v[216:219], v[200:203], v[128:143]
    s_waitcnt vmcnt(4)
    ds_read_b64_tr_b16 v[192:193], v12 offset:0
    ds_read_b64_tr_b16 v[194:195], v12 offset:512
    ds_read_b64_tr_b16 v[196:197], v13 offset:0
    ds_read_b64_tr_b16 v[198:199], v13 offset:512
    v_mfma_f32_32x32x16_bf16 v[144:159], v[216:219], v[204:207], v[144:159]
    s_add_u32 m0, s28, 6144
    s_nop 0
    buffer_load_dwordx4 v10, s[4:7], s29 offen lds
    s_add_u32 s29, s29, 24576
    v_mfma_f32_32x32x16_bf16 v[160:175], v[220:223], v[200:203], v[160:175]
    s_add_u32 m0, s28, 7168
    s_nop 0
    buffer_load_dwordx4 v10, s[4:7], s29 offen lds
    s_add_u32 s29, s29, 24576
    v_mfma_f32_32x32x16_bf16 v[176:191], v[220:223], v[204:207], v[176:191]
    s_waitcnt lgkmcnt(0)
    ds_read_b128 v[216:219], v17 offset:25600
    ds_read_b128 v[220:223], v17 offset:58368
    v_mfma_f32_32x32x16_bf16 v[128:143], v[208:211], v[192:195], v[128:143]
    s_waitcnt vmcnt(4)
    ds_read_b64_tr_b16 v[200:201], v12 offset:2048
    ds_read_b64_tr_b16 v[202:203], v12 offset:2560
    ds_read_b64_tr_b16 v[204:205], v13 offset:2048
    ds_read_b64_tr_b16 v[206:207], v13 offset:2560
    v_mfma_f32_32x32x16_bf16 v[144:159], v[208:211], v[196:199], v[144:159]
    s_add_u32 m0, s28, 0
    s_nop 0
    buffer_load_dwordx4 v10, s[4:7], s29 offen lds
    s_add_u32 s29, s29, 24576
    v_mfma_f32_32x32x16_bf16 v[160:175], v[212:215], v[192:195], v[160:175]
    s_add_u32 m0, s28, 1024
    s_nop 0
    buffer_load_dwordx4 v10, s[4:7], s29 offen lds
    s_add_u32 s29, s29, 24576
    v_mfma_f32_32x32x16_bf16 v[176:191], v[212:215], v[196:199], v[176:191]
    s_waitcnt lgkmcnt(0)
    ds_read_b128 v[208:211], v18 offset:26624
    ds_read_b128 v[212:215], v18 offset:59392
    v_mfma_f32_32x32x16_bf16 v[128:143], v[216:219], v[200:203], v[128:143]
    s_waitcnt vmcnt(4)
    ds_read_b64_tr_b16 v[192:193], v12 offset:4096
    ds_read_b64_tr_b16 v[194:195], v12 offset:4608
    ds_read_b64_tr_b16 v[196:197], v13 offset:4096
    ds_read_b64_tr_b16 v[198:199], v13 offset:4608
    v_mfma_f32_32x32x16_bf16 v[144:159], v[216:219], v[204:207], v[144:159]
    s_add_u32 m0, s28, 2048
    s_nop 0
    buffer_load_dwordx4 v10, s[4:7], s29 offen lds
    s_add_u32 s29, s29, 24576
    v_mfma_f32_32x32x16_bf16 v[160:175], v[220:223], v[200:203], v[160:175]
    s_add_u32 m0, s28, 3072
    s_nop 0
    buffer_load_dwordx4 v10, s[4:7], s29 offen lds
    s_add_u32 s29, s29, 24576
    v_mfma_f32_32x32x16_bf16 v[176:191], v[220:223], v[204:207], v[176:191]
    s_waitcnt lgkmcnt(0)
    ds_read_b128 v[216:219], v19 offset:27648
    ds_read_b128 v[220:223], v19 offset:60416
    v_mfma_f32_32x32x16_bf16 v[128:143], v[208:211], v[192:195], v[128:143]
    s_waitcnt vmcnt(4)
    ds_read_b64_tr_b16 v[200:201], v12 offset:6144
    ds_read_b64_tr_b16 v[202:203], v12 offset:6656
    ds_read_b64_tr_b16 v[204:205], v13 offset:6144
    ds_read_b64_tr_b16 v[206:207], v13 offset:6656
    v_mfma_f32_32x32x16_bf16 v[144:159], v[208:211], v[196:199], v[144:159]
    s_add_u32 m0, s28, 4096
    s_nop 0
    buffer_load_dwordx4 v10, s[4:7], s29 offen lds
    s_add_u32 s29, s29, 24576
    v_mfma_f32_32x32x16_bf16 v[160:175], v[212:215], v[192:195], v[160:175]
    s_add_u32 m0, s28, 5120
    s_nop 0
    buffer_load_dwordx4 v10, s[4:7], s29 offen lds
    s_add_u32 s29, s29, 24576
    v_mfma_f32_32x32x16_bf16 v[176:191], v[212:215], v[196:199], v[176:191]
    s_waitcnt lgkmcnt(0)
    ds_read_b128 v[208:211], v16 offset:28672
    ds_read_b128 v[212:215], v16 offset:61440
    v_mfma_f32_32x32x16_bf16 v[128:143], v[216:219], v[200:203], v[128:143]
    s_waitcnt vmcnt(4)
    ds_read_b64_tr_b16 v[192:193], v12 offset:0
    ds_read_b64_tr_b16 v[194:195], v12 offset:512
    ds_read_b64_tr_b16 v[196:197], v13 offset:0
    ds_read_b64_tr_b16 v[198:199], v13 offset:512
    v_mfma_f32_32x32x16_bf16 v[144:159], v[216:219], v[204:207], v[144:159]
    s_add_u32 m0, s28, 6144
    s_nop 0
    buffer_load_dwordx4 v10, s[4:7], s29 offen lds
    s_add_u32 s29, s29, 24576
    v_mfma_f32_32x32x16_bf16 v[160:175], v[220:223], v[200:203], v[160:175]
    s_add_u32 m0, s28, 7168
    s_nop 0
    buffer_load_dwordx4 v10, s[4:7], s29 offen lds
    s_add_u32 s29, s29, 24576
    v_mfma_f32_32x32x16_bf16 v[176:191], v[220:223], v[204:207], v[176:191]
    s_waitcnt lgkmcnt(0)
    ds_read_b128 v[216:219], v17 offset:29696
    ds_read_b128 v[220:223], v17 offset:62464
    v_mfma_f32_32x32x16_bf16 v[128:143], v[208:211], v[192:195], v[128:143]
    s_waitcnt vmcnt(4)
    ds_read_b64_tr_b16 v[200:201], v12 offset:2048
    ds_read_b64_tr_b16 v[202:203], v12 offset:2560
    ds_read_b64_tr_b16 v[204:205], v13 offset:2048
    ds_read_b64_tr_b16 v[206:207], v13 offset:2560
    v_mfma_f32_32x32x16_bf16 v[144:159], v[208:211], v[196:199], v[144:159]
    v_mfma_f32_32x32x16_bf16 v[160:175], v[212:215], v[192:195], v[160:175]
    v_mfma_f32_32x32x16_bf16 v[176:191], v[212:215], v[196:199], v[176:191]
    s_waitcnt lgkmcnt(0)
    ds_read_b128 v[208:211], v18 offset:30720
    ds_read_b128 v[212:215], v18 offset:63488
    v_mfma_f32_32x32x16_bf16 v[128:143], v[216:219], v[200:203], v[128:143]
    s_waitcnt vmcnt(2)
    ds_read_b64_tr_b16 v[192:193], v12 offset:4096
    ds_read_b64_tr_b16 v[194:195], v12 offset:4608
    ds_read_b64_tr_b16 v[196:197], v13 offset:4096
    ds_read_b64_tr_b16 v[198:199], v13 offset:4608
    v_mfma_f32_32x32x16_bf16 v[144:159], v[216:219], v[204:207], v[144:159]
    v_mfma_f32_32x32x16_bf16 v[160:175], v[220:223], v[200:203], v[160:175]
    v_mfma_f32_32x32x16_bf16 v[176:191], v[220:223], v[204:207], v[176:191]
    s_waitcnt lgkmcnt(0)
    ds_read_b128 v[216:219], v19 offset:31744
    ds_read_b128 v[220:223], v19 offset:64512
    v_mfma_f32_32x32x16_bf16 v[128:143], v[208:211], v[192:195], v[128:143]
    s_waitcnt vmcnt(0)
    ds_read_b64_tr_b16 v[200:201], v12 offset:6144
    ds_read_b64_tr_b16 v[202:203], v12 offset:6656
    ds_read_b64_tr_b16 v[204:205], v13 offset:6144
    ds_read_b64_tr_b16 v[206:207], v13 offset:6656
    v_mfma_f32_32x32x16_bf16 v[144:159], v[208:211], v[196:199], v[144:159]
    v_mfma_f32_32x32x16_bf16 v[160:175], v[212:215], v[192:195], v[160:175]
    v_mfma_f32_32x32x16_bf16 v[176:191], v[212:215], v[196:199], v[176:191]
    s_waitcnt lgkmcnt(0)
    v_mfma_f32_32x32x16_bf16 v[128:143], v[216:219], v[200:203], v[128:143]
    v_mfma_f32_32x32x16_bf16 v[144:159], v[216:219], v[204:207], v[144:159]
    v_mfma_f32_32x32x16_bf16 v[160:175], v[220:223], v[200:203], v[160:175]
    v_mfma_f32_32x32x16_bf16 v[176:191], v[220:223], v[204:207], v[176:191]
    v_lshrrev_b32 v2, 5, v1
    v_lshlrev_b32 v3, 8, v2
    v_and_b32 v2, 15, v1
    v_lshl_add_u32 v3, v2, 4, v3
    v_bfe_u32 v2, v1, 4, 1
    v_lshl_add_u32 v5, v2, 11, v3
    v_add_u32 v5, s28, v5
    v_lshl_add_u32 v6, v2, 16, v3
    s_lshl_b32 s46, s18, 18
    s_lshl_b32 s47, s17, 11
    s_add_u32 s46, s46, s47
    s_add_u32 s46, s46, 6291456
    v_cvt_pk_bf16_f32 v224, v128, v129
    v_cvt_pk_bf16_f32 v225, v130, v131
    v_cvt_pk_bf16_f32 v226, v132, v133
    v_cvt_pk_bf16_f32 v227, v134, v135
    buffer_store_dwordx4 v[224:227], v6, s[40:43], s46 offen offset:0 sc1
    v_cvt_pk_bf16_f32 v228, v136, v137
    v_cvt_pk_bf16_f32 v229, v138, v139
    v_cvt_pk_bf16_f32 v230, v140, v141
    v_cvt_pk_bf16_f32 v231, v142, v143
    buffer_store_dwordx4 v[228:231], v6, s[40:43], s46 offen offset:512 sc1
    v_cvt_pk_bf16_f32 v232, v160, v161
    v_cvt_pk_bf16_f32 v233, v162, v163
    v_cvt_pk_bf16_f32 v234, v164, v165
    v_cvt_pk_bf16_f32 v235, v166, v167
    buffer_store_dwordx4 v[232:235], v6, s[40:43], s46 offen offset:1024 sc1
    v_cvt_pk_bf16_f32 v236, v168, v169
    v_cvt_pk_bf16_f32 v237, v170, v171
    v_cvt_pk_bf16_f32 v238, v172, v173
    v_cvt_pk_bf16_f32 v239, v174, v175
    buffer_store_dwordx4 v[236:239], v6, s[40:43], s46 offen offset:1536 sc1
    s_add_u32 s46, s46, 131072
    v_cvt_pk_bf16_f32 v240, v144, v145
    v_cvt_pk_bf16_f32 v241, v146, v147
    v_cvt_pk_bf16_f32 v242, v148, v149
    v_cvt_pk_bf16_f32 v243, v150, v151
    buffer_store_dwordx4 v[240:243], v6, s[40:43], s46 offen offset:0 sc1
    v_cvt_pk_bf16_f32 v244, v152, v153
    v_cvt_pk_bf16_f32 v245, v154, v155
    v_cvt_pk_bf16_f32 v246, v156, v157
    v_cvt_pk_bf16_f32 v247, v158, v159
    buffer_store_dwordx4 v[244:247], v6, s[40:43], s46 offen offset:512 sc1
    v_cvt_pk_bf16_f32 v248, v176, v177
    v_cvt_pk_bf16_f32 v249, v178, v179
    v_cvt_pk_bf16_f32 v250, v180, v181
    v_cvt_pk_bf16_f32 v251, v182, v183
    buffer_store_dwordx4 v[248:251], v6, s[40:43], s46 offen offset:1024 sc1
    v_cvt_pk_bf16_f32 v252, v184, v185
    v_cvt_pk_bf16_f32 v253, v186, v187
    v_cvt_pk_bf16_f32 v254, v188, v189
    v_cvt_pk_bf16_f32 v255, v190, v191
    buffer_store_dwordx4 v[252:255], v6, s[40:43], s46 offen offset:1536 sc1
    s_add_u32 s46, s46, 131072
    ds_write_b128 v5, v[224:227] offset:0
    ds_write_b128 v5, v[228:231] offset:512
    ds_write_b128 v5, v[232:235] offset:1024
    ds_write_b128 v5, v[236:239] offset:1536
    ds_write_b128 v5, v[240:243] offset:4096
    ds_write_b128 v5, v[244:247] offset:4608
    ds_write_b128 v5, v[248:251] offset:5120
    ds_write_b128 v5, v[252:255] offset:5632
    s_waitcnt lgkmcnt(0)
    s_mov_b64 exec, 1
    v_mov_b32 v2, 159748
    v_mov_b32 v3, 1
    ds_add_u32 v2, v3
    s_mov_b64 exec, -1
    s_mov_b64 exec, 1
    v_mov_b32 v2, 159760
    v_mov_b32 v3, 1
    ds_add_u32 v2, v3
    s_mov_b64 exec, -1
    v_mov_b32 v2, 159800
Y_V_NC:
    ds_read_b64 v[4:5], v2
    s_waitcnt lgkmcnt(0)
    v_readfirstlane_b32 s2, v4
    v_readfirstlane_b32 s3, v5
    s_cmp_lg_u32 s2, 0
    s_cbranch_scc1 Y_V_NC_OK
    s_sleep 1
    s_branch Y_V_NC
Y_V_NC_OK:
    s_waitcnt vmcnt(0)
    s_mov_b64 exec, 1
    v_mov_b32 v2, 159744
    v_mov_b32 v3, 1
    ds_add_rtn_u32 v4, v2, v3
    s_waitcnt lgkmcnt(0)
    v_readfirstlane_b32 s46, v4
    s_nop 0
    s_cmp_eq_u32 s46, 1
    s_cbranch_scc0 Y_V_PB_NOPUB
    v_mov_b32 v4, s2
    v_mov_b32 v5, s3
    buffer_store_dwordx2 v[4:5], v8, s[40:43], s99 offen sc1
Y_V_PB_NOPUB:
    s_mov_b64 exec, -1
    s_branch Y_AWAIT
Y_Q:
    s_setprio 3
    s_waitcnt vmcnt(6)
    ds_read_b64_tr_b16 v[192:193], v12 offset:0
    ds_read_b64_tr_b16 v[194:195], v12 offset:512
    ds_read_b64_tr_b16 v[196:197], v13 offset:0
    ds_read_b64_tr_b16 v[198:199], v13 offset:512
    ds_read_b128 v[208:211], v16 offset:0
    ds_read_b128 v[212:215], v16 offset:32768
    s_waitcnt lgkmcnt(0)
    ds_read_b128 v[216:219], v17 offset:1024
    ds_read_b128 v[220:223], v17 offset:33792
    v_mfma_f32_32x32x16_bf16 v[128:143], v[192:195], v[208:211], 0
    s_waitcnt vmcnt(4)
    ds_read_b64_tr_b16 v[200:201], v12 offset:2048
    ds_read_b64_tr_b16 v[202:203], v12 offset:2560
    ds_read_b64_tr_b16 v[204:205], v13 offset:2048
    ds_read_b64_tr_b16 v[206:207], v13 offset:2560
    v_mfma_f32_32x32x16_bf16 v[144:159], v[196:199], v[208:211], 0
    s_add_u32 m0, s28, 0
    s_nop 0
    buffer_load_dwordx4 v10, s[4:7], s29 offen lds
    s_add_u32 s29, s29, 24576
    v_mfma_f32_32x32x16_bf16 v[160:175], v[192:195], v[212:215], 0
    s_add_u32 m0, s28, 1024
    s_nop 0
    buffer_load_dwordx4 v10, s[4:7], s29 offen lds
    s_add_u32 s29, s29, 24576
    v_mfma_f32_32x32x16_bf16 v[176:191], v[196:199], v[212:215], 0
    s_waitcnt lgkmcnt(0)
    ds_read_b128 v[208:211], v18 offset:2048
    ds_read_b128 v[212:215], v18 offset:34816
    v_mfma_f32_32x32x16_bf16 v[128:143], v[200:203], v[216:219], v[128:143]
    s_waitcnt vmcnt(4)
    ds_read_b64_tr_b16 v[192:193], v12 offset:4096
    ds_read_b64_tr_b16 v[194:195], v12 offset:4608
    ds_read_b64_tr_b16 v[196:197], v13 offset:4096
    ds_read_b64_tr_b16 v[198:199], v13 offset:4608
    v_mfma_f32_32x32x16_bf16 v[144:159], v[204:207], v[216:219], v[144:159]
    s_add_u32 m0, s28, 2048
    s_nop 0
    buffer_load_dwordx4 v10, s[4:7], s29 offen lds
    s_add_u32 s29, s29, 24576
    v_mfma_f32_32x32x16_bf16 v[160:175], v[200:203], v[220:223], v[160:175]
    s_add_u32 m0, s28, 3072
    s_nop 0
    buffer_load_dwordx4 v10, s[4:7], s29 offen lds
    s_add_u32 s29, s29, 24576
    v_mfma_f32_32x32x16_bf16 v[176:191], v[204:207], v[220:223], v[176:191]
    s_waitcnt lgkmcnt(0)
    ds_read_b128 v[216:219], v19 offset:3072
    ds_read_b128 v[220:223], v19 offset:35840
    v_mfma_f32_32x32x16_bf16 v[128:143], v[192:195], v[208:211], v[128:143]
    s_waitcnt vmcnt(4)
    ds_read_b64_tr_b16 v[200:201], v12 offset:6144
    ds_read_b64_tr_b16 v[202:203], v12 offset:6656
    ds_read_b64_tr_b16 v[204:205], v13 offset:6144
    ds_read_b64_tr_b16 v[206:207], v13 offset:6656
    v_mfma_f32_32x32x16_bf16 v[144:159], v[196:199], v[208:211], v[144:159]
    s_add_u32 m0, s28, 4096
    s_nop 0
    buffer_load_dwordx4 v10, s[4:7], s29 offen lds
    s_add_u32 s29, s29, 24576
    v_mfma_f32_32x32x16_bf16 v[160:175], v[192:195], v[212:215], v[160:175]
    s_add_u32 m0, s28, 5120
    s_nop 0
    buffer_load_dwordx4 v10, s[4:7], s29 offen lds
    s_add_u32 s29, s29, 24576
    v_mfma_f32_32x32x16_bf16 v[176:191], v[196:199], v[212:215], v[176:191]
    s_waitcnt lgkmcnt(0)
    ds_read_b128 v[208:211], v16 offset:4096
    ds_read_b128 v[212:215], v16 offset:36864
    v_mfma_f32_32x32x16_bf16 v[128:143], v[200:203], v[216:219], v[128:143]
    s_waitcnt vmcnt(4)
    ds_read_b64_tr_b16 v[192:193], v12 offset:0
    ds_read_b64_tr_b16 v[194:195], v12 offset:512
    ds_read_b64_tr_b16 v[196:197], v13 offset:0
    ds_read_b64_tr_b16 v[198:199], v13 offset:512
    v_mfma_f32_32x32x16_bf16 v[144:159], v[204:207], v[216:219], v[144:159]
    s_add_u32 m0, s28, 6144
    s_nop 0
    buffer_load_dwordx4 v10, s[4:7], s29 offen lds
    s_add_u32 s29, s29, 24576
    v_mfma_f32_32x32x16_bf16 v[160:175], v[200:203], v[220:223], v[160:175]
    s_add_u32 m0, s28, 7168
    s_nop 0
    buffer_load_dwordx4 v10, s[4:7], s29 offen lds
    s_add_u32 s29, s29, 24576
    v_mfma_f32_32x32x16_bf16 v[176:191], v[204:207], v[220:223], v[176:191]
    s_waitcnt lgkmcnt(0)
    ds_read_b128 v[216:219], v17 offset:5120
    ds_read_b128 v[220:223], v17 offset:37888
    v_mfma_f32_32x32x16_bf16 v[128:143], v[192:195], v[208:211], v[128:143]
    s_waitcnt vmcnt(4)
    ds_read_b64_tr_b16 v[200:201], v12 offset:2048
    ds_read_b64_tr_b16 v[202:203], v12 offset:2560
    ds_read_b64_tr_b16 v[204:205], v13 offset:2048
    ds_read_b64_tr_b16 v[206:207], v13 offset:2560
    v_mfma_f32_32x32x16_bf16 v[144:159], v[196:199], v[208:211], v[144:159]
    s_add_u32 m0, s28, 0
    s_nop 0
    buffer_load_dwordx4 v10, s[4:7], s29 offen lds
    s_add_u32 s29, s29, 24576
    v_mfma_f32_32x32x16_bf16 v[160:175], v[192:195], v[212:215], v[160:175]
    s_add_u32 m0, s28, 1024
    s_nop 0
    buffer_load_dwordx4 v10, s[4:7], s29 offen lds
    s_add_u32 s29, s29, 24576
    v_mfma_f32_32x32x16_bf16 v[176:191], v[196:199], v[212:215], v[176:191]
    s_waitcnt lgkmcnt(0)
    ds_read_b128 v[208:211], v18 offset:6144
    ds_read_b128 v[212:215], v18 offset:38912
    v_mfma_f32_32x32x16_bf16 v[128:143], v[200:203], v[216:219], v[128:143]
    s_waitcnt vmcnt(4)
    ds_read_b64_tr_b16 v[192:193], v12 offset:4096
    ds_read_b64_tr_b16 v[194:195], v12 offset:4608
    ds_read_b64_tr_b16 v[196:197], v13 offset:4096
    ds_read_b64_tr_b16 v[198:199], v13 offset:4608
    v_mfma_f32_32x32x16_bf16 v[144:159], v[204:207], v[216:219], v[144:159]
    s_add_u32 m0, s28, 2048
    s_nop 0
    buffer_load_dwordx4 v10, s[4:7], s29 offen lds
    s_add_u32 s29, s29, 24576
    v_mfma_f32_32x32x16_bf16 v[160:175], v[200:203], v[220:223], v[160:175]
    s_add_u32 m0, s28, 3072
    s_nop 0
    buffer_load_dwordx4 v10, s[4:7], s29 offen lds
    s_add_u32 s29, s29, 24576
    v_mfma_f32_32x32x16_bf16 v[176:191], v[204:207], v[220:223], v[176:191]
    s_waitcnt lgkmcnt(0)
    ds_read_b128 v[216:219], v19 offset:7168
    ds_read_b128 v[220:223], v19 offset:39936
    v_mfma_f32_32x32x16_bf16 v[128:143], v[192:195], v[208:211], v[128:143]
    s_waitcnt vmcnt(4)
    ds_read_b64_tr_b16 v[200:201], v12 offset:6144
    ds_read_b64_tr_b16 v[202:203], v12 offset:6656
    ds_read_b64_tr_b16 v[204:205], v13 offset:6144
    ds_read_b64_tr_b16 v[206:207], v13 offset:6656
    v_mfma_f32_32x32x16_bf16 v[144:159], v[196:199], v[208:211], v[144:159]
    s_add_u32 m0, s28, 4096
    s_nop 0
    buffer_load_dwordx4 v10, s[4:7], s29 offen lds
    s_add_u32 s29, s29, 24576
    v_mfma_f32_32x32x16_bf16 v[160:175], v[192:195], v[212:215], v[160:175]
    s_add_u32 m0, s28, 5120
    s_nop 0
    buffer_load_dwordx4 v10, s[4:7], s29 offen lds
    s_add_u32 s29, s29, 24576
    v_mfma_f32_32x32x16_bf16 v[176:191], v[196:199], v[212:215], v[176:191]
    s_waitcnt lgkmcnt(0)
    ds_read_b128 v[208:211], v16 offset:8192
    ds_read_b128 v[212:215], v16 offset:40960
    v_mfma_f32_32x32x16_bf16 v[128:143], v[200:203], v[216:219], v[128:143]
    s_waitcnt vmcnt(4)
    ds_read_b64_tr_b16 v[192:193], v12 offset:0
    ds_read_b64_tr_b16 v[194:195], v12 offset:512
    ds_read_b64_tr_b16 v[196:197], v13 offset:0
    ds_read_b64_tr_b16 v[198:199], v13 offset:512
    v_mfma_f32_32x32x16_bf16 v[144:159], v[204:207], v[216:219], v[144:159]
    s_add_u32 m0, s28, 6144
    s_nop 0
    buffer_load_dwordx4 v10, s[4:7], s29 offen lds
    s_add_u32 s29, s29, 24576
    v_mfma_f32_32x32x16_bf16 v[160:175], v[200:203], v[220:223], v[160:175]
    s_add_u32 m0, s28, 7168
    s_nop 0
    buffer_load_dwordx4 v10, s[4:7], s29 offen lds
    s_add_u32 s29, s29, 24576
    v_mfma_f32_32x32x16_bf16 v[176:191], v[204:207], v[220:223], v[176:191]
    s_waitcnt lgkmcnt(0)
    ds_read_b128 v[216:219], v17 offset:9216
    ds_read_b128 v[220:223], v17 offset:41984
    v_mfma_f32_32x32x16_bf16 v[128:143], v[192:195], v[208:211], v[128:143]
    s_waitcnt vmcnt(4)
    ds_read_b64_tr_b16 v[200:201], v12 offset:2048
    ds_read_b64_tr_b16 v[202:203], v12 offset:2560
    ds_read_b64_tr_b16 v[204:205], v13 offset:2048
    ds_read_b64_tr_b16 v[206:207], v13 offset:2560
    v_mfma_f32_32x32x16_bf16 v[144:159], v[196:199], v[208:211], v[144:159]
    s_add_u32 m0, s28, 0
    s_nop 0
    buffer_load_dwordx4 v10, s[4:7], s29 offen lds
    s_add_u32 s29, s29, 24576
    v_mfma_f32_32x32x16_bf16 v[160:175], v[192:195], v[212:215], v[160:175]
    s_add_u32 m0, s28, 1024
    s_nop 0
    buffer_load_dwordx4 v10, s[4:7], s29 offen lds
    s_add_u32 s29, s29, 24576
    v_mfma_f32_32x32x16_bf16 v[176:191], v[196:199], v[212:215], v[176:191]
    s_waitcnt lgkmcnt(0)
    ds_read_b128 v[208:211], v18 offset:10240
    ds_read_b128 v[212:215], v18 offset:43008
    v_mfma_f32_32x32x16_bf16 v[128:143], v[200:203], v[216:219], v[128:143]
    s_waitcnt vmcnt(4)
    ds_read_b64_tr_b16 v[192:193], v12 offset:4096
    ds_read_b64_tr_b16 v[194:195], v12 offset:4608
    ds_read_b64_tr_b16 v[196:197], v13 offset:4096
    ds_read_b64_tr_b16 v[198:199], v13 offset:4608
    v_mfma_f32_32x32x16_bf16 v[144:159], v[204:207], v[216:219], v[144:159]
    s_add_u32 m0, s28, 2048
    s_nop 0
    buffer_load_dwordx4 v10, s[4:7], s29 offen lds
    s_add_u32 s29, s29, 24576
    v_mfma_f32_32x32x16_bf16 v[160:175], v[200:203], v[220:223], v[160:175]
    s_add_u32 m0, s28, 3072
    s_nop 0
    buffer_load_dwordx4 v10, s[4:7], s29 offen lds
    s_add_u32 s29, s29, 24576
    v_mfma_f32_32x32x16_bf16 v[176:191], v[204:207], v[220:223], v[176:191]
    s_waitcnt lgkmcnt(0)
    ds_read_b128 v[216:219], v19 offset:11264
    ds_read_b128 v[220:223], v19 offset:44032
    v_mfma_f32_32x32x16_bf16 v[128:143], v[192:195], v[208:211], v[128:143]
    s_waitcnt vmcnt(4)
    ds_read_b64_tr_b16 v[200:201], v12 offset:6144
    ds_read_b64_tr_b16 v[202:203], v12 offset:6656
    ds_read_b64_tr_b16 v[204:205], v13 offset:6144
    ds_read_b64_tr_b16 v[206:207], v13 offset:6656
    v_mfma_f32_32x32x16_bf16 v[144:159], v[196:199], v[208:211], v[144:159]
    s_add_u32 m0, s28, 4096
    s_nop 0
    buffer_load_dwordx4 v10, s[4:7], s29 offen lds
    s_add_u32 s29, s29, 24576
    v_mfma_f32_32x32x16_bf16 v[160:175], v[192:195], v[212:215], v[160:175]
    s_add_u32 m0, s28, 5120
    s_nop 0
    buffer_load_dwordx4 v10, s[4:7], s29 offen lds
    s_add_u32 s29, s29, 24576
    v_mfma_f32_32x32x16_bf16 v[176:191], v[196:199], v[212:215], v[176:191]
    s_waitcnt lgkmcnt(0)
    ds_read_b128 v[208:211], v16 offset:12288
    ds_read_b128 v[212:215], v16 offset:45056
    v_mfma_f32_32x32x16_bf16 v[128:143], v[200:203], v[216:219], v[128:143]
    s_waitcnt vmcnt(4)
    ds_read_b64_tr_b16 v[192:193], v12 offset:0
    ds_read_b64_tr_b16 v[194:195], v12 offset:512
    ds_read_b64_tr_b16 v[196:197], v13 offset:0
    ds_read_b64_tr_b16 v[198:199], v13 offset:512
    v_mfma_f32_32x32x16_bf16 v[144:159], v[204:207], v[216:219], v[144:159]
    s_add_u32 m0, s28, 6144
    s_nop 0
    buffer_load_dwordx4 v10, s[4:7], s29 offen lds
    s_add_u32 s29, s29, 24576
    v_mfma_f32_32x32x16_bf16 v[160:175], v[200:203], v[220:223], v[160:175]
    s_add_u32 m0, s28, 7168
    s_nop 0
    buffer_load_dwordx4 v10, s[4:7], s29 offen lds
    s_add_u32 s29, s29, 24576
    v_mfma_f32_32x32x16_bf16 v[176:191], v[204:207], v[220:223], v[176:191]
    s_waitcnt lgkmcnt(0)
    ds_read_b128 v[216:219], v17 offset:13312
    ds_read_b128 v[220:223], v17 offset:46080
    v_mfma_f32_32x32x16_bf16 v[128:143], v[192:195], v[208:211], v[128:143]
    s_waitcnt vmcnt(4)
    ds_read_b64_tr_b16 v[200:201], v12 offset:2048
    ds_read_b64_tr_b16 v[202:203], v12 offset:2560
    ds_read_b64_tr_b16 v[204:205], v13 offset:2048
    ds_read_b64_tr_b16 v[206:207], v13 offset:2560
    v_mfma_f32_32x32x16_bf16 v[144:159], v[196:199], v[208:211], v[144:159]
    s_add_u32 m0, s28, 0
    s_nop 0
    buffer_load_dwordx4 v10, s[4:7], s29 offen lds
    s_add_u32 s29, s29, 24576
    v_mfma_f32_32x32x16_bf16 v[160:175], v[192:195], v[212:215], v[160:175]
    s_add_u32 m0, s28, 1024
    s_nop 0
    buffer_load_dwordx4 v10, s[4:7], s29 offen lds
    s_add_u32 s29, s29, 24576
    v_mfma_f32_32x32x16_bf16 v[176:191], v[196:199], v[212:215], v[176:191]
    s_waitcnt lgkmcnt(0)
    ds_read_b128 v[208:211], v18 offset:14336
    ds_read_b128 v[212:215], v18 offset:47104
    v_mfma_f32_32x32x16_bf16 v[128:143], v[200:203], v[216:219], v[128:143]
    s_waitcnt vmcnt(4)
    ds_read_b64_tr_b16 v[192:193], v12 offset:4096
    ds_read_b64_tr_b16 v[194:195], v12 offset:4608
    ds_read_b64_tr_b16 v[196:197], v13 offset:4096
    ds_read_b64_tr_b16 v[198:199], v13 offset:4608
    v_mfma_f32_32x32x16_bf16 v[144:159], v[204:207], v[216:219], v[144:159]
    s_add_u32 m0, s28, 2048
    s_nop 0
    buffer_load_dwordx4 v10, s[4:7], s29 offen lds
    s_add_u32 s29, s29, 24576
    v_mfma_f32_32x32x16_bf16 v[160:175], v[200:203], v[220:223], v[160:175]
    s_add_u32 m0, s28, 3072
    s_nop 0
    buffer_load_dwordx4 v10, s[4:7], s29 offen lds
    s_add_u32 s29, s29, 24576
    v_mfma_f32_32x32x16_bf16 v[176:191], v[204:207], v[220:223], v[176:191]
    s_waitcnt lgkmcnt(0)
    ds_read_b128 v[216:219], v19 offset:15360
    ds_read_b128 v[220:223], v19 offset:48128
    v_mfma_f32_32x32x16_bf16 v[128:143], v[192:195], v[208:211], v[128:143]
    s_waitcnt vmcnt(4)
    ds_read_b64_tr_b16 v[200:201], v12 offset:6144
    ds_read_b64_tr_b16 v[202:203], v12 offset:6656
    ds_read_b64_tr_b16 v[204:205], v13 offset:6144
    ds_read_b64_tr_b16 v[206:207], v13 offset:6656
    v_mfma_f32_32x32x16_bf16 v[144:159], v[196:199], v[208:211], v[144:159]
    s_add_u32 m0, s28, 4096
    s_nop 0
    buffer_load_dwordx4 v10, s[4:7], s29 offen lds
    s_add_u32 s29, s29, 24576
    v_mfma_f32_32x32x16_bf16 v[160:175], v[192:195], v[212:215], v[160:175]
    s_add_u32 m0, s28, 5120
    s_nop 0
    buffer_load_dwordx4 v10, s[4:7], s29 offen lds
    s_add_u32 s29, s29, 24576
    v_mfma_f32_32x32x16_bf16 v[176:191], v[196:199], v[212:215], v[176:191]
    s_waitcnt lgkmcnt(0)
    ds_read_b128 v[208:211], v16 offset:16384
    ds_read_b128 v[212:215], v16 offset:49152
    v_mfma_f32_32x32x16_bf16 v[128:143], v[200:203], v[216:219], v[128:143]
    s_waitcnt vmcnt(4)
    ds_read_b64_tr_b16 v[192:193], v12 offset:0
    ds_read_b64_tr_b16 v[194:195], v12 offset:512
    ds_read_b64_tr_b16 v[196:197], v13 offset:0
    ds_read_b64_tr_b16 v[198:199], v13 offset:512
    v_mfma_f32_32x32x16_bf16 v[144:159], v[204:207], v[216:219], v[144:159]
    s_add_u32 m0, s28, 6144
    s_nop 0
    buffer_load_dwordx4 v10, s[4:7], s29 offen lds
    s_add_u32 s29, s29, 24576
    v_mfma_f32_32x32x16_bf16 v[160:175], v[200:203], v[220:223], v[160:175]
    s_add_u32 m0, s28, 7168
    s_nop 0
    buffer_load_dwordx4 v10, s[4:7], s29 offen lds
    s_add_u32 s29, s29, 24576
    v_mfma_f32_32x32x16_bf16 v[176:191], v[204:207], v[220:223], v[176:191]
    s_waitcnt lgkmcnt(0)
    ds_read_b128 v[216:219], v17 offset:17408
    ds_read_b128 v[220:223], v17 offset:50176
    v_mfma_f32_32x32x16_bf16 v[128:143], v[192:195], v[208:211], v[128:143]
    s_waitcnt vmcnt(4)
    ds_read_b64_tr_b16 v[200:201], v12 offset:2048
    ds_read_b64_tr_b16 v[202:203], v12 offset:2560
    ds_read_b64_tr_b16 v[204:205], v13 offset:2048
    ds_read_b64_tr_b16 v[206:207], v13 offset:2560
    v_mfma_f32_32x32x16_bf16 v[144:159], v[196:199], v[208:211], v[144:159]
    s_add_u32 m0, s28, 0
    s_nop 0
    buffer_load_dwordx4 v10, s[4:7], s29 offen lds
    s_add_u32 s29, s29, 24576
    v_mfma_f32_32x32x16_bf16 v[160:175], v[192:195], v[212:215], v[160:175]
    s_add_u32 m0, s28, 1024
    s_nop 0
    buffer_load_dwordx4 v10, s[4:7], s29 offen lds
    s_add_u32 s29, s29, 24576
    v_mfma_f32_32x32x16_bf16 v[176:191], v[196:199], v[212:215], v[176:191]
    s_waitcnt lgkmcnt(0)
    ds_read_b128 v[208:211], v18 offset:18432
    ds_read_b128 v[212:215], v18 offset:51200
    v_mfma_f32_32x32x16_bf16 v[128:143], v[200:203], v[216:219], v[128:143]
    s_waitcnt vmcnt(4)
    ds_read_b64_tr_b16 v[192:193], v12 offset:4096
    ds_read_b64_tr_b16 v[194:195], v12 offset:4608
    ds_read_b64_tr_b16 v[196:197], v13 offset:4096
    ds_read_b64_tr_b16 v[198:199], v13 offset:4608
    v_mfma_f32_32x32x16_bf16 v[144:159], v[204:207], v[216:219], v[144:159]
    s_add_u32 m0, s28, 2048
    s_nop 0
    buffer_load_dwordx4 v10, s[4:7], s29 offen lds
    s_add_u32 s29, s29, 24576
    v_mfma_f32_32x32x16_bf16 v[160:175], v[200:203], v[220:223], v[160:175]
    s_add_u32 m0, s28, 3072
    s_nop 0
    buffer_load_dwordx4 v10, s[4:7], s29 offen lds
    s_add_u32 s29, s29, 24576
    v_mfma_f32_32x32x16_bf16 v[176:191], v[204:207], v[220:223], v[176:191]
    s_waitcnt lgkmcnt(0)
    ds_read_b128 v[216:219], v19 offset:19456
    ds_read_b128 v[220:223], v19 offset:52224
    v_mfma_f32_32x32x16_bf16 v[128:143], v[192:195], v[208:211], v[128:143]
    s_waitcnt vmcnt(4)
    ds_read_b64_tr_b16 v[200:201], v12 offset:6144
    ds_read_b64_tr_b16 v[202:203], v12 offset:6656
    ds_read_b64_tr_b16 v[204:205], v13 offset:6144
    ds_read_b64_tr_b16 v[206:207], v13 offset:6656
    v_mfma_f32_32x32x16_bf16 v[144:159], v[196:199], v[208:211], v[144:159]
    s_add_u32 m0, s28, 4096
    s_nop 0
    buffer_load_dwordx4 v10, s[4:7], s29 offen lds
    s_add_u32 s29, s29, 24576
    v_mfma_f32_32x32x16_bf16 v[160:175], v[192:195], v[212:215], v[160:175]
    s_add_u32 m0, s28, 5120
    s_nop 0
    buffer_load_dwordx4 v10, s[4:7], s29 offen lds
    s_add_u32 s29, s29, 24576
    v_mfma_f32_32x32x16_bf16 v[176:191], v[196:199], v[212:215], v[176:191]
    s_waitcnt lgkmcnt(0)
    ds_read_b128 v[208:211], v16 offset:20480
    ds_read_b128 v[212:215], v16 offset:53248
    v_mfma_f32_32x32x16_bf16 v[128:143], v[200:203], v[216:219], v[128:143]
    s_waitcnt vmcnt(4)
    ds_read_b64_tr_b16 v[192:193], v12 offset:0
    ds_read_b64_tr_b16 v[194:195], v12 offset:512
    ds_read_b64_tr_b16 v[196:197], v13 offset:0
    ds_read_b64_tr_b16 v[198:199], v13 offset:512
    v_mfma_f32_32x32x16_bf16 v[144:159], v[204:207], v[216:219], v[144:159]
    s_add_u32 m0, s28, 6144
    s_nop 0
    buffer_load_dwordx4 v10, s[4:7], s29 offen lds
    s_add_u32 s29, s29, 24576
    v_mfma_f32_32x32x16_bf16 v[160:175], v[200:203], v[220:223], v[160:175]
    s_add_u32 m0, s28, 7168
    s_nop 0
    buffer_load_dwordx4 v10, s[4:7], s29 offen lds
    s_add_u32 s29, s29, 24576
    v_mfma_f32_32x32x16_bf16 v[176:191], v[204:207], v[220:223], v[176:191]
    s_waitcnt lgkmcnt(0)
    ds_read_b128 v[216:219], v17 offset:21504
    ds_read_b128 v[220:223], v17 offset:54272
    v_mfma_f32_32x32x16_bf16 v[128:143], v[192:195], v[208:211], v[128:143]
    s_waitcnt vmcnt(4)
    ds_read_b64_tr_b16 v[200:201], v12 offset:2048
    ds_read_b64_tr_b16 v[202:203], v12 offset:2560
    ds_read_b64_tr_b16 v[204:205], v13 offset:2048
    ds_read_b64_tr_b16 v[206:207], v13 offset:2560
    v_mfma_f32_32x32x16_bf16 v[144:159], v[196:199], v[208:211], v[144:159]
    s_add_u32 m0, s28, 0
    s_nop 0
    buffer_load_dwordx4 v10, s[4:7], s29 offen lds
    s_add_u32 s29, s29, 24576
    v_mfma_f32_32x32x16_bf16 v[160:175], v[192:195], v[212:215], v[160:175]
    s_add_u32 m0, s28, 1024
    s_nop 0
    buffer_load_dwordx4 v10, s[4:7], s29 offen lds
    s_add_u32 s29, s29, 24576
    v_mfma_f32_32x32x16_bf16 v[176:191], v[196:199], v[212:215], v[176:191]
    s_waitcnt lgkmcnt(0)
    ds_read_b128 v[208:211], v18 offset:22528
    ds_read_b128 v[212:215], v18 offset:55296
    v_mfma_f32_32x32x16_bf16 v[128:143], v[200:203], v[216:219], v[128:143]
    s_waitcnt vmcnt(4)
    ds_read_b64_tr_b16 v[192:193], v12 offset:4096
    ds_read_b64_tr_b16 v[194:195], v12 offset:4608
    ds_read_b64_tr_b16 v[196:197], v13 offset:4096
    ds_read_b64_tr_b16 v[198:199], v13 offset:4608
    v_mfma_f32_32x32x16_bf16 v[144:159], v[204:207], v[216:219], v[144:159]
    s_add_u32 m0, s28, 2048
    s_nop 0
    buffer_load_dwordx4 v10, s[4:7], s29 offen lds
    s_add_u32 s29, s29, 24576
    v_mfma_f32_32x32x16_bf16 v[160:175], v[200:203], v[220:223], v[160:175]
    s_add_u32 m0, s28, 3072
    s_nop 0
    buffer_load_dwordx4 v10, s[4:7], s29 offen lds
    s_add_u32 s29, s29, 24576
    v_mfma_f32_32x32x16_bf16 v[176:191], v[204:207], v[220:223], v[176:191]
    s_waitcnt lgkmcnt(0)
    ds_read_b128 v[216:219], v19 offset:23552
    ds_read_b128 v[220:223], v19 offset:56320
    v_mfma_f32_32x32x16_bf16 v[128:143], v[192:195], v[208:211], v[128:143]
    s_waitcnt vmcnt(4)
    ds_read_b64_tr_b16 v[200:201], v12 offset:6144
    ds_read_b64_tr_b16 v[202:203], v12 offset:6656
    ds_read_b64_tr_b16 v[204:205], v13 offset:6144
    ds_read_b64_tr_b16 v[206:207], v13 offset:6656
    v_mfma_f32_32x32x16_bf16 v[144:159], v[196:199], v[208:211], v[144:159]
    s_add_u32 m0, s28, 4096
    s_nop 0
    buffer_load_dwordx4 v10, s[4:7], s29 offen lds
    s_add_u32 s29, s29, 24576
    v_mfma_f32_32x32x16_bf16 v[160:175], v[192:195], v[212:215], v[160:175]
    s_add_u32 m0, s28, 5120
    s_nop 0
    buffer_load_dwordx4 v10, s[4:7], s29 offen lds
    s_add_u32 s29, s29, 24576
    v_mfma_f32_32x32x16_bf16 v[176:191], v[196:199], v[212:215], v[176:191]
    s_waitcnt lgkmcnt(0)
    ds_read_b128 v[208:211], v16 offset:24576
    ds_read_b128 v[212:215], v16 offset:57344
    v_mfma_f32_32x32x16_bf16 v[128:143], v[200:203], v[216:219], v[128:143]
    s_waitcnt vmcnt(4)
    ds_read_b64_tr_b16 v[192:193], v12 offset:0
    ds_read_b64_tr_b16 v[194:195], v12 offset:512
    ds_read_b64_tr_b16 v[196:197], v13 offset:0
    ds_read_b64_tr_b16 v[198:199], v13 offset:512
    v_mfma_f32_32x32x16_bf16 v[144:159], v[204:207], v[216:219], v[144:159]
    s_add_u32 m0, s28, 6144
    s_nop 0
    buffer_load_dwordx4 v10, s[4:7], s29 offen lds
    s_add_u32 s29, s29, 24576
    v_mfma_f32_32x32x16_bf16 v[160:175], v[200:203], v[220:223], v[160:175]
    s_add_u32 m0, s28, 7168
    s_nop 0
    buffer_load_dwordx4 v10, s[4:7], s29 offen lds
    s_add_u32 s29, s29, 24576
    v_mfma_f32_32x32x16_bf16 v[176:191], v[204:207], v[220:223], v[176:191]
    s_waitcnt lgkmcnt(0)
    ds_read_b128 v[216:219], v17 offset:25600
    ds_read_b128 v[220:223], v17 offset:58368
    v_mfma_f32_32x32x16_bf16 v[128:143], v[192:195], v[208:211], v[128:143]
    s_waitcnt vmcnt(4)
    ds_read_b64_tr_b16 v[200:201], v12 offset:2048
    ds_read_b64_tr_b16 v[202:203], v12 offset:2560
    ds_read_b64_tr_b16 v[204:205], v13 offset:2048
    ds_read_b64_tr_b16 v[206:207], v13 offset:2560
    v_mfma_f32_32x32x16_bf16 v[144:159], v[196:199], v[208:211], v[144:159]
    s_add_u32 m0, s28, 0
    s_nop 0
    buffer_load_dwordx4 v10, s[4:7], s29 offen lds
    s_add_u32 s29, s29, 24576
    v_mfma_f32_32x32x16_bf16 v[160:175], v[192:195], v[212:215], v[160:175]
    s_add_u32 m0, s28, 1024
    s_nop 0
    buffer_load_dwordx4 v10, s[4:7], s29 offen lds
    s_add_u32 s29, s29, 24576
    v_mfma_f32_32x32x16_bf16 v[176:191], v[196:199], v[212:215], v[176:191]
    s_waitcnt lgkmcnt(0)
    ds_read_b128 v[208:211], v18 offset:26624
    ds_read_b128 v[212:215], v18 offset:59392
    v_mfma_f32_32x32x16_bf16 v[128:143], v[200:203], v[216:219], v[128:143]
    s_waitcnt vmcnt(4)
    ds_read_b64_tr_b16 v[192:193], v12 offset:4096
    ds_read_b64_tr_b16 v[194:195], v12 offset:4608
    ds_read_b64_tr_b16 v[196:197], v13 offset:4096
    ds_read_b64_tr_b16 v[198:199], v13 offset:4608
    v_mfma_f32_32x32x16_bf16 v[144:159], v[204:207], v[216:219], v[144:159]
    s_add_u32 m0, s28, 2048
    s_nop 0
    buffer_load_dwordx4 v10, s[4:7], s29 offen lds
    s_add_u32 s29, s29, 24576
    v_mfma_f32_32x32x16_bf16 v[160:175], v[200:203], v[220:223], v[160:175]
    s_add_u32 m0, s28, 3072
    s_nop 0
    buffer_load_dwordx4 v10, s[4:7], s29 offen lds
    s_add_u32 s29, s29, 24576
    v_mfma_f32_32x32x16_bf16 v[176:191], v[204:207], v[220:223], v[176:191]
    s_waitcnt lgkmcnt(0)
    ds_read_b128 v[216:219], v19 offset:27648
    ds_read_b128 v[220:223], v19 offset:60416
    v_mfma_f32_32x32x16_bf16 v[128:143], v[192:195], v[208:211], v[128:143]
    s_waitcnt vmcnt(4)
    ds_read_b64_tr_b16 v[200:201], v12 offset:6144
    ds_read_b64_tr_b16 v[202:203], v12 offset:6656
    ds_read_b64_tr_b16 v[204:205], v13 offset:6144
    ds_read_b64_tr_b16 v[206:207], v13 offset:6656
    v_mfma_f32_32x32x16_bf16 v[144:159], v[196:199], v[208:211], v[144:159]
    s_add_u32 m0, s28, 4096
    s_nop 0
    buffer_load_dwordx4 v10, s[4:7], s29 offen lds
    s_add_u32 s29, s29, 24576
    v_mfma_f32_32x32x16_bf16 v[160:175], v[192:195], v[212:215], v[160:175]
    s_add_u32 m0, s28, 5120
    s_nop 0
    buffer_load_dwordx4 v10, s[4:7], s29 offen lds
    s_add_u32 s29, s29, 24576
    v_mfma_f32_32x32x16_bf16 v[176:191], v[196:199], v[212:215], v[176:191]
    s_waitcnt lgkmcnt(0)
    ds_read_b128 v[208:211], v16 offset:28672
    ds_read_b128 v[212:215], v16 offset:61440
    v_mfma_f32_32x32x16_bf16 v[128:143], v[200:203], v[216:219], v[128:143]
    s_waitcnt vmcnt(4)
    ds_read_b64_tr_b16 v[192:193], v12 offset:0
    ds_read_b64_tr_b16 v[194:195], v12 offset:512
    ds_read_b64_tr_b16 v[196:197], v13 offset:0
    ds_read_b64_tr_b16 v[198:199], v13 offset:512
    v_mfma_f32_32x32x16_bf16 v[144:159], v[204:207], v[216:219], v[144:159]
    s_add_u32 m0, s28, 6144
    s_nop 0
    buffer_load_dwordx4 v10, s[4:7], s29 offen lds
    s_add_u32 s29, s29, 24576
    v_mfma_f32_32x32x16_bf16 v[160:175], v[200:203], v[220:223], v[160:175]
    s_add_u32 m0, s28, 7168
    s_nop 0
    buffer_load_dwordx4 v10, s[4:7], s29 offen lds
    s_add_u32 s29, s29, 24576
    v_mfma_f32_32x32x16_bf16 v[176:191], v[204:207], v[220:223], v[176:191]
    s_waitcnt lgkmcnt(0)
    ds_read_b128 v[216:219], v17 offset:29696
    ds_read_b128 v[220:223], v17 offset:62464
    v_mfma_f32_32x32x16_bf16 v[128:143], v[192:195], v[208:211], v[128:143]
    s_waitcnt vmcnt(4)
    ds_read_b64_tr_b16 v[200:201], v12 offset:2048
    ds_read_b64_tr_b16 v[202:203], v12 offset:2560
    ds_read_b64_tr_b16 v[204:205], v13 offset:2048
    ds_read_b64_tr_b16 v[206:207], v13 offset:2560
    v_mfma_f32_32x32x16_bf16 v[144:159], v[196:199], v[208:211], v[144:159]
    v_mfma_f32_32x32x16_bf16 v[160:175], v[192:195], v[212:215], v[160:175]
    v_mfma_f32_32x32x16_bf16 v[176:191], v[196:199], v[212:215], v[176:191]
    s_waitcnt lgkmcnt(0)
    ds_read_b128 v[208:211], v18 offset:30720
    ds_read_b128 v[212:215], v18 offset:63488
    v_mfma_f32_32x32x16_bf16 v[128:143], v[200:203], v[216:219], v[128:143]
    s_waitcnt vmcnt(2)
    ds_read_b64_tr_b16 v[192:193], v12 offset:4096
    ds_read_b64_tr_b16 v[194:195], v12 offset:4608
    ds_read_b64_tr_b16 v[196:197], v13 offset:4096
    ds_read_b64_tr_b16 v[198:199], v13 offset:4608
    v_mfma_f32_32x32x16_bf16 v[144:159], v[204:207], v[216:219], v[144:159]
    v_mfma_f32_32x32x16_bf16 v[160:175], v[200:203], v[220:223], v[160:175]
    v_mfma_f32_32x32x16_bf16 v[176:191], v[204:207], v[220:223], v[176:191]
    s_waitcnt lgkmcnt(0)
    ds_read_b128 v[216:219], v19 offset:31744
    ds_read_b128 v[220:223], v19 offset:64512
    v_mfma_f32_32x32x16_bf16 v[128:143], v[192:195], v[208:211], v[128:143]
    s_waitcnt vmcnt(0)
    ds_read_b64_tr_b16 v[200:201], v12 offset:6144
    ds_read_b64_tr_b16 v[202:203], v12 offset:6656
    ds_read_b64_tr_b16 v[204:205], v13 offset:6144
    ds_read_b64_tr_b16 v[206:207], v13 offset:6656
    v_mfma_f32_32x32x16_bf16 v[144:159], v[196:199], v[208:211], v[144:159]
    v_mfma_f32_32x32x16_bf16 v[160:175], v[192:195], v[212:215], v[160:175]
    v_mfma_f32_32x32x16_bf16 v[176:191], v[196:199], v[212:215], v[176:191]
    s_waitcnt lgkmcnt(0)
    v_mfma_f32_32x32x16_bf16 v[128:143], v[200:203], v[216:219], v[128:143]
    v_mfma_f32_32x32x16_bf16 v[144:159], v[204:207], v[216:219], v[144:159]
    v_mfma_f32_32x32x16_bf16 v[160:175], v[200:203], v[220:223], v[160:175]
    v_mfma_f32_32x32x16_bf16 v[176:191], v[204:207], v[220:223], v[176:191]
    s_mov_b32 s31, 0x3eb8aa3b
    v_add_u32 v2, 81920, v20
    s_nop 6
    v_mul_f32 v128, s31, v128
    v_mul_f32 v129, s31, v129
    v_mul_f32 v130, s31, v130
    v_mul_f32 v131, s31, v131
    v_mul_f32 v132, s31, v132
    v_mul_f32 v133, s31, v133
    v_mul_f32 v134, s31, v134
    v_mul_f32 v135, s31, v135
    v_cvt_pk_bf16_f32 v224, v128, v129
    v_cvt_pk_bf16_f32 v225, v130, v131
    v_cvt_pk_bf16_f32 v226, v132, v133
    v_cvt_pk_bf16_f32 v227, v134, v135
    ds_write_b128 v2, v[224:227] offset:0
    v_mul_f32 v160, s31, v160
    v_mul_f32 v161, s31, v161
    v_mul_f32 v162, s31, v162
    v_mul_f32 v163, s31, v163
    v_mul_f32 v164, s31, v164
    v_mul_f32 v165, s31, v165
    v_mul_f32 v166, s31, v166
    v_mul_f32 v167, s31, v167
    v_cvt_pk_bf16_f32 v228, v160, v161
    v_cvt_pk_bf16_f32 v229, v162, v163
    v_cvt_pk_bf16_f32 v230, v164, v165
    v_cvt_pk_bf16_f32 v231, v166, v167
    ds_write_b128 v2, v[228:231] offset:1024
    v_mul_f32 v136, s31, v136
    v_mul_f32 v137, s31, v137
    v_mul_f32 v138, s31, v138
    v_mul_f32 v139, s31, v139
    v_mul_f32 v140, s31, v140
    v_mul_f32 v141, s31, v141
    v_mul_f32 v142, s31, v142
    v_mul_f32 v143, s31, v143
    v_cvt_pk_bf16_f32 v232, v136, v137
    v_cvt_pk_bf16_f32 v233, v138, v139
    v_cvt_pk_bf16_f32 v234, v140, v141
    v_cvt_pk_bf16_f32 v235, v142, v143
    ds_write_b128 v2, v[232:235] offset:2048
    v_mul_f32 v168, s31, v168
    v_mul_f32 v169, s31, v169
    v_mul_f32 v170, s31, v170
    v_mul_f32 v171, s31, v171
    v_mul_f32 v172, s31, v172
    v_mul_f32 v173, s31, v173
    v_mul_f32 v174, s31, v174
    v_mul_f32 v175, s31, v175
    v_cvt_pk_bf16_f32 v236, v168, v169
    v_cvt_pk_bf16_f32 v237, v170, v171
    v_cvt_pk_bf16_f32 v238, v172, v173
    v_cvt_pk_bf16_f32 v239, v174, v175
    ds_write_b128 v2, v[236:239] offset:3072
    v_mul_f32 v144, s31, v144
    v_mul_f32 v145, s31, v145
    v_mul_f32 v146, s31, v146
    v_mul_f32 v147, s31, v147
    v_mul_f32 v148, s31, v148
    v_mul_f32 v149, s31, v149
    v_mul_f32 v150, s31, v150
    v_mul_f32 v151, s31, v151
    v_cvt_pk_bf16_f32 v240, v144, v145
    v_cvt_pk_bf16_f32 v241, v146, v147
    v_cvt_pk_bf16_f32 v242, v148, v149
    v_cvt_pk_bf16_f32 v243, v150, v151
    ds_write_b128 v2, v[240:243] offset:4096
    v_mul_f32 v176, s31, v176
    v_mul_f32 v177, s31, v177
    v_mul_f32 v178, s31, v178
    v_mul_f32 v179, s31, v179
    v_mul_f32 v180, s31, v180
    v_mul_f32 v181, s31, v181
    v_mul_f32 v182, s31, v182
    v_mul_f32 v183, s31, v183
    v_cvt_pk_bf16_f32 v244, v176, v177
    v_cvt_pk_bf16_f32 v245, v178, v179
    v_cvt_pk_bf16_f32 v246, v180, v181
    v_cvt_pk_bf16_f32 v247, v182, v183
    ds_write_b128 v2, v[244:247] offset:5120
    v_mul_f32 v152, s31, v152
    v_mul_f32 v153, s31, v153
    v_mul_f32 v154, s31, v154
    v_mul_f32 v155, s31, v155
    v_mul_f32 v156, s31, v156
    v_mul_f32 v157, s31, v157
    v_mul_f32 v158, s31, v158
    v_mul_f32 v159, s31, v159
    v_cvt_pk_bf16_f32 v248, v152, v153
    v_cvt_pk_bf16_f32 v249, v154, v155
    v_cvt_pk_bf16_f32 v250, v156, v157
    v_cvt_pk_bf16_f32 v251, v158, v159
    ds_write_b128 v2, v[248:251] offset:6144
    v_mul_f32 v184, s31, v184
    v_mul_f32 v185, s31, v185
    v_mul_f32 v186, s31, v186
    v_mul_f32 v187, s31, v187
    v_mul_f32 v188, s31, v188
    v_mul_f32 v189, s31, v189
    v_mul_f32 v190, s31, v190
    v_mul_f32 v191, s31, v191
    v_cvt_pk_bf16_f32 v252, v184, v185
    v_cvt_pk_bf16_f32 v253, v186, v187
    v_cvt_pk_bf16_f32 v254, v188, v189
    v_cvt_pk_bf16_f32 v255, v190, v191
    ds_write_b128 v2, v[252:255] offset:7168
    s_waitcnt lgkmcnt(0)
    s_mov_b64 exec, 1
    v_mov_b32 v2, 159760
    v_mov_b32 v3, 1
    ds_add_u32 v2, v3
    s_mov_b64 exec, -1
    s_mov_b64 exec, 1
    v_mov_b32 v2, 159748
    v_mov_b32 v3, 1
    ds_add_u32 v2, v3
    s_mov_b64 exec, -1
    s_branch Y_AWAIT
Y_POLLER:
    s_mov_b32 s98, 0
Y_NF:
    v_mov_b32 v2, 0
    global_load_dwordx2 v[4:5], v2, s[44:45] sc1
    s_waitcnt vmcnt(0)
    v_readfirstlane_b32 s2, v4
    v_readfirstlane_b32 s3, v5
    s_cmp_lg_u32 s2, 0
    s_cbranch_scc1 Y_NF_OK
    s_sleep 4
    s_add_u32 s98, s98, 1
    s_cmp_lt_u32 s98, 0x40000
    s_cbranch_scc1 Y_NF
    s_mov_b32 s2, 1
Y_NF_OK:
    s_mov_b64 exec, 1
    v_mov_b32 v2, 159800
    v_mov_b32 v4, s2
    v_mov_b32 v5, s3
    ds_write_b64 v2, v[4:5]
    s_mov_b64 exec, -1
Y_AWAIT:
    s_setprio 1
    v_lshlrev_b32 v9, 4, v8
    v_lshrrev_b32 v2, 5, v1
    v_lshlrev_b32 v21, 8, v2
    v_and_b32 v2, 15, v1
    v_lshl_add_u32 v21, v2, 4, v21
    v_and_b32 v2, 27, v1
    v_mov_b32 v152, 0x3f803f80
    v_cmp_eq_u32 vcc, 16, v2
    s_nop 1
    v_cndmask_b32 v152, 0, v152, vcc
    v_mov_b32 v153, v152
    v_mov_b32 v154, v152
    v_mov_b32 v155, v152
    v_mov_b32 v156, v152
    v_mov_b32 v157, v152
    v_mov_b32 v158, v152
    v_mov_b32 v159, v152
    v_mov_b32 v160, v152
    v_mov_b32 v161, v152
    v_mov_b32 v162, v152
    v_mov_b32 v163, v152
    v_mov_b32 v164, v152
    v_mov_b32 v165, v152
    v_mov_b32 v166, v152
    v_mov_b32 v167, v152
    v_mov_b32 v168, v152
    v_mov_b32 v169, v152
    v_mov_b32 v170, v152
    v_mov_b32 v171, v152
    v_mov_b32 v172, v152
    v_mov_b32 v173, v152
    v_mov_b32 v174, v152
    v_mov_b32 v175, v152
    v_mov_b32 v176, v152
    v_mov_b32 v177, v152
    v_mov_b32 v178, v152
    v_mov_b32 v179, v152
    v_mov_b32 v180, v152
    v_mov_b32 v181, v152
    v_mov_b32 v182, v152
    v_mov_b32 v183, v152
    v_mov_b32 v2, 159800
Y_ANC:
    ds_read_b64 v[4:5], v2
    s_waitcnt lgkmcnt(0)
    v_readfirstlane_b32 s2, v4
    v_readfirstlane_b32 s3, v5
    s_cmp_lg_u32 s2, 0
    s_cbranch_scc1 Y_ANC_OK
    s_sleep 1
    s_branch Y_ANC
Y_ANC_OK:
    v_mov_b32 v2, 159748
Y_SPIN:
    ds_read_b32 v3, v2
    s_waitcnt lgkmcnt(0)
    v_readfirstlane_b32 s46, v3
    s_nop 0
    s_cmp_ge_u32 s46, 3
    s_cbranch_scc1 Y_SPIN_OK
    s_sleep 4
    s_branch Y_SPIN
Y_SPIN_OK:
    s_mov_b32 s19, s16
    s_lshl_b32 s21, s18, 2
    s_add_u32 s21, s21, s19
    s_lshl_b32 s21, s21, 16
    s_add_u32 s21, s21, 4194304
    s_lshl_b32 s22, s17, 11
    s_mov_b32 s74, 1
    s_mov_b32 s75, 1
    s_mov_b32 s76, 0x0000ffff
    s_mov_b32 s77, 0x0000ffff
    s_add_u32 s46, s21, 0
    s_add_u32 s8, s40, s46
    s_addc_u32 s9, s41, 0
    s_mov_b32 s10, 131072
    s_mov_b32 s11, 0x00020000
    s_add_u32 s46, s21, 2097152
    s_add_u32 s12, s40, s46
    s_addc_u32 s13, s41, 0
    s_mov_b32 s14, 131072
    s_mov_b32 s15, 0x00020000
    s_lshl_b32 s46, s19, 11
    s_add_u32 s47, s46, 81920
    v_add_u32 v2, s47, v20
    ds_read_b128 v[24:27], v2
    ds_read_b128 v[28:31], v2 offset:1024
    s_add_u32 s47, s46, 65536
    v_add_u32 v2, s47, v20
    ds_read_b128 v[136:139], v2
    ds_read_b128 v[140:143], v2 offset:1024
    s_add_u32 s47, s46, 73728
    v_add_u32 v2, s47, v21
    s_mov_b64 exec, s[76:77]
    ds_read_b128 v[152:155], v2 offset:0
    ds_read_b128 v[156:159], v2 offset:512
    ds_read_b128 v[160:163], v2 offset:1024
    ds_read_b128 v[164:167], v2 offset:1536
    s_mov_b64 exec, -1
    v_mov_b32 v96, 0
    v_mov_b32 v97, 0
    v_mov_b32 v98, 0
    v_mov_b32 v99, 0
    v_mov_b32 v100, 0
    v_mov_b32 v101, 0
    v_mov_b32 v102, 0
    v_mov_b32 v103, 0
    v_mov_b32 v104, 0
    v_mov_b32 v105, 0
    v_mov_b32 v106, 0
    v_mov_b32 v107, 0
    v_mov_b32 v108, 0
    v_mov_b32 v109, 0
    v_mov_b32 v110, 0
    v_mov_b32 v111, 0
    v_mov_b32 v112, 0
    v_mov_b32 v113, 0
    v_mov_b32 v114, 0
    v_mov_b32 v115, 0
    v_mov_b32 v116, 0
    v_mov_b32 v117, 0
    v_mov_b32 v118, 0
    v_mov_b32 v119, 0
    v_mov_b32 v120, 0
    v_mov_b32 v121, 0
    v_mov_b32 v122, 0
    v_mov_b32 v123, 0
    v_mov_b32 v124, 0
    v_mov_b32 v125, 0
    v_mov_b32 v126, 0
    v_mov_b32 v127, 0
    s_waitcnt lgkmcnt(0)
    v_mfma_f32_32x32x16_bf16 v[64:79], v[136:139], v[24:27], 0
    v_mfma_f32_32x32x16_bf16 v[80:95], v[140:143], v[24:27], 0
    s_nop 10
    v_max3_f32 v184, v64, v65, v66
    v_max3_f32 v184, v184, v67, v68
    v_max3_f32 v184, v184, v69, v70
    v_max3_f32 v184, v184, v71, v72
    v_max3_f32 v184, v184, v73, v74
    v_max3_f32 v184, v184, v75, v76
    v_max3_f32 v184, v184, v77, v78
    v_max3_f32 v184, v184, v79, v80
    v_max3_f32 v184, v184, v81, v82
    v_max3_f32 v184, v184, v83, v84
    v_max3_f32 v184, v184, v85, v86
    v_max3_f32 v184, v184, v87, v88
    v_max3_f32 v184, v184, v89, v90
    v_max3_f32 v184, v184, v91, v92
    v_max3_f32 v184, v184, v93, v94
    v_max_f32 v184, v184, v95
    v_mov_b32 v185, v184
    s_nop 1
    v_permlane32_swap_b32 v184, v185
    v_max_f32 v184, v184, v185
    v_add_f32 v184, 0x42c00000, v184
    v_sub_f32 v32, 0, v184
    v_mov_b32 v33, v32
    v_mov_b32 v34, v32
    v_mov_b32 v35, v32
    v_mov_b32 v36, v32
    v_mov_b32 v37, v32
    v_mov_b32 v38, v32
    v_mov_b32 v39, v32
    v_mov_b32 v40, v32
    v_mov_b32 v41, v32
    v_mov_b32 v42, v32
    v_mov_b32 v43, v32
    v_mov_b32 v44, v32
    v_mov_b32 v45, v32
    v_mov_b32 v46, v32
    v_mov_b32 v47, v32
    v_mfma_f32_32x32x16_bf16 v[64:79], v[136:139], v[28:31], 0
    v_mfma_f32_32x32x16_bf16 v[80:95], v[140:143], v[28:31], 0
    s_nop 10
    v_max3_f32 v184, v64, v65, v66
    v_max3_f32 v184, v184, v67, v68
    v_max3_f32 v184, v184, v69, v70
    v_max3_f32 v184, v184, v71, v72
    v_max3_f32 v184, v184, v73, v74
    v_max3_f32 v184, v184, v75, v76
    v_max3_f32 v184, v184, v77, v78
    v_max3_f32 v184, v184, v79, v80
    v_max3_f32 v184, v184, v81, v82
    v_max3_f32 v184, v184, v83, v84
    v_max3_f32 v184, v184, v85, v86
    v_max3_f32 v184, v184, v87, v88
    v_max3_f32 v184, v184, v89, v90
    v_max3_f32 v184, v184, v91, v92
    v_max3_f32 v184, v184, v93, v94
    v_max_f32 v184, v184, v95
    v_mov_b32 v185, v184
    s_nop 1
    v_permlane32_swap_b32 v184, v185
    v_max_f32 v184, v184, v185
    v_add_f32 v184, 0x42c00000, v184
    v_sub_f32 v48, 0, v184
    v_mov_b32 v49, v48
    v_mov_b32 v50, v48
    v_mov_b32 v51, v48
    v_mov_b32 v52, v48
    v_mov_b32 v53, v48
    v_mov_b32 v54, v48
    v_mov_b32 v55, v48
    v_mov_b32 v56, v48
    v_mov_b32 v57, v48
    v_mov_b32 v58, v48
    v_mov_b32 v59, v48
    v_mov_b32 v60, v48
    v_mov_b32 v61, v48
    v_mov_b32 v62, v48
    v_mov_b32 v63, v48
    v_mov_b32 v128, 0
    v_mov_b32 v129, 0
    v_mov_b32 v130, 0
    v_mov_b32 v131, 0
    v_mov_b32 v132, 0
    v_mov_b32 v133, 0
    v_mov_b32 v134, 0
    v_mov_b32 v135, 0
    s_andn2_b32 s96, s74, s75
    s_cbranch_scc0 AT_RFP2
AT_BKP2:
    s_ff1_i32_b32 s96, s96
    v_readlane_b32 s23, v9, s96
    s_bitset1_b32 s75, s96
    s_nop 3
    buffer_load_dwordx4 v[144:147], v20, s[8:11], s23 offen
    s_mov_b64 exec, s[76:77]
    buffer_load_dwordx4 v[168:171], v21, s[12:15], s23 offen
    buffer_load_dwordx4 v[172:175], v21, s[12:15], s23 offen offset:512
    s_mov_b64 exec, -1
    s_add_u32 s23, s23, 1024
    buffer_load_dwordx4 v[148:151], v20, s[8:11], s23 offen
    v_mfma_f32_32x32x16_bf16 v[64:79], v[136:139], v[24:27], v[32:47]
    s_mov_b32 s26, 0
    s_nop 7
AT_LOOP:
    v_mfma_f32_32x32x16_bf16 v[112:127], v[176:179], v[128:131], v[112:127]
    s_nop 1
    v_exp_f32 v64, v64
    v_exp_f32 v65, v65
    v_exp_f32 v66, v66
    v_mfma_f32_32x32x16_bf16 v[112:127], v[180:183], v[132:135], v[112:127]
    v_exp_f32 v67, v67
    v_exp_f32 v68, v68
    v_exp_f32 v69, v69
    v_mfma_f32_32x32x16_bf16 v[80:95], v[136:139], v[28:31], v[48:63]
    v_exp_f32 v70, v70
    s_mov_b64 exec, s[76:77]
    buffer_load_dwordx4 v[176:179], v21, s[12:15], s23 offen
    buffer_load_dwordx4 v[180:183], v21, s[12:15], s23 offen offset:512
    s_mov_b64 exec, -1
    v_cvt_pk_bf16_f32 v128, v64, v65
    v_exp_f32 v71, v71
    s_andn2_b32 s96, s74, s75
    v_cvt_pk_bf16_f32 v129, v66, v67
    v_exp_f32 v72, v72
    s_cbranch_scc0 AT_RFL0
AT_BKL0:
    v_cvt_pk_bf16_f32 v130, v68, v69
    v_exp_f32 v73, v73
    s_ff1_i32_b32 s96, s96
    v_exp_f32 v74, v74
    v_readlane_b32 s23, v9, s96
    v_cvt_pk_bf16_f32 v131, v70, v71
    v_exp_f32 v75, v75
    s_bitset1_b32 s75, s96
    v_cvt_pk_bf16_f32 v132, v72, v73
    v_exp_f32 v76, v76
    v_exp_f32 v77, v77
    v_cvt_pk_bf16_f32 v133, v74, v75
    v_exp_f32 v78, v78
    buffer_load_dwordx4 v[136:139], v20, s[8:11], s23 offen
    v_exp_f32 v79, v79
    v_cvt_pk_bf16_f32 v134, v76, v77
    v_cvt_pk_bf16_f32 v135, v78, v79
    s_waitcnt vmcnt(10)
    v_mfma_f32_32x32x16_bf16 v[96:111], v[152:155], v[128:131], v[96:111]
    v_exp_f32 v80, v80
    v_exp_f32 v81, v81
    v_exp_f32 v82, v82
    v_mfma_f32_32x32x16_bf16 v[96:111], v[156:159], v[132:135], v[96:111]
    v_exp_f32 v83, v83
    v_exp_f32 v84, v84
    v_exp_f32 v85, v85
    s_waitcnt vmcnt(9)
    v_mfma_f32_32x32x16_bf16 v[64:79], v[140:143], v[24:27], v[32:47]
    v_exp_f32 v86, v86
    v_cvt_pk_bf16_f32 v128, v80, v81
    v_exp_f32 v87, v87
    v_cvt_pk_bf16_f32 v129, v82, v83
    v_exp_f32 v88, v88
    v_cvt_pk_bf16_f32 v130, v84, v85
    v_exp_f32 v89, v89
    v_exp_f32 v90, v90
    v_cvt_pk_bf16_f32 v131, v86, v87
    v_exp_f32 v91, v91
    v_cvt_pk_bf16_f32 v132, v88, v89
    v_exp_f32 v92, v92
    v_exp_f32 v93, v93
    v_cvt_pk_bf16_f32 v133, v90, v91
    v_exp_f32 v94, v94
    v_exp_f32 v95, v95
    v_cvt_pk_bf16_f32 v134, v92, v93
    v_cvt_pk_bf16_f32 v135, v94, v95
    v_mfma_f32_32x32x16_bf16 v[112:127], v[152:155], v[128:131], v[112:127]
    v_exp_f32 v64, v64
    v_exp_f32 v65, v65
    v_exp_f32 v66, v66
    v_mfma_f32_32x32x16_bf16 v[112:127], v[156:159], v[132:135], v[112:127]
    v_exp_f32 v67, v67
    v_exp_f32 v68, v68
    v_exp_f32 v69, v69
    v_mfma_f32_32x32x16_bf16 v[80:95], v[140:143], v[28:31], v[48:63]
    v_exp_f32 v70, v70
    s_mov_b64 exec, s[76:77]
    buffer_load_dwordx4 v[152:155], v21, s[12:15], s23 offen
    buffer_load_dwordx4 v[156:159], v21, s[12:15], s23 offen offset:512
    s_mov_b64 exec, -1
    v_cvt_pk_bf16_f32 v128, v64, v65
    v_exp_f32 v71, v71
    s_add_u32 s23, s23, 1024
    v_cvt_pk_bf16_f32 v129, v66, v67
    v_exp_f32 v72, v72
    buffer_load_dwordx4 v[140:143], v20, s[8:11], s23 offen
    v_cvt_pk_bf16_f32 v130, v68, v69
    v_exp_f32 v73, v73
    v_exp_f32 v74, v74
    v_cvt_pk_bf16_f32 v131, v70, v71
    v_exp_f32 v75, v75
    v_cvt_pk_bf16_f32 v132, v72, v73
    v_exp_f32 v76, v76
    v_exp_f32 v77, v77
    v_cvt_pk_bf16_f32 v133, v74, v75
    v_exp_f32 v78, v78
    v_exp_f32 v79, v79
    v_cvt_pk_bf16_f32 v134, v76, v77
    v_cvt_pk_bf16_f32 v135, v78, v79
    s_waitcnt vmcnt(10)
    v_mfma_f32_32x32x16_bf16 v[96:111], v[160:163], v[128:131], v[96:111]
    v_exp_f32 v80, v80
    v_exp_f32 v81, v81
    v_exp_f32 v82, v82
    v_mfma_f32_32x32x16_bf16 v[96:111], v[164:167], v[132:135], v[96:111]
    v_exp_f32 v83, v83
    v_exp_f32 v84, v84
    v_exp_f32 v85, v85
    s_waitcnt vmcnt(9)
    v_mfma_f32_32x32x16_bf16 v[64:79], v[144:147], v[24:27], v[32:47]
    v_exp_f32 v86, v86
    v_cvt_pk_bf16_f32 v128, v80, v81
    v_exp_f32 v87, v87
    v_cvt_pk_bf16_f32 v129, v82, v83
    v_exp_f32 v88, v88
    v_cvt_pk_bf16_f32 v130, v84, v85
    v_exp_f32 v89, v89
    v_exp_f32 v90, v90
    v_cvt_pk_bf16_f32 v131, v86, v87
    v_exp_f32 v91, v91
    v_cvt_pk_bf16_f32 v132, v88, v89
    v_exp_f32 v92, v92
    v_exp_f32 v93, v93
    v_cvt_pk_bf16_f32 v133, v90, v91
    v_exp_f32 v94, v94
    v_exp_f32 v95, v95
    v_cvt_pk_bf16_f32 v134, v92, v93
    v_cvt_pk_bf16_f32 v135, v94, v95
    v_mfma_f32_32x32x16_bf16 v[112:127], v[160:163], v[128:131], v[112:127]
    v_exp_f32 v64, v64
    v_exp_f32 v65, v65
    v_exp_f32 v66, v66
    v_mfma_f32_32x32x16_bf16 v[112:127], v[164:167], v[132:135], v[112:127]
    v_exp_f32 v67, v67
    v_exp_f32 v68, v68
    v_exp_f32 v69, v69
    v_mfma_f32_32x32x16_bf16 v[80:95], v[144:147], v[28:31], v[48:63]
    v_exp_f32 v70, v70
    s_mov_b64 exec, s[76:77]
    buffer_load_dwordx4 v[160:163], v21, s[12:15], s23 offen
    buffer_load_dwordx4 v[164:167], v21, s[12:15], s23 offen offset:512
    s_mov_b64 exec, -1
    v_cvt_pk_bf16_f32 v128, v64, v65
    v_exp_f32 v71, v71
    s_andn2_b32 s96, s74, s75
    v_cvt_pk_bf16_f32 v129, v66, v67
    v_exp_f32 v72, v72
    s_cbranch_scc0 AT_RFL2
AT_BKL2:
    v_cvt_pk_bf16_f32 v130, v68, v69
    v_exp_f32 v73, v73
    s_ff1_i32_b32 s96, s96
    v_exp_f32 v74, v74
    v_readlane_b32 s23, v9, s96
    v_cvt_pk_bf16_f32 v131, v70, v71
    v_exp_f32 v75, v75
    s_bitset1_b32 s75, s96
    v_cvt_pk_bf16_f32 v132, v72, v73
    v_exp_f32 v76, v76
    v_exp_f32 v77, v77
    v_cvt_pk_bf16_f32 v133, v74, v75
    v_exp_f32 v78, v78
    buffer_load_dwordx4 v[144:147], v20, s[8:11], s23 offen
    v_exp_f32 v79, v79
    v_cvt_pk_bf16_f32 v134, v76, v77
    v_cvt_pk_bf16_f32 v135, v78, v79
    s_waitcnt vmcnt(10)
    v_mfma_f32_32x32x16_bf16 v[96:111], v[168:171], v[128:131], v[96:111]
    v_exp_f32 v80, v80
    v_exp_f32 v81, v81
    v_exp_f32 v82, v82
    v_mfma_f32_32x32x16_bf16 v[96:111], v[172:175], v[132:135], v[96:111]
    v_exp_f32 v83, v83
    v_exp_f32 v84, v84
    v_exp_f32 v85, v85
    s_waitcnt vmcnt(9)
    v_mfma_f32_32x32x16_bf16 v[64:79], v[148:151], v[24:27], v[32:47]
    v_exp_f32 v86, v86
    v_cvt_pk_bf16_f32 v128, v80, v81
    v_exp_f32 v87, v87
    v_cvt_pk_bf16_f32 v129, v82, v83
    v_exp_f32 v88, v88
    v_cvt_pk_bf16_f32 v130, v84, v85
    v_exp_f32 v89, v89
    v_exp_f32 v90, v90
    v_cvt_pk_bf16_f32 v131, v86, v87
    v_exp_f32 v91, v91
    v_cvt_pk_bf16_f32 v132, v88, v89
    v_exp_f32 v92, v92
    v_exp_f32 v93, v93
    v_cvt_pk_bf16_f32 v133, v90, v91
    v_exp_f32 v94, v94
    v_exp_f32 v95, v95
    v_cvt_pk_bf16_f32 v134, v92, v93
    v_cvt_pk_bf16_f32 v135, v94, v95
    v_mfma_f32_32x32x16_bf16 v[112:127], v[168:171], v[128:131], v[112:127]
    v_exp_f32 v64, v64
    v_exp_f32 v65, v65
    v_exp_f32 v66, v66
    v_mfma_f32_32x32x16_bf16 v[112:127], v[172:175], v[132:135], v[112:127]
    v_exp_f32 v67, v67
    v_exp_f32 v68, v68
    v_exp_f32 v69, v69
    v_mfma_f32_32x32x16_bf16 v[80:95], v[148:151], v[28:31], v[48:63]
    v_exp_f32 v70, v70
    s_mov_b64 exec, s[76:77]
    buffer_load_dwordx4 v[168:171], v21, s[12:15], s23 offen
    buffer_load_dwordx4 v[172:175], v21, s[12:15], s23 offen offset:512
    s_mov_b64 exec, -1
    v_cvt_pk_bf16_f32 v128, v64, v65
    v_exp_f32 v71, v71
    s_add_u32 s23, s23, 1024
    v_cvt_pk_bf16_f32 v129, v66, v67
    v_exp_f32 v72, v72
    buffer_load_dwordx4 v[148:151], v20, s[8:11], s23 offen
    v_cvt_pk_bf16_f32 v130, v68, v69
    v_exp_f32 v73, v73
    v_exp_f32 v74, v74
    v_cvt_pk_bf16_f32 v131, v70, v71
    v_exp_f32 v75, v75
    v_cvt_pk_bf16_f32 v132, v72, v73
    v_exp_f32 v76, v76
    v_exp_f32 v77, v77
    v_cvt_pk_bf16_f32 v133, v74, v75
    v_exp_f32 v78, v78
    v_exp_f32 v79, v79
    v_cvt_pk_bf16_f32 v134, v76, v77
    v_cvt_pk_bf16_f32 v135, v78, v79
    s_waitcnt vmcnt(10)
    v_mfma_f32_32x32x16_bf16 v[96:111], v[176:179], v[128:131], v[96:111]
    v_exp_f32 v80, v80
    v_exp_f32 v81, v81
    v_exp_f32 v82, v82
    v_mfma_f32_32x32x16_bf16 v[96:111], v[180:183], v[132:135], v[96:111]
    v_exp_f32 v83, v83
    v_exp_f32 v84, v84
    v_exp_f32 v85, v85
    s_waitcnt vmcnt(9)
    v_mfma_f32_32x32x16_bf16 v[64:79], v[136:139], v[24:27], v[32:47]
    v_exp_f32 v86, v86
    v_cvt_pk_bf16_f32 v128, v80, v81
    v_exp_f32 v87, v87
    v_cvt_pk_bf16_f32 v129, v82, v83
    v_exp_f32 v88, v88
    v_cvt_pk_bf16_f32 v130, v84, v85
    v_exp_f32 v89, v89
    v_exp_f32 v90, v90
    v_cvt_pk_bf16_f32 v131, v86, v87
    v_exp_f32 v91, v91
    v_cvt_pk_bf16_f32 v132, v88, v89
    v_exp_f32 v92, v92
    v_exp_f32 v93, v93
    v_cvt_pk_bf16_f32 v133, v90, v91
    v_exp_f32 v94, v94
    v_exp_f32 v95, v95
    v_cvt_pk_bf16_f32 v134, v92, v93
    v_cvt_pk_bf16_f32 v135, v94, v95
    s_add_u32 s26, s26, 1
    s_cmp_lt_u32 s26, 15
    s_cbranch_scc1 AT_LOOP
    v_mfma_f32_32x32x16_bf16 v[112:127], v[176:179], v[128:131], v[112:127]
    v_exp_f32 v64, v64
    v_exp_f32 v65, v65
    v_exp_f32 v66, v66
    v_mfma_f32_32x32x16_bf16 v[112:127], v[180:183], v[132:135], v[112:127]
    v_exp_f32 v67, v67
    v_exp_f32 v68, v68
    v_exp_f32 v69, v69
    v_mfma_f32_32x32x16_bf16 v[80:95], v[136:139], v[28:31], v[48:63]
    v_exp_f32 v70, v70
    s_mov_b64 exec, s[76:77]
    buffer_load_dwordx4 v[176:179], v21, s[12:15], s23 offen
    buffer_load_dwordx4 v[180:183], v21, s[12:15], s23 offen offset:512
    s_mov_b64 exec, -1
    v_cvt_pk_bf16_f32 v128, v64, v65
    v_exp_f32 v71, v71
    v_cvt_pk_bf16_f32 v129, v66, v67
    v_exp_f32 v72, v72
    v_cvt_pk_bf16_f32 v130, v68, v69
    v_exp_f32 v73, v73
    v_exp_f32 v74, v74
    v_cvt_pk_bf16_f32 v131, v70, v71
    v_exp_f32 v75, v75
    v_cvt_pk_bf16_f32 v132, v72, v73
    v_exp_f32 v76, v76
    v_exp_f32 v77, v77
    v_cvt_pk_bf16_f32 v133, v74, v75
    v_exp_f32 v78, v78
    v_exp_f32 v79, v79
    v_cvt_pk_bf16_f32 v134, v76, v77
    v_cvt_pk_bf16_f32 v135, v78, v79
    s_waitcnt vmcnt(9)
    v_mfma_f32_32x32x16_bf16 v[96:111], v[152:155], v[128:131], v[96:111]
    v_exp_f32 v80, v80
    v_exp_f32 v81, v81
    v_exp_f32 v82, v82
    v_mfma_f32_32x32x16_bf16 v[96:111], v[156:159], v[132:135], v[96:111]
    v_exp_f32 v83, v83
    v_exp_f32 v84, v84
    v_exp_f32 v85, v85
    s_waitcnt vmcnt(8)
    v_mfma_f32_32x32x16_bf16 v[64:79], v[140:143], v[24:27], v[32:47]
    v_exp_f32 v86, v86
    v_cvt_pk_bf16_f32 v128, v80, v81
    v_exp_f32 v87, v87
    v_cvt_pk_bf16_f32 v129, v82, v83
    v_exp_f32 v88, v88
    v_cvt_pk_bf16_f32 v130, v84, v85
    v_exp_f32 v89, v89
    v_exp_f32 v90, v90
    v_cvt_pk_bf16_f32 v131, v86, v87
    v_exp_f32 v91, v91
    v_cvt_pk_bf16_f32 v132, v88, v89
    v_exp_f32 v92, v92
    v_exp_f32 v93, v93
    v_cvt_pk_bf16_f32 v133, v90, v91
    v_exp_f32 v94, v94
    v_exp_f32 v95, v95
    v_cvt_pk_bf16_f32 v134, v92, v93
    v_cvt_pk_bf16_f32 v135, v94, v95
    v_mfma_f32_32x32x16_bf16 v[112:127], v[152:155], v[128:131], v[112:127]
    v_exp_f32 v64, v64
    v_exp_f32 v65, v65
    v_exp_f32 v66, v66
    v_mfma_f32_32x32x16_bf16 v[112:127], v[156:159], v[132:135], v[112:127]
    v_exp_f32 v67, v67
    v_exp_f32 v68, v68
    v_exp_f32 v69, v69
    v_mfma_f32_32x32x16_bf16 v[80:95], v[140:143], v[28:31], v[48:63]
    v_exp_f32 v70, v70
    v_cvt_pk_bf16_f32 v128, v64, v65
    v_exp_f32 v71, v71
    v_cvt_pk_bf16_f32 v129, v66, v67
    v_exp_f32 v72, v72
    v_cvt_pk_bf16_f32 v130, v68, v69
    v_exp_f32 v73, v73
    v_exp_f32 v74, v74
    v_cvt_pk_bf16_f32 v131, v70, v71
    v_exp_f32 v75, v75
    v_cvt_pk_bf16_f32 v132, v72, v73
    v_exp_f32 v76, v76
    v_exp_f32 v77, v77
    v_cvt_pk_bf16_f32 v133, v74, v75
    v_exp_f32 v78, v78
    v_exp_f32 v79, v79
    v_cvt_pk_bf16_f32 v134, v76, v77
    v_cvt_pk_bf16_f32 v135, v78, v79
    s_waitcnt vmcnt(6)
    v_mfma_f32_32x32x16_bf16 v[96:111], v[160:163], v[128:131], v[96:111]
    v_exp_f32 v80, v80
    v_exp_f32 v81, v81
    v_exp_f32 v82, v82
    v_mfma_f32_32x32x16_bf16 v[96:111], v[164:167], v[132:135], v[96:111]
    v_exp_f32 v83, v83
    v_exp_f32 v84, v84
    v_exp_f32 v85, v85
    s_waitcnt vmcnt(5)
    v_mfma_f32_32x32x16_bf16 v[64:79], v[144:147], v[24:27], v[32:47]
    v_exp_f32 v86, v86
    v_cvt_pk_bf16_f32 v128, v80, v81
    v_exp_f32 v87, v87
    v_cvt_pk_bf16_f32 v129, v82, v83
    v_exp_f32 v88, v88
    v_cvt_pk_bf16_f32 v130, v84, v85
    v_exp_f32 v89, v89
    v_exp_f32 v90, v90
    v_cvt_pk_bf16_f32 v131, v86, v87
    v_exp_f32 v91, v91
    v_cvt_pk_bf16_f32 v132, v88, v89
    v_exp_f32 v92, v92
    v_exp_f32 v93, v93
    v_cvt_pk_bf16_f32 v133, v90, v91
    v_exp_f32 v94, v94
    v_exp_f32 v95, v95
    v_cvt_pk_bf16_f32 v134, v92, v93
    v_cvt_pk_bf16_f32 v135, v94, v95
    v_mfma_f32_32x32x16_bf16 v[112:127], v[160:163], v[128:131], v[112:127]
    v_exp_f32 v64, v64
    v_exp_f32 v65, v65
    v_exp_f32 v66, v66
    v_mfma_f32_32x32x16_bf16 v[112:127], v[164:167], v[132:135], v[112:127]
    v_exp_f32 v67, v67
    v_exp_f32 v68, v68
    v_exp_f32 v69, v69
    v_mfma_f32_32x32x16_bf16 v[80:95], v[144:147], v[28:31], v[48:63]
    v_exp_f32 v70, v70
    v_cvt_pk_bf16_f32 v128, v64, v65
    v_exp_f32 v71, v71
    v_cvt_pk_bf16_f32 v129, v66, v67
    v_exp_f32 v72, v72
    v_cvt_pk_bf16_f32 v130, v68, v69
    v_exp_f32 v73, v73
    v_exp_f32 v74, v74
    v_cvt_pk_bf16_f32 v131, v70, v71
    v_exp_f32 v75, v75
    v_cvt_pk_bf16_f32 v132, v72, v73
    v_exp_f32 v76, v76
    v_exp_f32 v77, v77
    v_cvt_pk_bf16_f32 v133, v74, v75
    v_exp_f32 v78, v78
    v_exp_f32 v79, v79
    v_cvt_pk_bf16_f32 v134, v76, v77
    v_cvt_pk_bf16_f32 v135, v78, v79
    s_waitcnt vmcnt(3)
    v_mfma_f32_32x32x16_bf16 v[96:111], v[168:171], v[128:131], v[96:111]
    v_exp_f32 v80, v80
    v_exp_f32 v81, v81
    v_exp_f32 v82, v82
    v_mfma_f32_32x32x16_bf16 v[96:111], v[172:175], v[132:135], v[96:111]
    v_exp_f32 v83, v83
    v_exp_f32 v84, v84
    v_exp_f32 v85, v85
    s_waitcnt vmcnt(2)
    v_mfma_f32_32x32x16_bf16 v[64:79], v[148:151], v[24:27], v[32:47]
    v_exp_f32 v86, v86
    v_cvt_pk_bf16_f32 v128, v80, v81
    v_exp_f32 v87, v87
    v_cvt_pk_bf16_f32 v129, v82, v83
    v_exp_f32 v88, v88
    v_cvt_pk_bf16_f32 v130, v84, v85
    v_exp_f32 v89, v89
    v_exp_f32 v90, v90
    v_cvt_pk_bf16_f32 v131, v86, v87
    v_exp_f32 v91, v91
    v_cvt_pk_bf16_f32 v132, v88, v89
    v_exp_f32 v92, v92
    v_exp_f32 v93, v93
    v_cvt_pk_bf16_f32 v133, v90, v91
    v_exp_f32 v94, v94
    v_exp_f32 v95, v95
    v_cvt_pk_bf16_f32 v134, v92, v93
    v_cvt_pk_bf16_f32 v135, v94, v95
    v_mfma_f32_32x32x16_bf16 v[112:127], v[168:171], v[128:131], v[112:127]
    v_exp_f32 v64, v64
    v_exp_f32 v65, v65
    v_exp_f32 v66, v66
    v_mfma_f32_32x32x16_bf16 v[112:127], v[172:175], v[132:135], v[112:127]
    v_exp_f32 v67, v67
    v_exp_f32 v68, v68
    v_exp_f32 v69, v69
    v_mfma_f32_32x32x16_bf16 v[80:95], v[148:151], v[28:31], v[48:63]
    v_exp_f32 v70, v70
    v_cvt_pk_bf16_f32 v128, v64, v65
    v_exp_f32 v71, v71
    v_cvt_pk_bf16_f32 v129, v66, v67
    v_exp_f32 v72, v72
    v_cvt_pk_bf16_f32 v130, v68, v69
    v_exp_f32 v73, v73
    v_exp_f32 v74, v74
    v_cvt_pk_bf16_f32 v131, v70, v71
    v_exp_f32 v75, v75
    v_cvt_pk_bf16_f32 v132, v72, v73
    v_exp_f32 v76, v76
    v_exp_f32 v77, v77
    v_cvt_pk_bf16_f32 v133, v74, v75
    v_exp_f32 v78, v78
    v_exp_f32 v79, v79
    v_cvt_pk_bf16_f32 v134, v76, v77
    v_cvt_pk_bf16_f32 v135, v78, v79
    s_waitcnt vmcnt(0)
    v_mfma_f32_32x32x16_bf16 v[96:111], v[176:179], v[128:131], v[96:111]
    v_exp_f32 v80, v80
    v_exp_f32 v81, v81
    v_exp_f32 v82, v82
    v_mfma_f32_32x32x16_bf16 v[96:111], v[180:183], v[132:135], v[96:111]
    v_exp_f32 v83, v83
    v_exp_f32 v84, v84
    v_exp_f32 v85, v85
    v_exp_f32 v86, v86
    v_cvt_pk_bf16_f32 v128, v80, v81
    v_exp_f32 v87, v87
    v_cvt_pk_bf16_f32 v129, v82, v83
    v_exp_f32 v88, v88
    v_cvt_pk_bf16_f32 v130, v84, v85
    v_exp_f32 v89, v89
    v_exp_f32 v90, v90
    v_cvt_pk_bf16_f32 v131, v86, v87
    v_exp_f32 v91, v91
    v_cvt_pk_bf16_f32 v132, v88, v89
    v_exp_f32 v92, v92
    v_exp_f32 v93, v93
    v_cvt_pk_bf16_f32 v133, v90, v91
    v_exp_f32 v94, v94
    v_exp_f32 v95, v95
    v_cvt_pk_bf16_f32 v134, v92, v93
    v_cvt_pk_bf16_f32 v135, v94, v95
    s_nop 1
    v_mfma_f32_32x32x16_bf16 v[112:127], v[176:179], v[128:131], v[112:127]
    v_mfma_f32_32x32x16_bf16 v[112:127], v[180:183], v[132:135], v[112:127]
    s_nop 15
    s_mov_b32 s46, 0x207
    s_mov_b32 s47, 0x2ff
    v_mov_b32 v80, v96
    v_mov_b32 v81, v97
    v_mov_b32 v82, v98
    v_mov_b32 v83, v99
    v_mov_b32 v84, v100
    v_mov_b32 v85, v101
    v_mov_b32 v86, v102
    v_mov_b32 v87, v103
    v_mov_b32 v88, v104
    v_cmp_class_f32 s[78:79], v88, s47
    v_cmp_class_f32 vcc, v80, s46
    s_nop 0
    s_or_b64 s[78:79], s[78:79], vcc
    v_cmp_class_f32 vcc, v81, s46
    s_nop 0
    s_or_b64 s[78:79], s[78:79], vcc
    v_cmp_class_f32 vcc, v82, s46
    s_nop 0
    s_or_b64 s[78:79], s[78:79], vcc
    v_cmp_class_f32 vcc, v83, s46
    s_nop 0
    s_or_b64 s[78:79], s[78:79], vcc
    v_cmp_class_f32 vcc, v84, s46
    s_nop 0
    s_or_b64 s[78:79], s[78:79], vcc
    v_cmp_class_f32 vcc, v85, s46
    s_nop 0
    s_or_b64 s[78:79], s[78:79], vcc
    v_cmp_class_f32 vcc, v86, s46
    s_nop 0
    s_or_b64 s[78:79], s[78:79], vcc
    v_cmp_class_f32 vcc, v87, s46
    s_nop 0
    s_or_b64 s[78:79], s[78:79], vcc
    s_cmp_lg_u64 s[78:79], 0
    s_cbranch_scc1 AT_SLOW0
AT_OUT0:
    v_rcp_f32 v48, v88
    s_nop 0
    v_mul_f32 v80, v80, v48
    v_mul_f32 v81, v81, v48
    v_mul_f32 v82, v82, v48
    v_mul_f32 v83, v83, v48
    v_mul_f32 v84, v84, v48
    v_mul_f32 v85, v85, v48
    v_mul_f32 v86, v86, v48
    v_mul_f32 v87, v87, v48
    v_cvt_pk_bf16_f32 v176, v80, v81
    v_cvt_pk_bf16_f32 v177, v82, v83
    v_cvt_pk_bf16_f32 v178, v84, v85
    v_cvt_pk_bf16_f32 v179, v86, v87
    s_lshl_b32 s46, s17, 1
    s_add_u32 s46, s46, 0
    s_lshl_b32 s46, s46, 15
    s_lshl_b32 s47, s18, 2
    s_add_u32 s47, s47, s19
    s_lshl_b32 s47, s47, 10
    s_add_u32 s46, s46, s47
    s_add_u32 s46, s46, 8388608
    buffer_store_dwordx4 v[176:179], v20, s[40:43], s46 offen sc1
    s_mov_b32 s46, 0x207
    s_mov_b32 s47, 0x2ff
    v_mov_b32 v80, v112
    v_mov_b32 v81, v113
    v_mov_b32 v82, v114
    v_mov_b32 v83, v115
    v_mov_b32 v84, v116
    v_mov_b32 v85, v117
    v_mov_b32 v86, v118
    v_mov_b32 v87, v119
    v_mov_b32 v88, v120
    v_cmp_class_f32 s[78:79], v88, s47
    v_cmp_class_f32 vcc, v80, s46
    s_nop 0
    s_or_b64 s[78:79], s[78:79], vcc
    v_cmp_class_f32 vcc, v81, s46
    s_nop 0
    s_or_b64 s[78:79], s[78:79], vcc
    v_cmp_class_f32 vcc, v82, s46
    s_nop 0
    s_or_b64 s[78:79], s[78:79], vcc
    v_cmp_class_f32 vcc, v83, s46
    s_nop 0
    s_or_b64 s[78:79], s[78:79], vcc
    v_cmp_class_f32 vcc, v84, s46
    s_nop 0
    s_or_b64 s[78:79], s[78:79], vcc
    v_cmp_class_f32 vcc, v85, s46
    s_nop 0
    s_or_b64 s[78:79], s[78:79], vcc
    v_cmp_class_f32 vcc, v86, s46
    s_nop 0
    s_or_b64 s[78:79], s[78:79], vcc
    v_cmp_class_f32 vcc, v87, s46
    s_nop 0
    s_or_b64 s[78:79], s[78:79], vcc
    s_cmp_lg_u64 s[78:79], 0
    s_cbranch_scc1 AT_SLOW1
AT_OUT1:
    v_rcp_f32 v48, v88
    s_nop 0
    v_mul_f32 v80, v80, v48
    v_mul_f32 v81, v81, v48
    v_mul_f32 v82, v82, v48
    v_mul_f32 v83, v83, v48
    v_mul_f32 v84, v84, v48
    v_mul_f32 v85, v85, v48
    v_mul_f32 v86, v86, v48
    v_mul_f32 v87, v87, v48
    v_cvt_pk_bf16_f32 v180, v80, v81
    v_cvt_pk_bf16_f32 v181, v82, v83
    v_cvt_pk_bf16_f32 v182, v84, v85
    v_cvt_pk_bf16_f32 v183, v86, v87
    s_lshl_b32 s46, s17, 1
    s_add_u32 s46, s46, 1
    s_lshl_b32 s46, s46, 15
    s_lshl_b32 s47, s18, 2
    s_add_u32 s47, s47, s19
    s_lshl_b32 s47, s47, 10
    s_add_u32 s46, s46, s47
    s_add_u32 s46, s46, 8388608
    buffer_store_dwordx4 v[180:183], v20, s[40:43], s46 offen sc1
    s_waitcnt vmcnt(0)
    s_mov_b64 exec, 1
    v_mov_b32 v2, 159788
    v_mov_b32 v3, 1
    ds_add_rtn_u32 v4, v2, v3
    s_waitcnt lgkmcnt(0)
    v_readfirstlane_b32 s46, v4
    s_nop 0
    s_cmp_eq_u32 s46, 3
    s_cbranch_scc0 AT_NOPUB
    s_mov_b32 exec_lo, 0
    s_mov_b32 exec_hi, 1
    v_mov_b32 v4, s2
    v_mov_b32 v5, s3
    buffer_store_dwordx2 v[4:5], v8, s[40:43], s99 offen sc1
    v_mov_b32 v2, 159776
    v_mov_b32 v3, 4
    ds_write_b32 v2, v3
AT_NOPUB:
    s_mov_b64 exec, -1
    s_branch AT_END
AT_RFP2:
    s_mov_b32 s98, 0
AT_RLP2:
    v_mov_b32 v2, 159764
    ds_read_b32 v3, v2
    s_waitcnt lgkmcnt(0)
    v_readfirstlane_b32 s96, v3
    s_nop 0
    s_or_b32 s74, s74, s96
    s_andn2_b32 s96, s74, s75
    s_cbranch_scc1 AT_BKP2
    s_mov_b64 exec, 1
    v_mov_b32 v2, 159808
    v_mov_b32 v3, 1
    ds_wrxchg_rtn_b32 v4, v2, v3
    s_waitcnt lgkmcnt(0)
    v_readfirstlane_b32 s96, v4
    s_mov_b64 exec, -1
    s_cmp_eq_u32 s96, 0
    s_cbranch_scc1 AT_RGP2
    s_sleep 6
    s_branch AT_RCP2
AT_RGP2:
    s_mov_b32 exec_hi, 0
    buffer_load_dwordx2 v[4:5], v8, s[40:43], s99 offen sc1
    s_waitcnt vmcnt(0)
    v_cmp_eq_u64 vcc, s[2:3], v[4:5]
    s_mov_b32 exec_hi, -1
    s_mov_b32 s96, vcc_lo
    s_or_b32 s74, s74, s96
    s_mov_b64 exec, 1
    v_mov_b32 v2, 159764
    v_mov_b32 v3, s96
    ds_or_b32 v2, v3
    s_mov_b64 exec, -1
    s_mov_b64 exec, 1
    v_mov_b32 v2, 159808
    v_mov_b32 v3, 0
    ds_write_b32 v2, v3
    s_mov_b64 exec, -1
    s_andn2_b32 s96, s74, s75
    s_cbranch_scc1 AT_BKP2
    s_sleep 2
AT_RCP2:
    s_add_u32 s98, s98, 1
    s_cmp_lt_u32 s98, 0x40000
    s_cbranch_scc1 AT_RLP2
    s_not_b32 s96, s75
    s_branch AT_BKP2
AT_RFL0:
    s_mov_b32 s98, 0
AT_RLL0:
    v_mov_b32 v2, 159764
    ds_read_b32 v3, v2
    s_waitcnt lgkmcnt(0)
    v_readfirstlane_b32 s96, v3
    s_nop 0
    s_or_b32 s74, s74, s96
    s_andn2_b32 s96, s74, s75
    s_cbranch_scc1 AT_BKL0
    s_mov_b64 exec, 1
    v_mov_b32 v2, 159808
    v_mov_b32 v3, 1
    ds_wrxchg_rtn_b32 v4, v2, v3
    s_waitcnt lgkmcnt(0)
    v_readfirstlane_b32 s96, v4
    s_mov_b64 exec, -1
    s_cmp_eq_u32 s96, 0
    s_cbranch_scc1 AT_RGL0
    s_sleep 6
    s_branch AT_RCL0
AT_RGL0:
    s_mov_b32 exec_hi, 0
    buffer_load_dwordx2 v[4:5], v8, s[40:43], s99 offen sc1
    s_waitcnt vmcnt(0)
    v_cmp_eq_u64 vcc, s[2:3], v[4:5]
    s_mov_b32 exec_hi, -1
    s_mov_b32 s96, vcc_lo
    s_or_b32 s74, s74, s96
    s_mov_b64 exec, 1
    v_mov_b32 v2, 159764
    v_mov_b32 v3, s96
    ds_or_b32 v2, v3
    s_mov_b64 exec, -1
    s_mov_b64 exec, 1
    v_mov_b32 v2, 159808
    v_mov_b32 v3, 0
    ds_write_b32 v2, v3
    s_mov_b64 exec, -1
    s_andn2_b32 s96, s74, s75
    s_cbranch_scc1 AT_BKL0
    s_sleep 2
AT_RCL0:
    s_add_u32 s98, s98, 1
    s_cmp_lt_u32 s98, 0x40000
    s_cbranch_scc1 AT_RLL0
    s_not_b32 s96, s75
    s_branch AT_BKL0
AT_RFL2:
    s_mov_b32 s98, 0
AT_RLL2:
    v_mov_b32 v2, 159764
    ds_read_b32 v3, v2
    s_waitcnt lgkmcnt(0)
    v_readfirstlane_b32 s96, v3
    s_nop 0
    s_or_b32 s74, s74, s96
    s_andn2_b32 s96, s74, s75
    s_cbranch_scc1 AT_BKL2
    s_mov_b64 exec, 1
    v_mov_b32 v2, 159808
    v_mov_b32 v3, 1
    ds_wrxchg_rtn_b32 v4, v2, v3
    s_waitcnt lgkmcnt(0)
    v_readfirstlane_b32 s96, v4
    s_mov_b64 exec, -1
    s_cmp_eq_u32 s96, 0
    s_cbranch_scc1 AT_RGL2
    s_sleep 6
    s_branch AT_RCL2
AT_RGL2:
    s_mov_b32 exec_hi, 0
    buffer_load_dwordx2 v[4:5], v8, s[40:43], s99 offen sc1
    s_waitcnt vmcnt(0)
    v_cmp_eq_u64 vcc, s[2:3], v[4:5]
    s_mov_b32 exec_hi, -1
    s_mov_b32 s96, vcc_lo
    s_or_b32 s74, s74, s96
    s_mov_b64 exec, 1
    v_mov_b32 v2, 159764
    v_mov_b32 v3, s96
    ds_or_b32 v2, v3
    s_mov_b64 exec, -1
    s_mov_b64 exec, 1
    v_mov_b32 v2, 159808
    v_mov_b32 v3, 0
    ds_write_b32 v2, v3
    s_mov_b64 exec, -1
    s_andn2_b32 s96, s74, s75
    s_cbranch_scc1 AT_BKL2
    s_sleep 2
AT_RCL2:
    s_add_u32 s98, s98, 1
    s_cmp_lt_u32 s98, 0x40000
    s_cbranch_scc1 AT_RLL2
    s_not_b32 s96, s75
    s_branch AT_BKL2
AT_SLOW0:
    v_mov_b32 v60, v24
    v_mov_b32 v61, v25
    v_mov_b32 v62, v26
    v_mov_b32 v63, v27
    s_mov_b32 s46, s21
    v_mov_b32 v48, 0xff800000
    s_mov_b32 s26, 0
AT_SL1_0:
    buffer_load_dwordx4 v[136:139], v20, s[40:43], s46 offen sc1
    s_waitcnt vmcnt(0)
    v_mfma_f32_32x32x16_bf16 v[64:79], v[136:139], v[60:63], 0
    s_nop 11
    v_max3_f32 v48, v48, v64, v65
    v_max3_f32 v48, v48, v66, v67
    v_max3_f32 v48, v48, v68, v69
    v_max3_f32 v48, v48, v70, v71
    v_max3_f32 v48, v48, v72, v73
    v_max3_f32 v48, v48, v74, v75
    v_max3_f32 v48, v48, v76, v77
    v_max3_f32 v48, v48, v78, v79
    s_add_u32 s46, s46, 1024
    s_add_u32 s26, s26, 1
    s_cmp_lt_u32 s26, 64
    s_cbranch_scc1 AT_SL1_0
    v_mov_b32 v49, v48
    s_nop 1
    v_permlane32_swap_b32 v48, v49
    v_max_f32 v48, v48, v49
    v_sub_f32 v32, 0, v48
    v_mov_b32 v33, v32
    v_mov_b32 v34, v32
    v_mov_b32 v35, v32
    v_mov_b32 v36, v32
    v_mov_b32 v37, v32
    v_mov_b32 v38, v32
    v_mov_b32 v39, v32
    v_mov_b32 v40, v32
    v_mov_b32 v41, v32
    v_mov_b32 v42, v32
    v_mov_b32 v43, v32
    v_mov_b32 v44, v32
    v_mov_b32 v45, v32
    v_mov_b32 v46, v32
    v_mov_b32 v47, v32
    v_mov_b32 v80, 0
    v_mov_b32 v81, 0
    v_mov_b32 v82, 0
    v_mov_b32 v83, 0
    v_mov_b32 v84, 0
    v_mov_b32 v85, 0
    v_mov_b32 v86, 0
    v_mov_b32 v87, 0
    v_mov_b32 v88, 0
    v_mov_b32 v89, 0
    v_mov_b32 v90, 0
    v_mov_b32 v91, 0
    v_mov_b32 v92, 0
    v_mov_b32 v93, 0
    v_mov_b32 v94, 0
    v_mov_b32 v95, 0
    s_mov_b32 s46, s21
    s_mov_b32 s26, 0
AT_SL2_0:
    buffer_load_dwordx4 v[136:139], v20, s[40:43], s46 offen sc1
    s_add_u32 s47, s46, 2097152
    s_mov_b64 exec, s[76:77]
    buffer_load_dwordx4 v[152:155], v21, s[40:43], s47 offen sc1
    buffer_load_dwordx4 v[156:159], v21, s[40:43], s47 offen offset:512 sc1
    s_mov_b64 exec, -1
    s_waitcnt vmcnt(0)
    v_mfma_f32_32x32x16_bf16 v[64:79], v[136:139], v[60:63], v[32:47]
    s_nop 11
    v_exp_f32 v64, v64
    v_exp_f32 v65, v65
    v_exp_f32 v66, v66
    v_exp_f32 v67, v67
    v_exp_f32 v68, v68
    v_exp_f32 v69, v69
    v_exp_f32 v70, v70
    v_exp_f32 v71, v71
    v_exp_f32 v72, v72
    v_exp_f32 v73, v73
    v_exp_f32 v74, v74
    v_exp_f32 v75, v75
    v_exp_f32 v76, v76
    v_exp_f32 v77, v77
    v_exp_f32 v78, v78
    v_exp_f32 v79, v79
    v_cvt_pk_bf16_f32 v128, v64, v65
    v_cvt_pk_bf16_f32 v129, v66, v67
    v_cvt_pk_bf16_f32 v130, v68, v69
    v_cvt_pk_bf16_f32 v131, v70, v71
    v_cvt_pk_bf16_f32 v132, v72, v73
    v_cvt_pk_bf16_f32 v133, v74, v75
    v_cvt_pk_bf16_f32 v134, v76, v77
    v_cvt_pk_bf16_f32 v135, v78, v79
    v_mfma_f32_32x32x16_bf16 v[80:95], v[152:155], v[128:131], v[80:95]
    s_nop 0
    v_mfma_f32_32x32x16_bf16 v[80:95], v[156:159], v[132:135], v[80:95]
    s_add_u32 s46, s46, 1024
    s_add_u32 s26, s26, 1
    s_cmp_lt_u32 s26, 64
    s_cbranch_scc1 AT_SL2_0
    s_nop 15
    s_branch AT_OUT0
AT_SLOW1:
    v_mov_b32 v60, v28
    v_mov_b32 v61, v29
    v_mov_b32 v62, v30
    v_mov_b32 v63, v31
    s_mov_b32 s46, s21
    v_mov_b32 v48, 0xff800000
    s_mov_b32 s26, 0
AT_SL1_1:
    buffer_load_dwordx4 v[136:139], v20, s[40:43], s46 offen sc1
    s_waitcnt vmcnt(0)
    v_mfma_f32_32x32x16_bf16 v[64:79], v[136:139], v[60:63], 0
    s_nop 11
    v_max3_f32 v48, v48, v64, v65
    v_max3_f32 v48, v48, v66, v67
    v_max3_f32 v48, v48, v68, v69
    v_max3_f32 v48, v48, v70, v71
    v_max3_f32 v48, v48, v72, v73
    v_max3_f32 v48, v48, v74, v75
    v_max3_f32 v48, v48, v76, v77
    v_max3_f32 v48, v48, v78, v79
    s_add_u32 s46, s46, 1024
    s_add_u32 s26, s26, 1
    s_cmp_lt_u32 s26, 64
    s_cbranch_scc1 AT_SL1_1
    v_mov_b32 v49, v48
    s_nop 1
    v_permlane32_swap_b32 v48, v49
    v_max_f32 v48, v48, v49
    v_sub_f32 v32, 0, v48
    v_mov_b32 v33, v32
    v_mov_b32 v34, v32
    v_mov_b32 v35, v32
    v_mov_b32 v36, v32
    v_mov_b32 v37, v32
    v_mov_b32 v38, v32
    v_mov_b32 v39, v32
    v_mov_b32 v40, v32
    v_mov_b32 v41, v32
    v_mov_b32 v42, v32
    v_mov_b32 v43, v32
    v_mov_b32 v44, v32
    v_mov_b32 v45, v32
    v_mov_b32 v46, v32
    v_mov_b32 v47, v32
    v_mov_b32 v80, 0
    v_mov_b32 v81, 0
    v_mov_b32 v82, 0
    v_mov_b32 v83, 0
    v_mov_b32 v84, 0
    v_mov_b32 v85, 0
    v_mov_b32 v86, 0
    v_mov_b32 v87, 0
    v_mov_b32 v88, 0
    v_mov_b32 v89, 0
    v_mov_b32 v90, 0
    v_mov_b32 v91, 0
    v_mov_b32 v92, 0
    v_mov_b32 v93, 0
    v_mov_b32 v94, 0
    v_mov_b32 v95, 0
    s_mov_b32 s46, s21
    s_mov_b32 s26, 0
AT_SL2_1:
    buffer_load_dwordx4 v[136:139], v20, s[40:43], s46 offen sc1
    s_add_u32 s47, s46, 2097152
    s_mov_b64 exec, s[76:77]
    buffer_load_dwordx4 v[152:155], v21, s[40:43], s47 offen sc1
    buffer_load_dwordx4 v[156:159], v21, s[40:43], s47 offen offset:512 sc1
    s_mov_b64 exec, -1
    s_waitcnt vmcnt(0)
    v_mfma_f32_32x32x16_bf16 v[64:79], v[136:139], v[60:63], v[32:47]
    s_nop 11
    v_exp_f32 v64, v64
    v_exp_f32 v65, v65
    v_exp_f32 v66, v66
    v_exp_f32 v67, v67
    v_exp_f32 v68, v68
    v_exp_f32 v69, v69
    v_exp_f32 v70, v70
    v_exp_f32 v71, v71
    v_exp_f32 v72, v72
    v_exp_f32 v73, v73
    v_exp_f32 v74, v74
    v_exp_f32 v75, v75
    v_exp_f32 v76, v76
    v_exp_f32 v77, v77
    v_exp_f32 v78, v78
    v_exp_f32 v79, v79
    v_cvt_pk_bf16_f32 v128, v64, v65
    v_cvt_pk_bf16_f32 v129, v66, v67
    v_cvt_pk_bf16_f32 v130, v68, v69
    v_cvt_pk_bf16_f32 v131, v70, v71
    v_cvt_pk_bf16_f32 v132, v72, v73
    v_cvt_pk_bf16_f32 v133, v74, v75
    v_cvt_pk_bf16_f32 v134, v76, v77
    v_cvt_pk_bf16_f32 v135, v78, v79
    v_mfma_f32_32x32x16_bf16 v[80:95], v[152:155], v[128:131], v[80:95]
    s_nop 0
    v_mfma_f32_32x32x16_bf16 v[80:95], v[156:159], v[132:135], v[80:95]
    s_add_u32 s46, s46, 1024
    s_add_u32 s26, s26, 1
    s_cmp_lt_u32 s26, 64
    s_cbranch_scc1 AT_SL2_1
    s_nop 15
    s_branch AT_OUT1
AT_END:
    s_branch Y_END
Y_G:
    s_setprio 1
    s_and_b32 s22, s18, 1
    s_sub_u32 s21, s16, 4
    s_lshl_b32 s21, s21, 1
    s_add_u32 s21, s21, s22
    s_cmp_eq_u32 s22, 1
    s_cselect_b32 s47, 0, 6
    s_lshl_b32 s22, s22, 6
    s_cmp_eq_u32 s16, 7
    s_cselect_b32 s21, s47, s21
    s_cselect_b32 s22, s22, 0
    v_xor_b32 v12, s22, v12
    s_lshl_b32 s48, s17, 3
    s_add_u32 s48, s48, s18
    s_mul_i32 s48, s48, 28672
    s_lshl_b32 s22, s21, 12
    s_add_u32 s48, s48, s22
    s_add_u32 s48, s48, 10485760
    s_mul_i32 s49, s18, 7
    s_add_u32 s49, s49, s21
    s_cmp_eq_u32 s16, 7
    s_cselect_b32 s73, 1, 3
    s_cselect_b32 s72, 1, 2
    v_mov_b32 v2, 159756
Y_GW:
    ds_read_b32 v3, v2
    s_waitcnt lgkmcnt(0)
    v_readfirstlane_b32 s46, v3
    s_nop 0
    s_cmp_ge_u32 s46, 1
    s_cbranch_scc1 Y_GW_OK
    s_sleep 1
    s_branch Y_GW
Y_GW_OK:
    s_add_u32 s31, s30, 28672
    s_add_u32 m0, s28, 0
    s_nop 0
    buffer_load_dwordx4 v11, s[8:11], s30 offen lds
    s_add_u32 m0, s28, 1024
    s_nop 0
    buffer_load_dwordx4 v11, s[8:11], s31 offen lds
    s_add_u32 m0, s28, 2048
    s_nop 0
    buffer_load_dwordx4 v11, s[12:15], s30 offen lds
    s_add_u32 m0, s28, 3072
    s_nop 0
    buffer_load_dwordx4 v11, s[12:15], s31 offen lds
    s_add_u32 s30, s30, 57344
    s_add_u32 s31, s30, 28672
    s_add_u32 m0, s28, 4096
    s_nop 0
    buffer_load_dwordx4 v11, s[8:11], s30 offen lds
    s_add_u32 m0, s28, 5120
    s_nop 0
    buffer_load_dwordx4 v11, s[8:11], s31 offen lds
    s_add_u32 m0, s28, 6144
    s_nop 0
    buffer_load_dwordx4 v11, s[12:15], s30 offen lds
    s_add_u32 m0, s28, 7168
    s_nop 0
    buffer_load_dwordx4 v11, s[12:15], s31 offen lds
    s_add_u32 s30, s30, 57344
    s_add_u32 s31, s30, 28672
    s_add_u32 m0, s28, 8192
    s_nop 0
    buffer_load_dwordx4 v11, s[8:11], s30 offen lds
    s_add_u32 m0, s28, 9216
    s_nop 0
    buffer_load_dwordx4 v11, s[8:11], s31 offen lds
    s_add_u32 m0, s28, 10240
    s_nop 0
    buffer_load_dwordx4 v11, s[12:15], s30 offen lds
    s_add_u32 m0, s28, 11264
    s_nop 0
    buffer_load_dwordx4 v11, s[12:15], s31 offen lds
    s_add_u32 s30, s30, 57344
    s_add_u32 s31, s30, 28672
    s_add_u32 m0, s28, 12288
    s_nop 0
    buffer_load_dwordx4 v11, s[8:11], s30 offen lds
    s_add_u32 m0, s28, 13312
    s_nop 0
    buffer_load_dwordx4 v11, s[8:11], s31 offen lds
    s_add_u32 m0, s28, 14336
    s_nop 0
    buffer_load_dwordx4 v11, s[12:15], s30 offen lds
    s_add_u32 m0, s28, 15360
    s_nop 0
    buffer_load_dwordx4 v11, s[12:15], s31 offen lds
    s_add_u32 s30, s30, 57344
    s_cmp_eq_u32 s16, 7
    s_cbranch_scc1 Y_G1
    s_waitcnt vmcnt(12)
    ds_read_b64_tr_b16 v[64:65], v12 offset:0
    ds_read_b64_tr_b16 v[66:67], v12 offset:512
    ds_read_b64_tr_b16 v[68:69], v13 offset:0
    ds_read_b64_tr_b16 v[70:71], v13 offset:512
    ds_read_b64_tr_b16 v[72:73], v12 offset:2048
    ds_read_b64_tr_b16 v[74:75], v12 offset:2560
    ds_read_b64_tr_b16 v[76:77], v13 offset:2048
    ds_read_b64_tr_b16 v[78:79], v13 offset:2560
    ds_read_b128 v[96:99], v16 offset:0
    ds_read_b128 v[100:103], v16 offset:32768
    s_waitcnt lgkmcnt(0)
    v_mfma_f32_32x32x16_bf16 v[128:143], v[64:67], v[96:99], 0
    s_waitcnt vmcnt(8)
    ds_read_b64_tr_b16 v[80:81], v12 offset:4096
    ds_read_b64_tr_b16 v[82:83], v12 offset:4608
    ds_read_b64_tr_b16 v[84:85], v13 offset:4096
    ds_read_b64_tr_b16 v[86:87], v13 offset:4608
    v_mfma_f32_32x32x16_bf16 v[144:159], v[68:71], v[96:99], 0
    ds_read_b64_tr_b16 v[88:89], v12 offset:6144
    ds_read_b64_tr_b16 v[90:91], v12 offset:6656
    ds_read_b64_tr_b16 v[92:93], v13 offset:6144
    ds_read_b64_tr_b16 v[94:95], v13 offset:6656
    v_mfma_f32_32x32x16_bf16 v[160:175], v[72:75], v[96:99], 0
    ds_read_b128 v[104:107], v17 offset:1024
    ds_read_b128 v[108:111], v17 offset:33792
    v_mfma_f32_32x32x16_bf16 v[176:191], v[76:79], v[96:99], 0
    s_add_u32 s31, s30, 28672
    s_add_u32 m0, s28, 0
    s_nop 0
    buffer_load_dwordx4 v11, s[8:11], s30 offen lds
    s_add_u32 m0, s28, 1024
    s_nop 0
    buffer_load_dwordx4 v11, s[8:11], s31 offen lds
    s_add_u32 m0, s28, 2048
    s_nop 0
    buffer_load_dwordx4 v11, s[12:15], s30 offen lds
    s_add_u32 m0, s28, 3072
    s_nop 0
    buffer_load_dwordx4 v11, s[12:15], s31 offen lds
    s_add_u32 s30, s30, 57344
    v_mfma_f32_32x32x16_bf16 v[192:207], v[64:67], v[100:103], 0
    v_mfma_f32_32x32x16_bf16 v[208:223], v[68:71], v[100:103], 0
    v_mfma_f32_32x32x16_bf16 v[224:239], v[72:75], v[100:103], 0
    v_mfma_f32_32x32x16_bf16 v[240:255], v[76:79], v[100:103], 0
    s_waitcnt lgkmcnt(0)
    v_mfma_f32_32x32x16_bf16 v[128:143], v[80:83], v[104:107], v[128:143]
    s_waitcnt vmcnt(8)
    ds_read_b64_tr_b16 v[64:65], v12 offset:8192
    ds_read_b64_tr_b16 v[66:67], v12 offset:8704
    ds_read_b64_tr_b16 v[68:69], v13 offset:8192
    ds_read_b64_tr_b16 v[70:71], v13 offset:8704
    v_mfma_f32_32x32x16_bf16 v[144:159], v[84:87], v[104:107], v[144:159]
    ds_read_b64_tr_b16 v[72:73], v12 offset:10240
    ds_read_b64_tr_b16 v[74:75], v12 offset:10752
    ds_read_b64_tr_b16 v[76:77], v13 offset:10240
    ds_read_b64_tr_b16 v[78:79], v13 offset:10752
    v_mfma_f32_32x32x16_bf16 v[160:175], v[88:91], v[104:107], v[160:175]
    ds_read_b128 v[96:99], v18 offset:2048
    ds_read_b128 v[100:103], v18 offset:34816
    v_mfma_f32_32x32x16_bf16 v[176:191], v[92:95], v[104:107], v[176:191]
    s_add_u32 s31, s30, 28672
    s_add_u32 m0, s28, 4096
    s_nop 0
    buffer_load_dwordx4 v11, s[8:11], s30 offen lds
    s_add_u32 m0, s28, 5120
    s_nop 0
    buffer_load_dwordx4 v11, s[8:11], s31 offen lds
    s_add_u32 m0, s28, 6144
    s_nop 0
    buffer_load_dwordx4 v11, s[12:15], s30 offen lds
    s_add_u32 m0, s28, 7168
    s_nop 0
    buffer_load_dwordx4 v11, s[12:15], s31 offen lds
    s_add_u32 s30, s30, 57344
    v_mfma_f32_32x32x16_bf16 v[192:207], v[80:83], v[108:111], v[192:207]
    v_mfma_f32_32x32x16_bf16 v[208:223], v[84:87], v[108:111], v[208:223]
    v_mfma_f32_32x32x16_bf16 v[224:239], v[88:91], v[108:111], v[224:239]
    v_mfma_f32_32x32x16_bf16 v[240:255], v[92:95], v[108:111], v[240:255]
    s_waitcnt lgkmcnt(0)
    v_mfma_f32_32x32x16_bf16 v[128:143], v[64:67], v[96:99], v[128:143]
    s_waitcnt vmcnt(8)
    ds_read_b64_tr_b16 v[80:81], v12 offset:12288
    ds_read_b64_tr_b16 v[82:83], v12 offset:12800
    ds_read_b64_tr_b16 v[84:85], v13 offset:12288
    ds_read_b64_tr_b16 v[86:87], v13 offset:12800
    v_mfma_f32_32x32x16_bf16 v[144:159], v[68:71], v[96:99], v[144:159]
    ds_read_b64_tr_b16 v[88:89], v12 offset:14336
    ds_read_b64_tr_b16 v[90:91], v12 offset:14848
    ds_read_b64_tr_b16 v[92:93], v13 offset:14336
    ds_read_b64_tr_b16 v[94:95], v13 offset:14848
    v_mfma_f32_32x32x16_bf16 v[160:175], v[72:75], v[96:99], v[160:175]
    ds_read_b128 v[104:107], v19 offset:3072
    ds_read_b128 v[108:111], v19 offset:35840
    v_mfma_f32_32x32x16_bf16 v[176:191], v[76:79], v[96:99], v[176:191]
    s_add_u32 s31, s30, 28672
    s_add_u32 m0, s28, 8192
    s_nop 0
    buffer_load_dwordx4 v11, s[8:11], s30 offen lds
    s_add_u32 m0, s28, 9216
    s_nop 0
    buffer_load_dwordx4 v11, s[8:11], s31 offen lds
    s_add_u32 m0, s28, 10240
    s_nop 0
    buffer_load_dwordx4 v11, s[12:15], s30 offen lds
    s_add_u32 m0, s28, 11264
    s_nop 0
    buffer_load_dwordx4 v11, s[12:15], s31 offen lds
    s_add_u32 s30, s30, 57344
    v_mfma_f32_32x32x16_bf16 v[192:207], v[64:67], v[100:103], v[192:207]
    v_mfma_f32_32x32x16_bf16 v[208:223], v[68:71], v[100:103], v[208:223]
    v_mfma_f32_32x32x16_bf16 v[224:239], v[72:75], v[100:103], v[224:239]
    v_mfma_f32_32x32x16_bf16 v[240:255], v[76:79], v[100:103], v[240:255]
    s_waitcnt lgkmcnt(0)
    v_mfma_f32_32x32x16_bf16 v[128:143], v[80:83], v[104:107], v[128:143]
    s_waitcnt vmcnt(8)
    ds_read_b64_tr_b16 v[64:65], v12 offset:0
    ds_read_b64_tr_b16 v[66:67], v12 offset:512
    ds_read_b64_tr_b16 v[68:69], v13 offset:0
    ds_read_b64_tr_b16 v[70:71], v13 offset:512
    v_mfma_f32_32x32x16_bf16 v[144:159], v[84:87], v[104:107], v[144:159]
    ds_read_b64_tr_b16 v[72:73], v12 offset:2048
    ds_read_b64_tr_b16 v[74:75], v12 offset:2560
    ds_read_b64_tr_b16 v[76:77], v13 offset:2048
    ds_read_b64_tr_b16 v[78:79], v13 offset:2560
    v_mfma_f32_32x32x16_bf16 v[160:175], v[88:91], v[104:107], v[160:175]
    ds_read_b128 v[96:99], v16 offset:4096
    ds_read_b128 v[100:103], v16 offset:36864
    v_mfma_f32_32x32x16_bf16 v[176:191], v[92:95], v[104:107], v[176:191]
    s_add_u32 s31, s30, 28672
    s_add_u32 m0, s28, 12288
    s_nop 0
    buffer_load_dwordx4 v11, s[8:11], s30 offen lds
    s_add_u32 m0, s28, 13312
    s_nop 0
    buffer_load_dwordx4 v11, s[8:11], s31 offen lds
    s_add_u32 m0, s28, 14336
    s_nop 0
    buffer_load_dwordx4 v11, s[12:15], s30 offen lds
    s_add_u32 m0, s28, 15360
    s_nop 0
    buffer_load_dwordx4 v11, s[12:15], s31 offen lds
    s_add_u32 s30, s30, 57344
    v_mfma_f32_32x32x16_bf16 v[192:207], v[80:83], v[108:111], v[192:207]
    v_mfma_f32_32x32x16_bf16 v[208:223], v[84:87], v[108:111], v[208:223]
    v_mfma_f32_32x32x16_bf16 v[224:239], v[88:91], v[108:111], v[224:239]
    v_mfma_f32_32x32x16_bf16 v[240:255], v[92:95], v[108:111], v[240:255]
    s_waitcnt lgkmcnt(0)
    v_mfma_f32_32x32x16_bf16 v[128:143], v[64:67], v[96:99], v[128:143]
    s_waitcnt vmcnt(8)
    ds_read_b64_tr_b16 v[80:81], v12 offset:4096
    ds_read_b64_tr_b16 v[82:83], v12 offset:4608
    ds_read_b64_tr_b16 v[84:85], v13 offset:4096
    ds_read_b64_tr_b16 v[86:87], v13 offset:4608
    v_mfma_f32_32x32x16_bf16 v[144:159], v[68:71], v[96:99], v[144:159]
    ds_read_b64_tr_b16 v[88:89], v12 offset:6144
    ds_read_b64_tr_b16 v[90:91], v12 offset:6656
    ds_read_b64_tr_b16 v[92:93], v13 offset:6144
    ds_read_b64_tr_b16 v[94:95], v13 offset:6656
    v_mfma_f32_32x32x16_bf16 v[160:175], v[72:75], v[96:99], v[160:175]
    ds_read_b128 v[104:107], v17 offset:5120
    ds_read_b128 v[108:111], v17 offset:37888
    v_mfma_f32_32x32x16_bf16 v[176:191], v[76:79], v[96:99], v[176:191]
    s_add_u32 s31, s30, 28672
    s_add_u32 m0, s28, 0
    s_nop 0
    buffer_load_dwordx4 v11, s[8:11], s30 offen lds
    s_add_u32 m0, s28, 1024
    s_nop 0
    buffer_load_dwordx4 v11, s[8:11], s31 offen lds
    s_add_u32 m0, s28, 2048
    s_nop 0
    buffer_load_dwordx4 v11, s[12:15], s30 offen lds
    s_add_u32 m0, s28, 3072
    s_nop 0
    buffer_load_dwordx4 v11, s[12:15], s31 offen lds
    s_add_u32 s30, s30, 57344
    v_mfma_f32_32x32x16_bf16 v[192:207], v[64:67], v[100:103], v[192:207]
    v_mfma_f32_32x32x16_bf16 v[208:223], v[68:71], v[100:103], v[208:223]
    v_mfma_f32_32x32x16_bf16 v[224:239], v[72:75], v[100:103], v[224:239]
    v_mfma_f32_32x32x16_bf16 v[240:255], v[76:79], v[100:103], v[240:255]
    s_waitcnt lgkmcnt(0)
    v_mfma_f32_32x32x16_bf16 v[128:143], v[80:83], v[104:107], v[128:143]
    s_waitcnt vmcnt(8)
    ds_read_b64_tr_b16 v[64:65], v12 offset:8192
    ds_read_b64_tr_b16 v[66:67], v12 offset:8704
    ds_read_b64_tr_b16 v[68:69], v13 offset:8192
    ds_read_b64_tr_b16 v[70:71], v13 offset:8704
    v_mfma_f32_32x32x16_bf16 v[144:159], v[84:87], v[104:107], v[144:159]
    ds_read_b64_tr_b16 v[72:73], v12 offset:10240
    ds_read_b64_tr_b16 v[74:75], v12 offset:10752
    ds_read_b64_tr_b16 v[76:77], v13 offset:10240
    ds_read_b64_tr_b16 v[78:79], v13 offset:10752
    v_mfma_f32_32x32x16_bf16 v[160:175], v[88:91], v[104:107], v[160:175]
    ds_read_b128 v[96:99], v18 offset:6144
    ds_read_b128 v[100:103], v18 offset:38912
    v_mfma_f32_32x32x16_bf16 v[176:191], v[92:95], v[104:107], v[176:191]
    s_add_u32 s31, s30, 28672
    s_add_u32 m0, s28, 4096
    s_nop 0
    buffer_load_dwordx4 v11, s[8:11], s30 offen lds
    s_add_u32 m0, s28, 5120
    s_nop 0
    buffer_load_dwordx4 v11, s[8:11], s31 offen lds
    s_add_u32 m0, s28, 6144
    s_nop 0
    buffer_load_dwordx4 v11, s[12:15], s30 offen lds
    s_add_u32 m0, s28, 7168
    s_nop 0
    buffer_load_dwordx4 v11, s[12:15], s31 offen lds
    s_add_u32 s30, s30, 57344
    v_mfma_f32_32x32x16_bf16 v[192:207], v[80:83], v[108:111], v[192:207]
    v_mfma_f32_32x32x16_bf16 v[208:223], v[84:87], v[108:111], v[208:223]
    v_mfma_f32_32x32x16_bf16 v[224:239], v[88:91], v[108:111], v[224:239]
    v_mfma_f32_32x32x16_bf16 v[240:255], v[92:95], v[108:111], v[240:255]
    s_waitcnt lgkmcnt(0)
    v_mfma_f32_32x32x16_bf16 v[128:143], v[64:67], v[96:99], v[128:143]
    s_waitcnt vmcnt(8)
    ds_read_b64_tr_b16 v[80:81], v12 offset:12288
    ds_read_b64_tr_b16 v[82:83], v12 offset:12800
    ds_read_b64_tr_b16 v[84:85], v13 offset:12288
    ds_read_b64_tr_b16 v[86:87], v13 offset:12800
    v_mfma_f32_32x32x16_bf16 v[144:159], v[68:71], v[96:99], v[144:159]
    ds_read_b64_tr_b16 v[88:89], v12 offset:14336
    ds_read_b64_tr_b16 v[90:91], v12 offset:14848
    ds_read_b64_tr_b16 v[92:93], v13 offset:14336
    ds_read_b64_tr_b16 v[94:95], v13 offset:14848
    v_mfma_f32_32x32x16_bf16 v[160:175], v[72:75], v[96:99], v[160:175]
    ds_read_b128 v[104:107], v19 offset:7168
    ds_read_b128 v[108:111], v19 offset:39936
    v_mfma_f32_32x32x16_bf16 v[176:191], v[76:79], v[96:99], v[176:191]
    s_add_u32 s31, s30, 28672
    s_add_u32 m0, s28, 8192
    s_nop 0
    buffer_load_dwordx4 v11, s[8:11], s30 offen lds
    s_add_u32 m0, s28, 9216
    s_nop 0
    buffer_load_dwordx4 v11, s[8:11], s31 offen lds
    s_add_u32 m0, s28, 10240
    s_nop 0
    buffer_load_dwordx4 v11, s[12:15], s30 offen lds
    s_add_u32 m0, s28, 11264
    s_nop 0
    buffer_load_dwordx4 v11, s[12:15], s31 offen lds
    s_add_u32 s30, s30, 57344
    v_mfma_f32_32x32x16_bf16 v[192:207], v[64:67], v[100:103], v[192:207]
    v_mfma_f32_32x32x16_bf16 v[208:223], v[68:71], v[100:103], v[208:223]
    v_mfma_f32_32x32x16_bf16 v[224:239], v[72:75], v[100:103], v[224:239]
    v_mfma_f32_32x32x16_bf16 v[240:255], v[76:79], v[100:103], v[240:255]
    s_waitcnt lgkmcnt(0)
    v_mfma_f32_32x32x16_bf16 v[128:143], v[80:83], v[104:107], v[128:143]
    s_waitcnt vmcnt(8)
    ds_read_b64_tr_b16 v[64:65], v12 offset:0
    ds_read_b64_tr_b16 v[66:67], v12 offset:512
    ds_read_b64_tr_b16 v[68:69], v13 offset:0
    ds_read_b64_tr_b16 v[70:71], v13 offset:512
    v_mfma_f32_32x32x16_bf16 v[144:159], v[84:87], v[104:107], v[144:159]
    ds_read_b64_tr_b16 v[72:73], v12 offset:2048
    ds_read_b64_tr_b16 v[74:75], v12 offset:2560
    ds_read_b64_tr_b16 v[76:77], v13 offset:2048
    ds_read_b64_tr_b16 v[78:79], v13 offset:2560
    v_mfma_f32_32x32x16_bf16 v[160:175], v[88:91], v[104:107], v[160:175]
    ds_read_b128 v[96:99], v16 offset:8192
    ds_read_b128 v[100:103], v16 offset:40960
    v_mfma_f32_32x32x16_bf16 v[176:191], v[92:95], v[104:107], v[176:191]
    s_add_u32 s31, s30, 28672
    s_add_u32 m0, s28, 12288
    s_nop 0
    buffer_load_dwordx4 v11, s[8:11], s30 offen lds
    s_add_u32 m0, s28, 13312
    s_nop 0
    buffer_load_dwordx4 v11, s[8:11], s31 offen lds
    s_add_u32 m0, s28, 14336
    s_nop 0
    buffer_load_dwordx4 v11, s[12:15], s30 offen lds
    s_add_u32 m0, s28, 15360
    s_nop 0
    buffer_load_dwordx4 v11, s[12:15], s31 offen lds
    s_add_u32 s30, s30, 57344
    v_mfma_f32_32x32x16_bf16 v[192:207], v[80:83], v[108:111], v[192:207]
    v_mfma_f32_32x32x16_bf16 v[208:223], v[84:87], v[108:111], v[208:223]
    v_mfma_f32_32x32x16_bf16 v[224:239], v[88:91], v[108:111], v[224:239]
    v_mfma_f32_32x32x16_bf16 v[240:255], v[92:95], v[108:111], v[240:255]
    s_waitcnt lgkmcnt(0)
    v_mfma_f32_32x32x16_bf16 v[128:143], v[64:67], v[96:99], v[128:143]
    s_waitcnt vmcnt(8)
    ds_read_b64_tr_b16 v[80:81], v12 offset:4096
    ds_read_b64_tr_b16 v[82:83], v12 offset:4608
    ds_read_b64_tr_b16 v[84:85], v13 offset:4096
    ds_read_b64_tr_b16 v[86:87], v13 offset:4608
    v_mfma_f32_32x32x16_bf16 v[144:159], v[68:71], v[96:99], v[144:159]
    ds_read_b64_tr_b16 v[88:89], v12 offset:6144
    ds_read_b64_tr_b16 v[90:91], v12 offset:6656
    ds_read_b64_tr_b16 v[92:93], v13 offset:6144
    ds_read_b64_tr_b16 v[94:95], v13 offset:6656
    v_mfma_f32_32x32x16_bf16 v[160:175], v[72:75], v[96:99], v[160:175]
    ds_read_b128 v[104:107], v17 offset:9216
    ds_read_b128 v[108:111], v17 offset:41984
    v_mfma_f32_32x32x16_bf16 v[176:191], v[76:79], v[96:99], v[176:191]
    s_add_u32 s31, s30, 28672
    s_add_u32 m0, s28, 0
    s_nop 0
    buffer_load_dwordx4 v11, s[8:11], s30 offen lds
    s_add_u32 m0, s28, 1024
    s_nop 0
    buffer_load_dwordx4 v11, s[8:11], s31 offen lds
    s_add_u32 m0, s28, 2048
    s_nop 0
    buffer_load_dwordx4 v11, s[12:15], s30 offen lds
    s_add_u32 m0, s28, 3072
    s_nop 0
    buffer_load_dwordx4 v11, s[12:15], s31 offen lds
    s_add_u32 s30, s30, 57344
    v_mfma_f32_32x32x16_bf16 v[192:207], v[64:67], v[100:103], v[192:207]
    v_mfma_f32_32x32x16_bf16 v[208:223], v[68:71], v[100:103], v[208:223]
    v_mfma_f32_32x32x16_bf16 v[224:239], v[72:75], v[100:103], v[224:239]
    v_mfma_f32_32x32x16_bf16 v[240:255], v[76:79], v[100:103], v[240:255]
    s_waitcnt lgkmcnt(0)
    v_mfma_f32_32x32x16_bf16 v[128:143], v[80:83], v[104:107], v[128:143]
    s_waitcnt vmcnt(8)
    ds_read_b64_tr_b16 v[64:65], v12 offset:8192
    ds_read_b64_tr_b16 v[66:67], v12 offset:8704
    ds_read_b64_tr_b16 v[68:69], v13 offset:8192
    ds_read_b64_tr_b16 v[70:71], v13 offset:8704
    v_mfma_f32_32x32x16_bf16 v[144:159], v[84:87], v[104:107], v[144:159]
    ds_read_b64_tr_b16 v[72:73], v12 offset:10240
    ds_read_b64_tr_b16 v[74:75], v12 offset:10752
    ds_read_b64_tr_b16 v[76:77], v13 offset:10240
    ds_read_b64_tr_b16 v[78:79], v13 offset:10752
    v_mfma_f32_32x32x16_bf16 v[160:175], v[88:91], v[104:107], v[160:175]
    ds_read_b128 v[96:99], v18 offset:10240
    ds_read_b128 v[100:103], v18 offset:43008
    v_mfma_f32_32x32x16_bf16 v[176:191], v[92:95], v[104:107], v[176:191]
    s_add_u32 s31, s30, 28672
    s_add_u32 m0, s28, 4096
    s_nop 0
    buffer_load_dwordx4 v11, s[8:11], s30 offen lds
    s_add_u32 m0, s28, 5120
    s_nop 0
    buffer_load_dwordx4 v11, s[8:11], s31 offen lds
    s_add_u32 m0, s28, 6144
    s_nop 0
    buffer_load_dwordx4 v11, s[12:15], s30 offen lds
    s_add_u32 m0, s28, 7168
    s_nop 0
    buffer_load_dwordx4 v11, s[12:15], s31 offen lds
    s_add_u32 s30, s30, 57344
    v_mfma_f32_32x32x16_bf16 v[192:207], v[80:83], v[108:111], v[192:207]
    v_mfma_f32_32x32x16_bf16 v[208:223], v[84:87], v[108:111], v[208:223]
    v_mfma_f32_32x32x16_bf16 v[224:239], v[88:91], v[108:111], v[224:239]
    v_mfma_f32_32x32x16_bf16 v[240:255], v[92:95], v[108:111], v[240:255]
    s_waitcnt lgkmcnt(0)
    v_mfma_f32_32x32x16_bf16 v[128:143], v[64:67], v[96:99], v[128:143]
    s_waitcnt vmcnt(8)
    ds_read_b64_tr_b16 v[80:81], v12 offset:12288
    ds_read_b64_tr_b16 v[82:83], v12 offset:12800
    ds_read_b64_tr_b16 v[84:85], v13 offset:12288
    ds_read_b64_tr_b16 v[86:87], v13 offset:12800
    v_mfma_f32_32x32x16_bf16 v[144:159], v[68:71], v[96:99], v[144:159]
    ds_read_b64_tr_b16 v[88:89], v12 offset:14336
    ds_read_b64_tr_b16 v[90:91], v12 offset:14848
    ds_read_b64_tr_b16 v[92:93], v13 offset:14336
    ds_read_b64_tr_b16 v[94:95], v13 offset:14848
    v_mfma_f32_32x32x16_bf16 v[160:175], v[72:75], v[96:99], v[160:175]
    ds_read_b128 v[104:107], v19 offset:11264
    ds_read_b128 v[108:111], v19 offset:44032
    v_mfma_f32_32x32x16_bf16 v[176:191], v[76:79], v[96:99], v[176:191]
    s_add_u32 s31, s30, 28672
    s_add_u32 m0, s28, 8192
    s_nop 0
    buffer_load_dwordx4 v11, s[8:11], s30 offen lds
    s_add_u32 m0, s28, 9216
    s_nop 0
    buffer_load_dwordx4 v11, s[8:11], s31 offen lds
    s_add_u32 m0, s28, 10240
    s_nop 0
    buffer_load_dwordx4 v11, s[12:15], s30 offen lds
    s_add_u32 m0, s28, 11264
    s_nop 0
    buffer_load_dwordx4 v11, s[12:15], s31 offen lds
    s_add_u32 s30, s30, 57344
    v_mfma_f32_32x32x16_bf16 v[192:207], v[64:67], v[100:103], v[192:207]
    v_mfma_f32_32x32x16_bf16 v[208:223], v[68:71], v[100:103], v[208:223]
    v_mfma_f32_32x32x16_bf16 v[224:239], v[72:75], v[100:103], v[224:239]
    v_mfma_f32_32x32x16_bf16 v[240:255], v[76:79], v[100:103], v[240:255]
    s_waitcnt lgkmcnt(0)
    v_mfma_f32_32x32x16_bf16 v[128:143], v[80:83], v[104:107], v[128:143]
    s_waitcnt vmcnt(8)
    ds_read_b64_tr_b16 v[64:65], v12 offset:0
    ds_read_b64_tr_b16 v[66:67], v12 offset:512
    ds_read_b64_tr_b16 v[68:69], v13 offset:0
    ds_read_b64_tr_b16 v[70:71], v13 offset:512
    v_mfma_f32_32x32x16_bf16 v[144:159], v[84:87], v[104:107], v[144:159]
    ds_read_b64_tr_b16 v[72:73], v12 offset:2048
    ds_read_b64_tr_b16 v[74:75], v12 offset:2560
    ds_read_b64_tr_b16 v[76:77], v13 offset:2048
    ds_read_b64_tr_b16 v[78:79], v13 offset:2560
    v_mfma_f32_32x32x16_bf16 v[160:175], v[88:91], v[104:107], v[160:175]
    ds_read_b128 v[96:99], v16 offset:12288
    ds_read_b128 v[100:103], v16 offset:45056
    v_mfma_f32_32x32x16_bf16 v[176:191], v[92:95], v[104:107], v[176:191]
    s_add_u32 s31, s30, 28672
    s_add_u32 m0, s28, 12288
    s_nop 0
    buffer_load_dwordx4 v11, s[8:11], s30 offen lds
    s_add_u32 m0, s28, 13312
    s_nop 0
    buffer_load_dwordx4 v11, s[8:11], s31 offen lds
    s_add_u32 m0, s28, 14336
    s_nop 0
    buffer_load_dwordx4 v11, s[12:15], s30 offen lds
    s_add_u32 m0, s28, 15360
    s_nop 0
    buffer_load_dwordx4 v11, s[12:15], s31 offen lds
    s_add_u32 s30, s30, 57344
    v_mfma_f32_32x32x16_bf16 v[192:207], v[80:83], v[108:111], v[192:207]
    v_mfma_f32_32x32x16_bf16 v[208:223], v[84:87], v[108:111], v[208:223]
    v_mfma_f32_32x32x16_bf16 v[224:239], v[88:91], v[108:111], v[224:239]
    v_mfma_f32_32x32x16_bf16 v[240:255], v[92:95], v[108:111], v[240:255]
    s_waitcnt lgkmcnt(0)
    v_mfma_f32_32x32x16_bf16 v[128:143], v[64:67], v[96:99], v[128:143]
    s_waitcnt vmcnt(8)
    ds_read_b64_tr_b16 v[80:81], v12 offset:4096
    ds_read_b64_tr_b16 v[82:83], v12 offset:4608
    ds_read_b64_tr_b16 v[84:85], v13 offset:4096
    ds_read_b64_tr_b16 v[86:87], v13 offset:4608
    v_mfma_f32_32x32x16_bf16 v[144:159], v[68:71], v[96:99], v[144:159]
    ds_read_b64_tr_b16 v[88:89], v12 offset:6144
    ds_read_b64_tr_b16 v[90:91], v12 offset:6656
    ds_read_b64_tr_b16 v[92:93], v13 offset:6144
    ds_read_b64_tr_b16 v[94:95], v13 offset:6656
    v_mfma_f32_32x32x16_bf16 v[160:175], v[72:75], v[96:99], v[160:175]
    ds_read_b128 v[104:107], v17 offset:13312
    ds_read_b128 v[108:111], v17 offset:46080
    v_mfma_f32_32x32x16_bf16 v[176:191], v[76:79], v[96:99], v[176:191]
    s_add_u32 s31, s30, 28672
    s_add_u32 m0, s28, 0
    s_nop 0
    buffer_load_dwordx4 v11, s[8:11], s30 offen lds
    s_add_u32 m0, s28, 1024
    s_nop 0
    buffer_load_dwordx4 v11, s[8:11], s31 offen lds
    s_add_u32 m0, s28, 2048
    s_nop 0
    buffer_load_dwordx4 v11, s[12:15], s30 offen lds
    s_add_u32 m0, s28, 3072
    s_nop 0
    buffer_load_dwordx4 v11, s[12:15], s31 offen lds
    s_add_u32 s30, s30, 57344
    v_mfma_f32_32x32x16_bf16 v[192:207], v[64:67], v[100:103], v[192:207]
    v_mfma_f32_32x32x16_bf16 v[208:223], v[68:71], v[100:103], v[208:223]
    v_mfma_f32_32x32x16_bf16 v[224:239], v[72:75], v[100:103], v[224:239]
    v_mfma_f32_32x32x16_bf16 v[240:255], v[76:79], v[100:103], v[240:255]
    s_waitcnt lgkmcnt(0)
    v_mfma_f32_32x32x16_bf16 v[128:143], v[80:83], v[104:107], v[128:143]
    s_waitcnt vmcnt(8)
    ds_read_b64_tr_b16 v[64:65], v12 offset:8192
    ds_read_b64_tr_b16 v[66:67], v12 offset:8704
    ds_read_b64_tr_b16 v[68:69], v13 offset:8192
    ds_read_b64_tr_b16 v[70:71], v13 offset:8704
    v_mfma_f32_32x32x16_bf16 v[144:159], v[84:87], v[104:107], v[144:159]
    ds_read_b64_tr_b16 v[72:73], v12 offset:10240
    ds_read_b64_tr_b16 v[74:75], v12 offset:10752
    ds_read_b64_tr_b16 v[76:77], v13 offset:10240
    ds_read_b64_tr_b16 v[78:79], v13 offset:10752
    v_mfma_f32_32x32x16_bf16 v[160:175], v[88:91], v[104:107], v[160:175]
    ds_read_b128 v[96:99], v18 offset:14336
    ds_read_b128 v[100:103], v18 offset:47104
    v_mfma_f32_32x32x16_bf16 v[176:191], v[92:95], v[104:107], v[176:191]
    s_add_u32 s31, s30, 28672
    s_add_u32 m0, s28, 4096
    s_nop 0
    buffer_load_dwordx4 v11, s[8:11], s30 offen lds
    s_add_u32 m0, s28, 5120
    s_nop 0
    buffer_load_dwordx4 v11, s[8:11], s31 offen lds
    s_add_u32 m0, s28, 6144
    s_nop 0
    buffer_load_dwordx4 v11, s[12:15], s30 offen lds
    s_add_u32 m0, s28, 7168
    s_nop 0
    buffer_load_dwordx4 v11, s[12:15], s31 offen lds
    s_add_u32 s30, s30, 57344
    v_mfma_f32_32x32x16_bf16 v[192:207], v[80:83], v[108:111], v[192:207]
    v_mfma_f32_32x32x16_bf16 v[208:223], v[84:87], v[108:111], v[208:223]
    v_mfma_f32_32x32x16_bf16 v[224:239], v[88:91], v[108:111], v[224:239]
    v_mfma_f32_32x32x16_bf16 v[240:255], v[92:95], v[108:111], v[240:255]
    s_waitcnt lgkmcnt(0)
    v_mfma_f32_32x32x16_bf16 v[128:143], v[64:67], v[96:99], v[128:143]
    s_waitcnt vmcnt(8)
    ds_read_b64_tr_b16 v[80:81], v12 offset:12288
    ds_read_b64_tr_b16 v[82:83], v12 offset:12800
    ds_read_b64_tr_b16 v[84:85], v13 offset:12288
    ds_read_b64_tr_b16 v[86:87], v13 offset:12800
    v_mfma_f32_32x32x16_bf16 v[144:159], v[68:71], v[96:99], v[144:159]
    ds_read_b64_tr_b16 v[88:89], v12 offset:14336
    ds_read_b64_tr_b16 v[90:91], v12 offset:14848
    ds_read_b64_tr_b16 v[92:93], v13 offset:14336
    ds_read_b64_tr_b16 v[94:95], v13 offset:14848
    v_mfma_f32_32x32x16_bf16 v[160:175], v[72:75], v[96:99], v[160:175]
    ds_read_b128 v[104:107], v19 offset:15360
    ds_read_b128 v[108:111], v19 offset:48128
    v_mfma_f32_32x32x16_bf16 v[176:191], v[76:79], v[96:99], v[176:191]
    s_add_u32 s31, s30, 28672
    s_add_u32 m0, s28, 8192
    s_nop 0
    buffer_load_dwordx4 v11, s[8:11], s30 offen lds
    s_add_u32 m0, s28, 9216
    s_nop 0
    buffer_load_dwordx4 v11, s[8:11], s31 offen lds
    s_add_u32 m0, s28, 10240
    s_nop 0
    buffer_load_dwordx4 v11, s[12:15], s30 offen lds
    s_add_u32 m0, s28, 11264
    s_nop 0
    buffer_load_dwordx4 v11, s[12:15], s31 offen lds
    s_add_u32 s30, s30, 57344
    v_mfma_f32_32x32x16_bf16 v[192:207], v[64:67], v[100:103], v[192:207]
    v_mfma_f32_32x32x16_bf16 v[208:223], v[68:71], v[100:103], v[208:223]
    v_mfma_f32_32x32x16_bf16 v[224:239], v[72:75], v[100:103], v[224:239]
    v_mfma_f32_32x32x16_bf16 v[240:255], v[76:79], v[100:103], v[240:255]
    s_waitcnt lgkmcnt(0)
    v_mfma_f32_32x32x16_bf16 v[128:143], v[80:83], v[104:107], v[128:143]
    s_waitcnt vmcnt(8)
    ds_read_b64_tr_b16 v[64:65], v12 offset:0
    ds_read_b64_tr_b16 v[66:67], v12 offset:512
    ds_read_b64_tr_b16 v[68:69], v13 offset:0
    ds_read_b64_tr_b16 v[70:71], v13 offset:512
    v_mfma_f32_32x32x16_bf16 v[144:159], v[84:87], v[104:107], v[144:159]
    ds_read_b64_tr_b16 v[72:73], v12 offset:2048
    ds_read_b64_tr_b16 v[74:75], v12 offset:2560
    ds_read_b64_tr_b16 v[76:77], v13 offset:2048
    ds_read_b64_tr_b16 v[78:79], v13 offset:2560
    v_mfma_f32_32x32x16_bf16 v[160:175], v[88:91], v[104:107], v[160:175]
    ds_read_b128 v[96:99], v16 offset:16384
    ds_read_b128 v[100:103], v16 offset:49152
    v_mfma_f32_32x32x16_bf16 v[176:191], v[92:95], v[104:107], v[176:191]
    s_add_u32 s31, s30, 28672
    s_add_u32 m0, s28, 12288
    s_nop 0
    buffer_load_dwordx4 v11, s[8:11], s30 offen lds
    s_add_u32 m0, s28, 13312
    s_nop 0
    buffer_load_dwordx4 v11, s[8:11], s31 offen lds
    s_add_u32 m0, s28, 14336
    s_nop 0
    buffer_load_dwordx4 v11, s[12:15], s30 offen lds
    s_add_u32 m0, s28, 15360
    s_nop 0
    buffer_load_dwordx4 v11, s[12:15], s31 offen lds
    s_add_u32 s30, s30, 57344
    v_mfma_f32_32x32x16_bf16 v[192:207], v[80:83], v[108:111], v[192:207]
    v_mfma_f32_32x32x16_bf16 v[208:223], v[84:87], v[108:111], v[208:223]
    v_mfma_f32_32x32x16_bf16 v[224:239], v[88:91], v[108:111], v[224:239]
    v_mfma_f32_32x32x16_bf16 v[240:255], v[92:95], v[108:111], v[240:255]
    s_waitcnt lgkmcnt(0)
    v_mfma_f32_32x32x16_bf16 v[128:143], v[64:67], v[96:99], v[128:143]
    s_waitcnt vmcnt(8)
    ds_read_b64_tr_b16 v[80:81], v12 offset:4096
    ds_read_b64_tr_b16 v[82:83], v12 offset:4608
    ds_read_b64_tr_b16 v[84:85], v13 offset:4096
    ds_read_b64_tr_b16 v[86:87], v13 offset:4608
    v_mfma_f32_32x32x16_bf16 v[144:159], v[68:71], v[96:99], v[144:159]
    ds_read_b64_tr_b16 v[88:89], v12 offset:6144
    ds_read_b64_tr_b16 v[90:91], v12 offset:6656
    ds_read_b64_tr_b16 v[92:93], v13 offset:6144
    ds_read_b64_tr_b16 v[94:95], v13 offset:6656
    v_mfma_f32_32x32x16_bf16 v[160:175], v[72:75], v[96:99], v[160:175]
    ds_read_b128 v[104:107], v17 offset:17408
    ds_read_b128 v[108:111], v17 offset:50176
    v_mfma_f32_32x32x16_bf16 v[176:191], v[76:79], v[96:99], v[176:191]
    s_add_u32 s31, s30, 28672
    s_add_u32 m0, s28, 0
    s_nop 0
    buffer_load_dwordx4 v11, s[8:11], s30 offen lds
    s_add_u32 m0, s28, 1024
    s_nop 0
    buffer_load_dwordx4 v11, s[8:11], s31 offen lds
    s_add_u32 m0, s28, 2048
    s_nop 0
    buffer_load_dwordx4 v11, s[12:15], s30 offen lds
    s_add_u32 m0, s28, 3072
    s_nop 0
    buffer_load_dwordx4 v11, s[12:15], s31 offen lds
    s_add_u32 s30, s30, 57344
    v_mfma_f32_32x32x16_bf16 v[192:207], v[64:67], v[100:103], v[192:207]
    v_mfma_f32_32x32x16_bf16 v[208:223], v[68:71], v[100:103], v[208:223]
    v_mfma_f32_32x32x16_bf16 v[224:239], v[72:75], v[100:103], v[224:239]
    v_mfma_f32_32x32x16_bf16 v[240:255], v[76:79], v[100:103], v[240:255]
    s_waitcnt lgkmcnt(0)
    v_mfma_f32_32x32x16_bf16 v[128:143], v[80:83], v[104:107], v[128:143]
    s_waitcnt vmcnt(8)
    ds_read_b64_tr_b16 v[64:65], v12 offset:8192
    ds_read_b64_tr_b16 v[66:67], v12 offset:8704
    ds_read_b64_tr_b16 v[68:69], v13 offset:8192
    ds_read_b64_tr_b16 v[70:71], v13 offset:8704
    v_mfma_f32_32x32x16_bf16 v[144:159], v[84:87], v[104:107], v[144:159]
    ds_read_b64_tr_b16 v[72:73], v12 offset:10240
    ds_read_b64_tr_b16 v[74:75], v12 offset:10752
    ds_read_b64_tr_b16 v[76:77], v13 offset:10240
    ds_read_b64_tr_b16 v[78:79], v13 offset:10752
    v_mfma_f32_32x32x16_bf16 v[160:175], v[88:91], v[104:107], v[160:175]
    ds_read_b128 v[96:99], v18 offset:18432
    ds_read_b128 v[100:103], v18 offset:51200
    v_mfma_f32_32x32x16_bf16 v[176:191], v[92:95], v[104:107], v[176:191]
    s_add_u32 s31, s30, 28672
    s_add_u32 m0, s28, 4096
    s_nop 0
    buffer_load_dwordx4 v11, s[8:11], s30 offen lds
    s_add_u32 m0, s28, 5120
    s_nop 0
    buffer_load_dwordx4 v11, s[8:11], s31 offen lds
    s_add_u32 m0, s28, 6144
    s_nop 0
    buffer_load_dwordx4 v11, s[12:15], s30 offen lds
    s_add_u32 m0, s28, 7168
    s_nop 0
    buffer_load_dwordx4 v11, s[12:15], s31 offen lds
    s_add_u32 s30, s30, 57344
    v_mfma_f32_32x32x16_bf16 v[192:207], v[80:83], v[108:111], v[192:207]
    v_mfma_f32_32x32x16_bf16 v[208:223], v[84:87], v[108:111], v[208:223]
    v_mfma_f32_32x32x16_bf16 v[224:239], v[88:91], v[108:111], v[224:239]
    v_mfma_f32_32x32x16_bf16 v[240:255], v[92:95], v[108:111], v[240:255]
    s_waitcnt lgkmcnt(0)
    v_mfma_f32_32x32x16_bf16 v[128:143], v[64:67], v[96:99], v[128:143]
    s_waitcnt vmcnt(8)
    ds_read_b64_tr_b16 v[80:81], v12 offset:12288
    ds_read_b64_tr_b16 v[82:83], v12 offset:12800
    ds_read_b64_tr_b16 v[84:85], v13 offset:12288
    ds_read_b64_tr_b16 v[86:87], v13 offset:12800
    v_mfma_f32_32x32x16_bf16 v[144:159], v[68:71], v[96:99], v[144:159]
    ds_read_b64_tr_b16 v[88:89], v12 offset:14336
    ds_read_b64_tr_b16 v[90:91], v12 offset:14848
    ds_read_b64_tr_b16 v[92:93], v13 offset:14336
    ds_read_b64_tr_b16 v[94:95], v13 offset:14848
    v_mfma_f32_32x32x16_bf16 v[160:175], v[72:75], v[96:99], v[160:175]
    ds_read_b128 v[104:107], v19 offset:19456
    ds_read_b128 v[108:111], v19 offset:52224
    v_mfma_f32_32x32x16_bf16 v[176:191], v[76:79], v[96:99], v[176:191]
    s_add_u32 s31, s30, 28672
    s_add_u32 m0, s28, 8192
    s_nop 0
    buffer_load_dwordx4 v11, s[8:11], s30 offen lds
    s_add_u32 m0, s28, 9216
    s_nop 0
    buffer_load_dwordx4 v11, s[8:11], s31 offen lds
    s_add_u32 m0, s28, 10240
    s_nop 0
    buffer_load_dwordx4 v11, s[12:15], s30 offen lds
    s_add_u32 m0, s28, 11264
    s_nop 0
    buffer_load_dwordx4 v11, s[12:15], s31 offen lds
    s_add_u32 s30, s30, 57344
    v_mfma_f32_32x32x16_bf16 v[192:207], v[64:67], v[100:103], v[192:207]
    v_mfma_f32_32x32x16_bf16 v[208:223], v[68:71], v[100:103], v[208:223]
    v_mfma_f32_32x32x16_bf16 v[224:239], v[72:75], v[100:103], v[224:239]
    v_mfma_f32_32x32x16_bf16 v[240:255], v[76:79], v[100:103], v[240:255]
    s_waitcnt lgkmcnt(0)
    v_mfma_f32_32x32x16_bf16 v[128:143], v[80:83], v[104:107], v[128:143]
    s_waitcnt vmcnt(8)
    ds_read_b64_tr_b16 v[64:65], v12 offset:0
    ds_read_b64_tr_b16 v[66:67], v12 offset:512
    ds_read_b64_tr_b16 v[68:69], v13 offset:0
    ds_read_b64_tr_b16 v[70:71], v13 offset:512
    v_mfma_f32_32x32x16_bf16 v[144:159], v[84:87], v[104:107], v[144:159]
    ds_read_b64_tr_b16 v[72:73], v12 offset:2048
    ds_read_b64_tr_b16 v[74:75], v12 offset:2560
    ds_read_b64_tr_b16 v[76:77], v13 offset:2048
    ds_read_b64_tr_b16 v[78:79], v13 offset:2560
    v_mfma_f32_32x32x16_bf16 v[160:175], v[88:91], v[104:107], v[160:175]
    ds_read_b128 v[96:99], v16 offset:20480
    ds_read_b128 v[100:103], v16 offset:53248
    v_mfma_f32_32x32x16_bf16 v[176:191], v[92:95], v[104:107], v[176:191]
    s_add_u32 s31, s30, 28672
    s_add_u32 m0, s28, 12288
    s_nop 0
    buffer_load_dwordx4 v11, s[8:11], s30 offen lds
    s_add_u32 m0, s28, 13312
    s_nop 0
    buffer_load_dwordx4 v11, s[8:11], s31 offen lds
    s_add_u32 m0, s28, 14336
    s_nop 0
    buffer_load_dwordx4 v11, s[12:15], s30 offen lds
    s_add_u32 m0, s28, 15360
    s_nop 0
    buffer_load_dwordx4 v11, s[12:15], s31 offen lds
    s_add_u32 s30, s30, 57344
    v_mfma_f32_32x32x16_bf16 v[192:207], v[80:83], v[108:111], v[192:207]
    v_mfma_f32_32x32x16_bf16 v[208:223], v[84:87], v[108:111], v[208:223]
    v_mfma_f32_32x32x16_bf16 v[224:239], v[88:91], v[108:111], v[224:239]
    v_mfma_f32_32x32x16_bf16 v[240:255], v[92:95], v[108:111], v[240:255]
    s_waitcnt lgkmcnt(0)
    v_mfma_f32_32x32x16_bf16 v[128:143], v[64:67], v[96:99], v[128:143]
    s_waitcnt vmcnt(8)
    ds_read_b64_tr_b16 v[80:81], v12 offset:4096
    ds_read_b64_tr_b16 v[82:83], v12 offset:4608
    ds_read_b64_tr_b16 v[84:85], v13 offset:4096
    ds_read_b64_tr_b16 v[86:87], v13 offset:4608
    v_mfma_f32_32x32x16_bf16 v[144:159], v[68:71], v[96:99], v[144:159]
    ds_read_b64_tr_b16 v[88:89], v12 offset:6144
    ds_read_b64_tr_b16 v[90:91], v12 offset:6656
    ds_read_b64_tr_b16 v[92:93], v13 offset:6144
    ds_read_b64_tr_b16 v[94:95], v13 offset:6656
    v_mfma_f32_32x32x16_bf16 v[160:175], v[72:75], v[96:99], v[160:175]
    ds_read_b128 v[104:107], v17 offset:21504
    ds_read_b128 v[108:111], v17 offset:54272
    v_mfma_f32_32x32x16_bf16 v[176:191], v[76:79], v[96:99], v[176:191]
    s_add_u32 s31, s30, 28672
    s_add_u32 m0, s28, 0
    s_nop 0
    buffer_load_dwordx4 v11, s[8:11], s30 offen lds
    s_add_u32 m0, s28, 1024
    s_nop 0
    buffer_load_dwordx4 v11, s[8:11], s31 offen lds
    s_add_u32 m0, s28, 2048
    s_nop 0
    buffer_load_dwordx4 v11, s[12:15], s30 offen lds
    s_add_u32 m0, s28, 3072
    s_nop 0
    buffer_load_dwordx4 v11, s[12:15], s31 offen lds
    s_add_u32 s30, s30, 57344
    v_mfma_f32_32x32x16_bf16 v[192:207], v[64:67], v[100:103], v[192:207]
    v_mfma_f32_32x32x16_bf16 v[208:223], v[68:71], v[100:103], v[208:223]
    v_mfma_f32_32x32x16_bf16 v[224:239], v[72:75], v[100:103], v[224:239]
    v_mfma_f32_32x32x16_bf16 v[240:255], v[76:79], v[100:103], v[240:255]
    s_waitcnt lgkmcnt(0)
    v_mfma_f32_32x32x16_bf16 v[128:143], v[80:83], v[104:107], v[128:143]
    s_waitcnt vmcnt(8)
    ds_read_b64_tr_b16 v[64:65], v12 offset:8192
    ds_read_b64_tr_b16 v[66:67], v12 offset:8704
    ds_read_b64_tr_b16 v[68:69], v13 offset:8192
    ds_read_b64_tr_b16 v[70:71], v13 offset:8704
    v_mfma_f32_32x32x16_bf16 v[144:159], v[84:87], v[104:107], v[144:159]
    ds_read_b64_tr_b16 v[72:73], v12 offset:10240
    ds_read_b64_tr_b16 v[74:75], v12 offset:10752
    ds_read_b64_tr_b16 v[76:77], v13 offset:10240
    ds_read_b64_tr_b16 v[78:79], v13 offset:10752
    v_mfma_f32_32x32x16_bf16 v[160:175], v[88:91], v[104:107], v[160:175]
    ds_read_b128 v[96:99], v18 offset:22528
    ds_read_b128 v[100:103], v18 offset:55296
    v_mfma_f32_32x32x16_bf16 v[176:191], v[92:95], v[104:107], v[176:191]
    s_add_u32 s31, s30, 28672
    s_add_u32 m0, s28, 4096
    s_nop 0
    buffer_load_dwordx4 v11, s[8:11], s30 offen lds
    s_add_u32 m0, s28, 5120
    s_nop 0
    buffer_load_dwordx4 v11, s[8:11], s31 offen lds
    s_add_u32 m0, s28, 6144
    s_nop 0
    buffer_load_dwordx4 v11, s[12:15], s30 offen lds
    s_add_u32 m0, s28, 7168
    s_nop 0
    buffer_load_dwordx4 v11, s[12:15], s31 offen lds
    s_add_u32 s30, s30, 57344
    v_mfma_f32_32x32x16_bf16 v[192:207], v[80:83], v[108:111], v[192:207]
    v_mfma_f32_32x32x16_bf16 v[208:223], v[84:87], v[108:111], v[208:223]
    v_mfma_f32_32x32x16_bf16 v[224:239], v[88:91], v[108:111], v[224:239]
    v_mfma_f32_32x32x16_bf16 v[240:255], v[92:95], v[108:111], v[240:255]
    s_waitcnt lgkmcnt(0)
    v_mfma_f32_32x32x16_bf16 v[128:143], v[64:67], v[96:99], v[128:143]
    s_waitcnt vmcnt(8)
    ds_read_b64_tr_b16 v[80:81], v12 offset:12288
    ds_read_b64_tr_b16 v[82:83], v12 offset:12800
    ds_read_b64_tr_b16 v[84:85], v13 offset:12288
    ds_read_b64_tr_b16 v[86:87], v13 offset:12800
    v_mfma_f32_32x32x16_bf16 v[144:159], v[68:71], v[96:99], v[144:159]
    ds_read_b64_tr_b16 v[88:89], v12 offset:14336
    ds_read_b64_tr_b16 v[90:91], v12 offset:14848
    ds_read_b64_tr_b16 v[92:93], v13 offset:14336
    ds_read_b64_tr_b16 v[94:95], v13 offset:14848
    v_mfma_f32_32x32x16_bf16 v[160:175], v[72:75], v[96:99], v[160:175]
    ds_read_b128 v[104:107], v19 offset:23552
    ds_read_b128 v[108:111], v19 offset:56320
    v_mfma_f32_32x32x16_bf16 v[176:191], v[76:79], v[96:99], v[176:191]
    s_add_u32 s31, s30, 28672
    s_add_u32 m0, s28, 8192
    s_nop 0
    buffer_load_dwordx4 v11, s[8:11], s30 offen lds
    s_add_u32 m0, s28, 9216
    s_nop 0
    buffer_load_dwordx4 v11, s[8:11], s31 offen lds
    s_add_u32 m0, s28, 10240
    s_nop 0
    buffer_load_dwordx4 v11, s[12:15], s30 offen lds
    s_add_u32 m0, s28, 11264
    s_nop 0
    buffer_load_dwordx4 v11, s[12:15], s31 offen lds
    s_add_u32 s30, s30, 57344
    v_mfma_f32_32x32x16_bf16 v[192:207], v[64:67], v[100:103], v[192:207]
    v_mfma_f32_32x32x16_bf16 v[208:223], v[68:71], v[100:103], v[208:223]
    v_mfma_f32_32x32x16_bf16 v[224:239], v[72:75], v[100:103], v[224:239]
    v_mfma_f32_32x32x16_bf16 v[240:255], v[76:79], v[100:103], v[240:255]
    s_waitcnt lgkmcnt(0)
    v_mfma_f32_32x32x16_bf16 v[128:143], v[80:83], v[104:107], v[128:143]
    s_waitcnt vmcnt(8)
    ds_read_b64_tr_b16 v[64:65], v12 offset:0
    ds_read_b64_tr_b16 v[66:67], v12 offset:512
    ds_read_b64_tr_b16 v[68:69], v13 offset:0
    ds_read_b64_tr_b16 v[70:71], v13 offset:512
    v_mfma_f32_32x32x16_bf16 v[144:159], v[84:87], v[104:107], v[144:159]
    ds_read_b64_tr_b16 v[72:73], v12 offset:2048
    ds_read_b64_tr_b16 v[74:75], v12 offset:2560
    ds_read_b64_tr_b16 v[76:77], v13 offset:2048
    ds_read_b64_tr_b16 v[78:79], v13 offset:2560
    v_mfma_f32_32x32x16_bf16 v[160:175], v[88:91], v[104:107], v[160:175]
    ds_read_b128 v[96:99], v16 offset:24576
    ds_read_b128 v[100:103], v16 offset:57344
    v_mfma_f32_32x32x16_bf16 v[176:191], v[92:95], v[104:107], v[176:191]
    s_add_u32 s31, s30, 28672
    s_add_u32 m0, s28, 12288
    s_nop 0
    buffer_load_dwordx4 v11, s[8:11], s30 offen lds
    s_add_u32 m0, s28, 13312
    s_nop 0
    buffer_load_dwordx4 v11, s[8:11], s31 offen lds
    s_add_u32 m0, s28, 14336
    s_nop 0
    buffer_load_dwordx4 v11, s[12:15], s30 offen lds
    s_add_u32 m0, s28, 15360
    s_nop 0
    buffer_load_dwordx4 v11, s[12:15], s31 offen lds
    s_add_u32 s30, s30, 57344
    v_mfma_f32_32x32x16_bf16 v[192:207], v[80:83], v[108:111], v[192:207]
    v_mfma_f32_32x32x16_bf16 v[208:223], v[84:87], v[108:111], v[208:223]
    v_mfma_f32_32x32x16_bf16 v[224:239], v[88:91], v[108:111], v[224:239]
    v_mfma_f32_32x32x16_bf16 v[240:255], v[92:95], v[108:111], v[240:255]
    s_waitcnt lgkmcnt(0)
    v_mfma_f32_32x32x16_bf16 v[128:143], v[64:67], v[96:99], v[128:143]
    s_waitcnt vmcnt(8)
    ds_read_b64_tr_b16 v[80:81], v12 offset:4096
    ds_read_b64_tr_b16 v[82:83], v12 offset:4608
    ds_read_b64_tr_b16 v[84:85], v13 offset:4096
    ds_read_b64_tr_b16 v[86:87], v13 offset:4608
    v_mfma_f32_32x32x16_bf16 v[144:159], v[68:71], v[96:99], v[144:159]
    ds_read_b64_tr_b16 v[88:89], v12 offset:6144
    ds_read_b64_tr_b16 v[90:91], v12 offset:6656
    ds_read_b64_tr_b16 v[92:93], v13 offset:6144
    ds_read_b64_tr_b16 v[94:95], v13 offset:6656
    v_mfma_f32_32x32x16_bf16 v[160:175], v[72:75], v[96:99], v[160:175]
    ds_read_b128 v[104:107], v17 offset:25600
    ds_read_b128 v[108:111], v17 offset:58368
    v_mfma_f32_32x32x16_bf16 v[176:191], v[76:79], v[96:99], v[176:191]
    s_add_u32 s31, s30, 28672
    s_add_u32 m0, s28, 0
    s_nop 0
    buffer_load_dwordx4 v11, s[8:11], s30 offen lds
    s_add_u32 m0, s28, 1024
    s_nop 0
    buffer_load_dwordx4 v11, s[8:11], s31 offen lds
    s_add_u32 m0, s28, 2048
    s_nop 0
    buffer_load_dwordx4 v11, s[12:15], s30 offen lds
    s_add_u32 m0, s28, 3072
    s_nop 0
    buffer_load_dwordx4 v11, s[12:15], s31 offen lds
    s_add_u32 s30, s30, 57344
    v_mfma_f32_32x32x16_bf16 v[192:207], v[64:67], v[100:103], v[192:207]
    v_mfma_f32_32x32x16_bf16 v[208:223], v[68:71], v[100:103], v[208:223]
    v_mfma_f32_32x32x16_bf16 v[224:239], v[72:75], v[100:103], v[224:239]
    v_mfma_f32_32x32x16_bf16 v[240:255], v[76:79], v[100:103], v[240:255]
    s_waitcnt lgkmcnt(0)
    v_mfma_f32_32x32x16_bf16 v[128:143], v[80:83], v[104:107], v[128:143]
    s_waitcnt vmcnt(8)
    ds_read_b64_tr_b16 v[64:65], v12 offset:8192
    ds_read_b64_tr_b16 v[66:67], v12 offset:8704
    ds_read_b64_tr_b16 v[68:69], v13 offset:8192
    ds_read_b64_tr_b16 v[70:71], v13 offset:8704
    v_mfma_f32_32x32x16_bf16 v[144:159], v[84:87], v[104:107], v[144:159]
    ds_read_b64_tr_b16 v[72:73], v12 offset:10240
    ds_read_b64_tr_b16 v[74:75], v12 offset:10752
    ds_read_b64_tr_b16 v[76:77], v13 offset:10240
    ds_read_b64_tr_b16 v[78:79], v13 offset:10752
    v_mfma_f32_32x32x16_bf16 v[160:175], v[88:91], v[104:107], v[160:175]
    ds_read_b128 v[96:99], v18 offset:26624
    ds_read_b128 v[100:103], v18 offset:59392
    v_mfma_f32_32x32x16_bf16 v[176:191], v[92:95], v[104:107], v[176:191]
    s_add_u32 s31, s30, 28672
    s_add_u32 m0, s28, 4096
    s_nop 0
    buffer_load_dwordx4 v11, s[8:11], s30 offen lds
    s_add_u32 m0, s28, 5120
    s_nop 0
    buffer_load_dwordx4 v11, s[8:11], s31 offen lds
    s_add_u32 m0, s28, 6144
    s_nop 0
    buffer_load_dwordx4 v11, s[12:15], s30 offen lds
    s_add_u32 m0, s28, 7168
    s_nop 0
    buffer_load_dwordx4 v11, s[12:15], s31 offen lds
    s_add_u32 s30, s30, 57344
    v_mfma_f32_32x32x16_bf16 v[192:207], v[80:83], v[108:111], v[192:207]
    v_mfma_f32_32x32x16_bf16 v[208:223], v[84:87], v[108:111], v[208:223]
    v_mfma_f32_32x32x16_bf16 v[224:239], v[88:91], v[108:111], v[224:239]
    v_mfma_f32_32x32x16_bf16 v[240:255], v[92:95], v[108:111], v[240:255]
    s_waitcnt lgkmcnt(0)
    v_mfma_f32_32x32x16_bf16 v[128:143], v[64:67], v[96:99], v[128:143]
    s_waitcnt vmcnt(8)
    ds_read_b64_tr_b16 v[80:81], v12 offset:12288
    ds_read_b64_tr_b16 v[82:83], v12 offset:12800
    ds_read_b64_tr_b16 v[84:85], v13 offset:12288
    ds_read_b64_tr_b16 v[86:87], v13 offset:12800
    v_mfma_f32_32x32x16_bf16 v[144:159], v[68:71], v[96:99], v[144:159]
    ds_read_b64_tr_b16 v[88:89], v12 offset:14336
    ds_read_b64_tr_b16 v[90:91], v12 offset:14848
    ds_read_b64_tr_b16 v[92:93], v13 offset:14336
    ds_read_b64_tr_b16 v[94:95], v13 offset:14848
    v_mfma_f32_32x32x16_bf16 v[160:175], v[72:75], v[96:99], v[160:175]
    ds_read_b128 v[104:107], v19 offset:27648
    ds_read_b128 v[108:111], v19 offset:60416
    v_mfma_f32_32x32x16_bf16 v[176:191], v[76:79], v[96:99], v[176:191]
    s_add_u32 s31, s30, 28672
    s_add_u32 m0, s28, 8192
    s_nop 0
    buffer_load_dwordx4 v11, s[8:11], s30 offen lds
    s_add_u32 m0, s28, 9216
    s_nop 0
    buffer_load_dwordx4 v11, s[8:11], s31 offen lds
    s_add_u32 m0, s28, 10240
    s_nop 0
    buffer_load_dwordx4 v11, s[12:15], s30 offen lds
    s_add_u32 m0, s28, 11264
    s_nop 0
    buffer_load_dwordx4 v11, s[12:15], s31 offen lds
    s_add_u32 s30, s30, 57344
    v_mfma_f32_32x32x16_bf16 v[192:207], v[64:67], v[100:103], v[192:207]
    v_mfma_f32_32x32x16_bf16 v[208:223], v[68:71], v[100:103], v[208:223]
    v_mfma_f32_32x32x16_bf16 v[224:239], v[72:75], v[100:103], v[224:239]
    v_mfma_f32_32x32x16_bf16 v[240:255], v[76:79], v[100:103], v[240:255]
    s_waitcnt lgkmcnt(0)
    v_mfma_f32_32x32x16_bf16 v[128:143], v[80:83], v[104:107], v[128:143]
    s_waitcnt vmcnt(8)
    ds_read_b64_tr_b16 v[64:65], v12 offset:0
    ds_read_b64_tr_b16 v[66:67], v12 offset:512
    ds_read_b64_tr_b16 v[68:69], v13 offset:0
    ds_read_b64_tr_b16 v[70:71], v13 offset:512
    v_mfma_f32_32x32x16_bf16 v[144:159], v[84:87], v[104:107], v[144:159]
    ds_read_b64_tr_b16 v[72:73], v12 offset:2048
    ds_read_b64_tr_b16 v[74:75], v12 offset:2560
    ds_read_b64_tr_b16 v[76:77], v13 offset:2048
    ds_read_b64_tr_b16 v[78:79], v13 offset:2560
    v_mfma_f32_32x32x16_bf16 v[160:175], v[88:91], v[104:107], v[160:175]
    ds_read_b128 v[96:99], v16 offset:28672
    ds_read_b128 v[100:103], v16 offset:61440
    v_mfma_f32_32x32x16_bf16 v[176:191], v[92:95], v[104:107], v[176:191]
    s_add_u32 s31, s30, 28672
    s_add_u32 m0, s28, 12288
    s_nop 0
    buffer_load_dwordx4 v11, s[8:11], s30 offen lds
    s_add_u32 m0, s28, 13312
    s_nop 0
    buffer_load_dwordx4 v11, s[8:11], s31 offen lds
    s_add_u32 m0, s28, 14336
    s_nop 0
    buffer_load_dwordx4 v11, s[12:15], s30 offen lds
    s_add_u32 m0, s28, 15360
    s_nop 0
    buffer_load_dwordx4 v11, s[12:15], s31 offen lds
    s_add_u32 s30, s30, 57344
    v_mfma_f32_32x32x16_bf16 v[192:207], v[80:83], v[108:111], v[192:207]
    v_mfma_f32_32x32x16_bf16 v[208:223], v[84:87], v[108:111], v[208:223]
    v_mfma_f32_32x32x16_bf16 v[224:239], v[88:91], v[108:111], v[224:239]
    v_mfma_f32_32x32x16_bf16 v[240:255], v[92:95], v[108:111], v[240:255]
    s_waitcnt lgkmcnt(0)
    v_mfma_f32_32x32x16_bf16 v[128:143], v[64:67], v[96:99], v[128:143]
    s_waitcnt vmcnt(8)
    ds_read_b64_tr_b16 v[80:81], v12 offset:4096
    ds_read_b64_tr_b16 v[82:83], v12 offset:4608
    ds_read_b64_tr_b16 v[84:85], v13 offset:4096
    ds_read_b64_tr_b16 v[86:87], v13 offset:4608
    v_mfma_f32_32x32x16_bf16 v[144:159], v[68:71], v[96:99], v[144:159]
    ds_read_b64_tr_b16 v[88:89], v12 offset:6144
    ds_read_b64_tr_b16 v[90:91], v12 offset:6656
    ds_read_b64_tr_b16 v[92:93], v13 offset:6144
    ds_read_b64_tr_b16 v[94:95], v13 offset:6656
    v_mfma_f32_32x32x16_bf16 v[160:175], v[72:75], v[96:99], v[160:175]
    ds_read_b128 v[104:107], v17 offset:29696
    ds_read_b128 v[108:111], v17 offset:62464
    v_mfma_f32_32x32x16_bf16 v[176:191], v[76:79], v[96:99], v[176:191]
    v_mfma_f32_32x32x16_bf16 v[192:207], v[64:67], v[100:103], v[192:207]
    v_mfma_f32_32x32x16_bf16 v[208:223], v[68:71], v[100:103], v[208:223]
    v_mfma_f32_32x32x16_bf16 v[224:239], v[72:75], v[100:103], v[224:239]
    v_mfma_f32_32x32x16_bf16 v[240:255], v[76:79], v[100:103], v[240:255]
    s_waitcnt lgkmcnt(0)
    v_mfma_f32_32x32x16_bf16 v[128:143], v[80:83], v[104:107], v[128:143]
    s_waitcnt vmcnt(4)
    ds_read_b64_tr_b16 v[64:65], v12 offset:8192
    ds_read_b64_tr_b16 v[66:67], v12 offset:8704
    ds_read_b64_tr_b16 v[68:69], v13 offset:8192
    ds_read_b64_tr_b16 v[70:71], v13 offset:8704
    v_mfma_f32_32x32x16_bf16 v[144:159], v[84:87], v[104:107], v[144:159]
    ds_read_b64_tr_b16 v[72:73], v12 offset:10240
    ds_read_b64_tr_b16 v[74:75], v12 offset:10752
    ds_read_b64_tr_b16 v[76:77], v13 offset:10240
    ds_read_b64_tr_b16 v[78:79], v13 offset:10752
    v_mfma_f32_32x32x16_bf16 v[160:175], v[88:91], v[104:107], v[160:175]
    ds_read_b128 v[96:99], v18 offset:30720
    ds_read_b128 v[100:103], v18 offset:63488
    v_mfma_f32_32x32x16_bf16 v[176:191], v[92:95], v[104:107], v[176:191]
    v_mfma_f32_32x32x16_bf16 v[192:207], v[80:83], v[108:111], v[192:207]
    v_mfma_f32_32x32x16_bf16 v[208:223], v[84:87], v[108:111], v[208:223]
    v_mfma_f32_32x32x16_bf16 v[224:239], v[88:91], v[108:111], v[224:239]
    v_mfma_f32_32x32x16_bf16 v[240:255], v[92:95], v[108:111], v[240:255]
    s_waitcnt lgkmcnt(0)
    v_mfma_f32_32x32x16_bf16 v[128:143], v[64:67], v[96:99], v[128:143]
    s_waitcnt vmcnt(0)
    ds_read_b64_tr_b16 v[80:81], v12 offset:12288
    ds_read_b64_tr_b16 v[82:83], v12 offset:12800
    ds_read_b64_tr_b16 v[84:85], v13 offset:12288
    ds_read_b64_tr_b16 v[86:87], v13 offset:12800
    v_mfma_f32_32x32x16_bf16 v[144:159], v[68:71], v[96:99], v[144:159]
    ds_read_b64_tr_b16 v[88:89], v12 offset:14336
    ds_read_b64_tr_b16 v[90:91], v12 offset:14848
    ds_read_b64_tr_b16 v[92:93], v13 offset:14336
    ds_read_b64_tr_b16 v[94:95], v13 offset:14848
    v_mfma_f32_32x32x16_bf16 v[160:175], v[72:75], v[96:99], v[160:175]
    ds_read_b128 v[104:107], v19 offset:31744
    ds_read_b128 v[108:111], v19 offset:64512
    v_mfma_f32_32x32x16_bf16 v[176:191], v[76:79], v[96:99], v[176:191]
    v_mfma_f32_32x32x16_bf16 v[192:207], v[64:67], v[100:103], v[192:207]
    v_mfma_f32_32x32x16_bf16 v[208:223], v[68:71], v[100:103], v[208:223]
    v_mfma_f32_32x32x16_bf16 v[224:239], v[72:75], v[100:103], v[224:239]
    v_mfma_f32_32x32x16_bf16 v[240:255], v[76:79], v[100:103], v[240:255]
    s_waitcnt lgkmcnt(0)
    v_mfma_f32_32x32x16_bf16 v[128:143], v[80:83], v[104:107], v[128:143]
    v_mfma_f32_32x32x16_bf16 v[144:159], v[84:87], v[104:107], v[144:159]
    v_mfma_f32_32x32x16_bf16 v[160:175], v[88:91], v[104:107], v[160:175]
    v_mfma_f32_32x32x16_bf16 v[176:191], v[92:95], v[104:107], v[176:191]
    v_mfma_f32_32x32x16_bf16 v[192:207], v[80:83], v[108:111], v[192:207]
    v_mfma_f32_32x32x16_bf16 v[208:223], v[84:87], v[108:111], v[208:223]
    v_mfma_f32_32x32x16_bf16 v[224:239], v[88:91], v[108:111], v[224:239]
    v_mfma_f32_32x32x16_bf16 v[240:255], v[92:95], v[108:111], v[240:255]
    s_mov_b32 s31, 0xbfb8aa3b
    s_mov_b32 s30, s31
    s_mov_b32 s31, 1.0
    s_setprio 2
    s_nop 0
    v_pk_mul_f32 v[128:129], v[128:129], s[30:31] op_sel_hi:[1,0]
    v_pk_mul_f32 v[130:131], v[130:131], s[30:31] op_sel_hi:[1,0]
    v_pk_mul_f32 v[132:133], v[132:133], s[30:31] op_sel_hi:[1,0]
    v_pk_mul_f32 v[134:135], v[134:135], s[30:31] op_sel_hi:[1,0]
    v_pk_mul_f32 v[136:137], v[136:137], s[30:31] op_sel_hi:[1,0]
    v_pk_mul_f32 v[138:139], v[138:139], s[30:31] op_sel_hi:[1,0]
    v_pk_mul_f32 v[140:141], v[140:141], s[30:31] op_sel_hi:[1,0]
    v_pk_mul_f32 v[142:143], v[142:143], s[30:31] op_sel_hi:[1,0]
    v_exp_f32 v128, v128
    v_exp_f32 v129, v129
    v_exp_f32 v130, v130
    v_exp_f32 v131, v131
    v_exp_f32 v132, v132
    v_exp_f32 v133, v133
    v_exp_f32 v134, v134
    v_exp_f32 v135, v135
    v_exp_f32 v136, v136
    v_exp_f32 v137, v137
    v_exp_f32 v138, v138
    v_exp_f32 v139, v139
    v_exp_f32 v140, v140
    v_exp_f32 v141, v141
    v_exp_f32 v142, v142
    v_exp_f32 v143, v143
    v_pk_add_f32 v[128:129], v[128:129], s[30:31] op_sel:[0,1] op_sel_hi:[1,1]
    v_pk_add_f32 v[130:131], v[130:131], s[30:31] op_sel:[0,1] op_sel_hi:[1,1]
    v_pk_add_f32 v[132:133], v[132:133], s[30:31] op_sel:[0,1] op_sel_hi:[1,1]
    v_pk_add_f32 v[134:135], v[134:135], s[30:31] op_sel:[0,1] op_sel_hi:[1,1]
    v_pk_add_f32 v[136:137], v[136:137], s[30:31] op_sel:[0,1] op_sel_hi:[1,1]
    v_pk_add_f32 v[138:139], v[138:139], s[30:31] op_sel:[0,1] op_sel_hi:[1,1]
    v_pk_add_f32 v[140:141], v[140:141], s[30:31] op_sel:[0,1] op_sel_hi:[1,1]
    v_pk_add_f32 v[142:143], v[142:143], s[30:31] op_sel:[0,1] op_sel_hi:[1,1]
    v_rcp_f32 v128, v128
    v_rcp_f32 v129, v129
    v_rcp_f32 v130, v130
    v_rcp_f32 v131, v131
    v_rcp_f32 v132, v132
    v_rcp_f32 v133, v133
    v_rcp_f32 v134, v134
    v_rcp_f32 v135, v135
    v_rcp_f32 v136, v136
    v_rcp_f32 v137, v137
    v_rcp_f32 v138, v138
    v_rcp_f32 v139, v139
    v_rcp_f32 v140, v140
    v_rcp_f32 v141, v141
    v_rcp_f32 v142, v142
    v_rcp_f32 v143, v143
    v_pk_mul_f32 v[128:129], v[128:129], v[160:161]
    v_pk_mul_f32 v[130:131], v[130:131], v[162:163]
    v_pk_mul_f32 v[132:133], v[132:133], v[164:165]
    v_pk_mul_f32 v[134:135], v[134:135], v[166:167]
    v_pk_mul_f32 v[136:137], v[136:137], v[168:169]
    v_pk_mul_f32 v[138:139], v[138:139], v[170:171]
    v_pk_mul_f32 v[140:141], v[140:141], v[172:173]
    v_pk_mul_f32 v[142:143], v[142:143], v[174:175]
    v_cvt_pk_bf16_f32 v64, v128, v129
    v_cvt_pk_bf16_f32 v65, v130, v131
    v_cvt_pk_bf16_f32 v66, v132, v133
    v_cvt_pk_bf16_f32 v67, v134, v135
    v_cvt_pk_bf16_f32 v68, v136, v137
    v_cvt_pk_bf16_f32 v69, v138, v139
    v_cvt_pk_bf16_f32 v70, v140, v141
    v_cvt_pk_bf16_f32 v71, v142, v143
    buffer_store_dwordx4 v[64:67], v20, s[40:43], s48 offen offset:0 sc1
    buffer_store_dwordx4 v[68:71], v20, s[40:43], s48 offen offset:1024 sc1
    v_pk_mul_f32 v[192:193], v[192:193], s[30:31] op_sel_hi:[1,0]
    v_pk_mul_f32 v[194:195], v[194:195], s[30:31] op_sel_hi:[1,0]
    v_pk_mul_f32 v[196:197], v[196:197], s[30:31] op_sel_hi:[1,0]
    v_pk_mul_f32 v[198:199], v[198:199], s[30:31] op_sel_hi:[1,0]
    v_pk_mul_f32 v[200:201], v[200:201], s[30:31] op_sel_hi:[1,0]
    v_pk_mul_f32 v[202:203], v[202:203], s[30:31] op_sel_hi:[1,0]
    v_pk_mul_f32 v[204:205], v[204:205], s[30:31] op_sel_hi:[1,0]
    v_pk_mul_f32 v[206:207], v[206:207], s[30:31] op_sel_hi:[1,0]
    v_exp_f32 v192, v192
    v_exp_f32 v193, v193
    v_exp_f32 v194, v194
    v_exp_f32 v195, v195
    v_exp_f32 v196, v196
    v_exp_f32 v197, v197
    v_exp_f32 v198, v198
    v_exp_f32 v199, v199
    v_exp_f32 v200, v200
    v_exp_f32 v201, v201
    v_exp_f32 v202, v202
    v_exp_f32 v203, v203
    v_exp_f32 v204, v204
    v_exp_f32 v205, v205
    v_exp_f32 v206, v206
    v_exp_f32 v207, v207
    v_pk_add_f32 v[192:193], v[192:193], s[30:31] op_sel:[0,1] op_sel_hi:[1,1]
    v_pk_add_f32 v[194:195], v[194:195], s[30:31] op_sel:[0,1] op_sel_hi:[1,1]
    v_pk_add_f32 v[196:197], v[196:197], s[30:31] op_sel:[0,1] op_sel_hi:[1,1]
    v_pk_add_f32 v[198:199], v[198:199], s[30:31] op_sel:[0,1] op_sel_hi:[1,1]
    v_pk_add_f32 v[200:201], v[200:201], s[30:31] op_sel:[0,1] op_sel_hi:[1,1]
    v_pk_add_f32 v[202:203], v[202:203], s[30:31] op_sel:[0,1] op_sel_hi:[1,1]
    v_pk_add_f32 v[204:205], v[204:205], s[30:31] op_sel:[0,1] op_sel_hi:[1,1]
    v_pk_add_f32 v[206:207], v[206:207], s[30:31] op_sel:[0,1] op_sel_hi:[1,1]
    v_rcp_f32 v192, v192
    v_rcp_f32 v193, v193
    v_rcp_f32 v194, v194
    v_rcp_f32 v195, v195
    v_rcp_f32 v196, v196
    v_rcp_f32 v197, v197
    v_rcp_f32 v198, v198
    v_rcp_f32 v199, v199
    v_rcp_f32 v200, v200
    v_rcp_f32 v201, v201
    v_rcp_f32 v202, v202
    v_rcp_f32 v203, v203
    v_rcp_f32 v204, v204
    v_rcp_f32 v205, v205
    v_rcp_f32 v206, v206
    v_rcp_f32 v207, v207
    v_pk_mul_f32 v[192:193], v[192:193], v[224:225]
    v_pk_mul_f32 v[194:195], v[194:195], v[226:227]
    v_pk_mul_f32 v[196:197], v[196:197], v[228:229]
    v_pk_mul_f32 v[198:199], v[198:199], v[230:231]
    v_pk_mul_f32 v[200:201], v[200:201], v[232:233]
    v_pk_mul_f32 v[202:203], v[202:203], v[234:235]
    v_pk_mul_f32 v[204:205], v[204:205], v[236:237]
    v_pk_mul_f32 v[206:207], v[206:207], v[238:239]
    v_cvt_pk_bf16_f32 v72, v192, v193
    v_cvt_pk_bf16_f32 v73, v194, v195
    v_cvt_pk_bf16_f32 v74, v196, v197
    v_cvt_pk_bf16_f32 v75, v198, v199
    v_cvt_pk_bf16_f32 v76, v200, v201
    v_cvt_pk_bf16_f32 v77, v202, v203
    v_cvt_pk_bf16_f32 v78, v204, v205
    v_cvt_pk_bf16_f32 v79, v206, v207
    buffer_store_dwordx4 v[72:75], v20, s[40:43], s48 offen offset:2048 sc1
    buffer_store_dwordx4 v[76:79], v20, s[40:43], s48 offen offset:3072 sc1
    v_pk_mul_f32 v[144:145], v[144:145], s[30:31] op_sel_hi:[1,0]
    v_pk_mul_f32 v[146:147], v[146:147], s[30:31] op_sel_hi:[1,0]
    v_pk_mul_f32 v[148:149], v[148:149], s[30:31] op_sel_hi:[1,0]
    v_pk_mul_f32 v[150:151], v[150:151], s[30:31] op_sel_hi:[1,0]
    v_pk_mul_f32 v[152:153], v[152:153], s[30:31] op_sel_hi:[1,0]
    v_pk_mul_f32 v[154:155], v[154:155], s[30:31] op_sel_hi:[1,0]
    v_pk_mul_f32 v[156:157], v[156:157], s[30:31] op_sel_hi:[1,0]
    v_pk_mul_f32 v[158:159], v[158:159], s[30:31] op_sel_hi:[1,0]
    v_exp_f32 v144, v144
    v_exp_f32 v145, v145
    v_exp_f32 v146, v146
    v_exp_f32 v147, v147
    v_exp_f32 v148, v148
    v_exp_f32 v149, v149
    v_exp_f32 v150, v150
    v_exp_f32 v151, v151
    v_exp_f32 v152, v152
    v_exp_f32 v153, v153
    v_exp_f32 v154, v154
    v_exp_f32 v155, v155
    v_exp_f32 v156, v156
    v_exp_f32 v157, v157
    v_exp_f32 v158, v158
    v_exp_f32 v159, v159
    v_pk_add_f32 v[144:145], v[144:145], s[30:31] op_sel:[0,1] op_sel_hi:[1,1]
    v_pk_add_f32 v[146:147], v[146:147], s[30:31] op_sel:[0,1] op_sel_hi:[1,1]
    v_pk_add_f32 v[148:149], v[148:149], s[30:31] op_sel:[0,1] op_sel_hi:[1,1]
    v_pk_add_f32 v[150:151], v[150:151], s[30:31] op_sel:[0,1] op_sel_hi:[1,1]
    v_pk_add_f32 v[152:153], v[152:153], s[30:31] op_sel:[0,1] op_sel_hi:[1,1]
    v_pk_add_f32 v[154:155], v[154:155], s[30:31] op_sel:[0,1] op_sel_hi:[1,1]
    v_pk_add_f32 v[156:157], v[156:157], s[30:31] op_sel:[0,1] op_sel_hi:[1,1]
    v_pk_add_f32 v[158:159], v[158:159], s[30:31] op_sel:[0,1] op_sel_hi:[1,1]
    v_rcp_f32 v144, v144
    v_rcp_f32 v145, v145
    v_rcp_f32 v146, v146
    v_rcp_f32 v147, v147
    v_rcp_f32 v148, v148
    v_rcp_f32 v149, v149
    v_rcp_f32 v150, v150
    v_rcp_f32 v151, v151
    v_rcp_f32 v152, v152
    v_rcp_f32 v153, v153
    v_rcp_f32 v154, v154
    v_rcp_f32 v155, v155
    v_rcp_f32 v156, v156
    v_rcp_f32 v157, v157
    v_rcp_f32 v158, v158
    v_rcp_f32 v159, v159
    v_pk_mul_f32 v[144:145], v[144:145], v[176:177]
    v_pk_mul_f32 v[146:147], v[146:147], v[178:179]
    v_pk_mul_f32 v[148:149], v[148:149], v[180:181]
    v_pk_mul_f32 v[150:151], v[150:151], v[182:183]
    v_pk_mul_f32 v[152:153], v[152:153], v[184:185]
    v_pk_mul_f32 v[154:155], v[154:155], v[186:187]
    v_pk_mul_f32 v[156:157], v[156:157], v[188:189]
    v_pk_mul_f32 v[158:159], v[158:159], v[190:191]
    v_cvt_pk_bf16_f32 v80, v144, v145
    v_cvt_pk_bf16_f32 v81, v146, v147
    v_cvt_pk_bf16_f32 v82, v148, v149
    v_cvt_pk_bf16_f32 v83, v150, v151
    v_cvt_pk_bf16_f32 v84, v152, v153
    v_cvt_pk_bf16_f32 v85, v154, v155
    v_cvt_pk_bf16_f32 v86, v156, v157
    v_cvt_pk_bf16_f32 v87, v158, v159
    s_add_u32 s47, s48, 4096
    buffer_store_dwordx4 v[80:83], v20, s[40:43], s47 offen offset:0 sc1
    buffer_store_dwordx4 v[84:87], v20, s[40:43], s47 offen offset:1024 sc1
    v_pk_mul_f32 v[208:209], v[208:209], s[30:31] op_sel_hi:[1,0]
    v_pk_mul_f32 v[210:211], v[210:211], s[30:31] op_sel_hi:[1,0]
    v_pk_mul_f32 v[212:213], v[212:213], s[30:31] op_sel_hi:[1,0]
    v_pk_mul_f32 v[214:215], v[214:215], s[30:31] op_sel_hi:[1,0]
    v_pk_mul_f32 v[216:217], v[216:217], s[30:31] op_sel_hi:[1,0]
    v_pk_mul_f32 v[218:219], v[218:219], s[30:31] op_sel_hi:[1,0]
    v_pk_mul_f32 v[220:221], v[220:221], s[30:31] op_sel_hi:[1,0]
    v_pk_mul_f32 v[222:223], v[222:223], s[30:31] op_sel_hi:[1,0]
    v_exp_f32 v208, v208
    v_exp_f32 v209, v209
    v_exp_f32 v210, v210
    v_exp_f32 v211, v211
    v_exp_f32 v212, v212
    v_exp_f32 v213, v213
    v_exp_f32 v214, v214
    v_exp_f32 v215, v215
    v_exp_f32 v216, v216
    v_exp_f32 v217, v217
    v_exp_f32 v218, v218
    v_exp_f32 v219, v219
    v_exp_f32 v220, v220
    v_exp_f32 v221, v221
    v_exp_f32 v222, v222
    v_exp_f32 v223, v223
    v_pk_add_f32 v[208:209], v[208:209], s[30:31] op_sel:[0,1] op_sel_hi:[1,1]
    v_pk_add_f32 v[210:211], v[210:211], s[30:31] op_sel:[0,1] op_sel_hi:[1,1]
    v_pk_add_f32 v[212:213], v[212:213], s[30:31] op_sel:[0,1] op_sel_hi:[1,1]
    v_pk_add_f32 v[214:215], v[214:215], s[30:31] op_sel:[0,1] op_sel_hi:[1,1]
    v_pk_add_f32 v[216:217], v[216:217], s[30:31] op_sel:[0,1] op_sel_hi:[1,1]
    v_pk_add_f32 v[218:219], v[218:219], s[30:31] op_sel:[0,1] op_sel_hi:[1,1]
    v_pk_add_f32 v[220:221], v[220:221], s[30:31] op_sel:[0,1] op_sel_hi:[1,1]
    v_pk_add_f32 v[222:223], v[222:223], s[30:31] op_sel:[0,1] op_sel_hi:[1,1]
    v_rcp_f32 v208, v208
    v_rcp_f32 v209, v209
    v_rcp_f32 v210, v210
    v_rcp_f32 v211, v211
    v_rcp_f32 v212, v212
    v_rcp_f32 v213, v213
    v_rcp_f32 v214, v214
    v_rcp_f32 v215, v215
    v_rcp_f32 v216, v216
    v_rcp_f32 v217, v217
    v_rcp_f32 v218, v218
    v_rcp_f32 v219, v219
    v_rcp_f32 v220, v220
    v_rcp_f32 v221, v221
    v_rcp_f32 v222, v222
    v_rcp_f32 v223, v223
    v_pk_mul_f32 v[208:209], v[208:209], v[240:241]
    v_pk_mul_f32 v[210:211], v[210:211], v[242:243]
    v_pk_mul_f32 v[212:213], v[212:213], v[244:245]
    v_pk_mul_f32 v[214:215], v[214:215], v[246:247]
    v_pk_mul_f32 v[216:217], v[216:217], v[248:249]
    v_pk_mul_f32 v[218:219], v[218:219], v[250:251]
    v_pk_mul_f32 v[220:221], v[220:221], v[252:253]
    v_pk_mul_f32 v[222:223], v[222:223], v[254:255]
    v_cvt_pk_bf16_f32 v88, v208, v209
    v_cvt_pk_bf16_f32 v89, v210, v211
    v_cvt_pk_bf16_f32 v90, v212, v213
    v_cvt_pk_bf16_f32 v91, v214, v215
    v_cvt_pk_bf16_f32 v92, v216, v217
    v_cvt_pk_bf16_f32 v93, v218, v219
    v_cvt_pk_bf16_f32 v94, v220, v221
    v_cvt_pk_bf16_f32 v95, v222, v223
    buffer_store_dwordx4 v[88:91], v20, s[40:43], s47 offen offset:2048 sc1
    buffer_store_dwordx4 v[92:95], v20, s[40:43], s47 offen offset:3072 sc1
    s_setprio 1
    s_branch Y_GDONE
Y_G1:
    s_waitcnt vmcnt(12)
    ds_read_b64_tr_b16 v[64:65], v12 offset:0
    ds_read_b64_tr_b16 v[66:67], v12 offset:512
    ds_read_b64_tr_b16 v[72:73], v12 offset:2048
    ds_read_b64_tr_b16 v[74:75], v12 offset:2560
    ds_read_b128 v[96:99], v16 offset:0
    ds_read_b128 v[100:103], v16 offset:32768
    s_waitcnt lgkmcnt(0)
    v_mfma_f32_32x32x16_bf16 v[128:143], v[64:67], v[96:99], 0
    s_waitcnt vmcnt(8)
    ds_read_b64_tr_b16 v[80:81], v12 offset:4096
    ds_read_b64_tr_b16 v[82:83], v12 offset:4608
    v_mfma_f32_32x32x16_bf16 v[160:175], v[72:75], v[96:99], 0
    ds_read_b64_tr_b16 v[88:89], v12 offset:6144
    ds_read_b64_tr_b16 v[90:91], v12 offset:6656
    v_mfma_f32_32x32x16_bf16 v[192:207], v[64:67], v[100:103], 0
    ds_read_b128 v[104:107], v17 offset:1024
    ds_read_b128 v[108:111], v17 offset:33792
    v_mfma_f32_32x32x16_bf16 v[224:239], v[72:75], v[100:103], 0
    s_add_u32 s31, s30, 28672
    s_add_u32 m0, s28, 0
    s_nop 0
    buffer_load_dwordx4 v11, s[8:11], s30 offen lds
    s_add_u32 m0, s28, 1024
    s_nop 0
    buffer_load_dwordx4 v11, s[8:11], s31 offen lds
    s_add_u32 m0, s28, 2048
    s_nop 0
    buffer_load_dwordx4 v11, s[12:15], s30 offen lds
    s_add_u32 m0, s28, 3072
    s_nop 0
    buffer_load_dwordx4 v11, s[12:15], s31 offen lds
    s_add_u32 s30, s30, 57344
    s_waitcnt lgkmcnt(0)
    v_mfma_f32_32x32x16_bf16 v[128:143], v[80:83], v[104:107], v[128:143]
    s_waitcnt vmcnt(8)
    ds_read_b64_tr_b16 v[64:65], v12 offset:8192
    ds_read_b64_tr_b16 v[66:67], v12 offset:8704
    v_mfma_f32_32x32x16_bf16 v[160:175], v[88:91], v[104:107], v[160:175]
    ds_read_b64_tr_b16 v[72:73], v12 offset:10240
    ds_read_b64_tr_b16 v[74:75], v12 offset:10752
    v_mfma_f32_32x32x16_bf16 v[192:207], v[80:83], v[108:111], v[192:207]
    ds_read_b128 v[96:99], v18 offset:2048
    ds_read_b128 v[100:103], v18 offset:34816
    v_mfma_f32_32x32x16_bf16 v[224:239], v[88:91], v[108:111], v[224:239]
    s_add_u32 s31, s30, 28672
    s_add_u32 m0, s28, 4096
    s_nop 0
    buffer_load_dwordx4 v11, s[8:11], s30 offen lds
    s_add_u32 m0, s28, 5120
    s_nop 0
    buffer_load_dwordx4 v11, s[8:11], s31 offen lds
    s_add_u32 m0, s28, 6144
    s_nop 0
    buffer_load_dwordx4 v11, s[12:15], s30 offen lds
    s_add_u32 m0, s28, 7168
    s_nop 0
    buffer_load_dwordx4 v11, s[12:15], s31 offen lds
    s_add_u32 s30, s30, 57344
    s_waitcnt lgkmcnt(0)
    v_mfma_f32_32x32x16_bf16 v[128:143], v[64:67], v[96:99], v[128:143]
    s_waitcnt vmcnt(8)
    ds_read_b64_tr_b16 v[80:81], v12 offset:12288
    ds_read_b64_tr_b16 v[82:83], v12 offset:12800
    v_mfma_f32_32x32x16_bf16 v[160:175], v[72:75], v[96:99], v[160:175]
    ds_read_b64_tr_b16 v[88:89], v12 offset:14336
    ds_read_b64_tr_b16 v[90:91], v12 offset:14848
    v_mfma_f32_32x32x16_bf16 v[192:207], v[64:67], v[100:103], v[192:207]
    ds_read_b128 v[104:107], v19 offset:3072
    ds_read_b128 v[108:111], v19 offset:35840
    v_mfma_f32_32x32x16_bf16 v[224:239], v[72:75], v[100:103], v[224:239]
    s_add_u32 s31, s30, 28672
    s_add_u32 m0, s28, 8192
    s_nop 0
    buffer_load_dwordx4 v11, s[8:11], s30 offen lds
    s_add_u32 m0, s28, 9216
    s_nop 0
    buffer_load_dwordx4 v11, s[8:11], s31 offen lds
    s_add_u32 m0, s28, 10240
    s_nop 0
    buffer_load_dwordx4 v11, s[12:15], s30 offen lds
    s_add_u32 m0, s28, 11264
    s_nop 0
    buffer_load_dwordx4 v11, s[12:15], s31 offen lds
    s_add_u32 s30, s30, 57344
    s_waitcnt lgkmcnt(0)
    v_mfma_f32_32x32x16_bf16 v[128:143], v[80:83], v[104:107], v[128:143]
    s_waitcnt vmcnt(8)
    ds_read_b64_tr_b16 v[64:65], v12 offset:0
    ds_read_b64_tr_b16 v[66:67], v12 offset:512
    v_mfma_f32_32x32x16_bf16 v[160:175], v[88:91], v[104:107], v[160:175]
    ds_read_b64_tr_b16 v[72:73], v12 offset:2048
    ds_read_b64_tr_b16 v[74:75], v12 offset:2560
    v_mfma_f32_32x32x16_bf16 v[192:207], v[80:83], v[108:111], v[192:207]
    ds_read_b128 v[96:99], v16 offset:4096
    ds_read_b128 v[100:103], v16 offset:36864
    v_mfma_f32_32x32x16_bf16 v[224:239], v[88:91], v[108:111], v[224:239]
    s_add_u32 s31, s30, 28672
    s_add_u32 m0, s28, 12288
    s_nop 0
    buffer_load_dwordx4 v11, s[8:11], s30 offen lds
    s_add_u32 m0, s28, 13312
    s_nop 0
    buffer_load_dwordx4 v11, s[8:11], s31 offen lds
    s_add_u32 m0, s28, 14336
    s_nop 0
    buffer_load_dwordx4 v11, s[12:15], s30 offen lds
    s_add_u32 m0, s28, 15360
    s_nop 0
    buffer_load_dwordx4 v11, s[12:15], s31 offen lds
    s_add_u32 s30, s30, 57344
    s_waitcnt lgkmcnt(0)
    v_mfma_f32_32x32x16_bf16 v[128:143], v[64:67], v[96:99], v[128:143]
    s_waitcnt vmcnt(8)
    ds_read_b64_tr_b16 v[80:81], v12 offset:4096
    ds_read_b64_tr_b16 v[82:83], v12 offset:4608
    v_mfma_f32_32x32x16_bf16 v[160:175], v[72:75], v[96:99], v[160:175]
    ds_read_b64_tr_b16 v[88:89], v12 offset:6144
    ds_read_b64_tr_b16 v[90:91], v12 offset:6656
    v_mfma_f32_32x32x16_bf16 v[192:207], v[64:67], v[100:103], v[192:207]
    ds_read_b128 v[104:107], v17 offset:5120
    ds_read_b128 v[108:111], v17 offset:37888
    v_mfma_f32_32x32x16_bf16 v[224:239], v[72:75], v[100:103], v[224:239]
    s_add_u32 s31, s30, 28672
    s_add_u32 m0, s28, 0
    s_nop 0
    buffer_load_dwordx4 v11, s[8:11], s30 offen lds
    s_add_u32 m0, s28, 1024
    s_nop 0
    buffer_load_dwordx4 v11, s[8:11], s31 offen lds
    s_add_u32 m0, s28, 2048
    s_nop 0
    buffer_load_dwordx4 v11, s[12:15], s30 offen lds
    s_add_u32 m0, s28, 3072
    s_nop 0
    buffer_load_dwordx4 v11, s[12:15], s31 offen lds
    s_add_u32 s30, s30, 57344
    s_waitcnt lgkmcnt(0)
    v_mfma_f32_32x32x16_bf16 v[128:143], v[80:83], v[104:107], v[128:143]
    s_waitcnt vmcnt(8)
    ds_read_b64_tr_b16 v[64:65], v12 offset:8192
    ds_read_b64_tr_b16 v[66:67], v12 offset:8704
    v_mfma_f32_32x32x16_bf16 v[160:175], v[88:91], v[104:107], v[160:175]
    ds_read_b64_tr_b16 v[72:73], v12 offset:10240
    ds_read_b64_tr_b16 v[74:75], v12 offset:10752
    v_mfma_f32_32x32x16_bf16 v[192:207], v[80:83], v[108:111], v[192:207]
    ds_read_b128 v[96:99], v18 offset:6144
    ds_read_b128 v[100:103], v18 offset:38912
    v_mfma_f32_32x32x16_bf16 v[224:239], v[88:91], v[108:111], v[224:239]
    s_add_u32 s31, s30, 28672
    s_add_u32 m0, s28, 4096
    s_nop 0
    buffer_load_dwordx4 v11, s[8:11], s30 offen lds
    s_add_u32 m0, s28, 5120
    s_nop 0
    buffer_load_dwordx4 v11, s[8:11], s31 offen lds
    s_add_u32 m0, s28, 6144
    s_nop 0
    buffer_load_dwordx4 v11, s[12:15], s30 offen lds
    s_add_u32 m0, s28, 7168
    s_nop 0
    buffer_load_dwordx4 v11, s[12:15], s31 offen lds
    s_add_u32 s30, s30, 57344
    s_waitcnt lgkmcnt(0)
    v_mfma_f32_32x32x16_bf16 v[128:143], v[64:67], v[96:99], v[128:143]
    s_waitcnt vmcnt(8)
    ds_read_b64_tr_b16 v[80:81], v12 offset:12288
    ds_read_b64_tr_b16 v[82:83], v12 offset:12800
    v_mfma_f32_32x32x16_bf16 v[160:175], v[72:75], v[96:99], v[160:175]
    ds_read_b64_tr_b16 v[88:89], v12 offset:14336
    ds_read_b64_tr_b16 v[90:91], v12 offset:14848
    v_mfma_f32_32x32x16_bf16 v[192:207], v[64:67], v[100:103], v[192:207]
    ds_read_b128 v[104:107], v19 offset:7168
    ds_read_b128 v[108:111], v19 offset:39936
    v_mfma_f32_32x32x16_bf16 v[224:239], v[72:75], v[100:103], v[224:239]
    s_add_u32 s31, s30, 28672
    s_add_u32 m0, s28, 8192
    s_nop 0
    buffer_load_dwordx4 v11, s[8:11], s30 offen lds
    s_add_u32 m0, s28, 9216
    s_nop 0
    buffer_load_dwordx4 v11, s[8:11], s31 offen lds
    s_add_u32 m0, s28, 10240
    s_nop 0
    buffer_load_dwordx4 v11, s[12:15], s30 offen lds
    s_add_u32 m0, s28, 11264
    s_nop 0
    buffer_load_dwordx4 v11, s[12:15], s31 offen lds
    s_add_u32 s30, s30, 57344
    s_waitcnt lgkmcnt(0)
    v_mfma_f32_32x32x16_bf16 v[128:143], v[80:83], v[104:107], v[128:143]
    s_waitcnt vmcnt(8)
    ds_read_b64_tr_b16 v[64:65], v12 offset:0
    ds_read_b64_tr_b16 v[66:67], v12 offset:512
    v_mfma_f32_32x32x16_bf16 v[160:175], v[88:91], v[104:107], v[160:175]
    ds_read_b64_tr_b16 v[72:73], v12 offset:2048
    ds_read_b64_tr_b16 v[74:75], v12 offset:2560
    v_mfma_f32_32x32x16_bf16 v[192:207], v[80:83], v[108:111], v[192:207]
    ds_read_b128 v[96:99], v16 offset:8192
    ds_read_b128 v[100:103], v16 offset:40960
    v_mfma_f32_32x32x16_bf16 v[224:239], v[88:91], v[108:111], v[224:239]
    s_add_u32 s31, s30, 28672
    s_add_u32 m0, s28, 12288
    s_nop 0
    buffer_load_dwordx4 v11, s[8:11], s30 offen lds
    s_add_u32 m0, s28, 13312
    s_nop 0
    buffer_load_dwordx4 v11, s[8:11], s31 offen lds
    s_add_u32 m0, s28, 14336
    s_nop 0
    buffer_load_dwordx4 v11, s[12:15], s30 offen lds
    s_add_u32 m0, s28, 15360
    s_nop 0
    buffer_load_dwordx4 v11, s[12:15], s31 offen lds
    s_add_u32 s30, s30, 57344
    s_waitcnt lgkmcnt(0)
    v_mfma_f32_32x32x16_bf16 v[128:143], v[64:67], v[96:99], v[128:143]
    s_waitcnt vmcnt(8)
    ds_read_b64_tr_b16 v[80:81], v12 offset:4096
    ds_read_b64_tr_b16 v[82:83], v12 offset:4608
    v_mfma_f32_32x32x16_bf16 v[160:175], v[72:75], v[96:99], v[160:175]
    ds_read_b64_tr_b16 v[88:89], v12 offset:6144
    ds_read_b64_tr_b16 v[90:91], v12 offset:6656
    v_mfma_f32_32x32x16_bf16 v[192:207], v[64:67], v[100:103], v[192:207]
    ds_read_b128 v[104:107], v17 offset:9216
    ds_read_b128 v[108:111], v17 offset:41984
    v_mfma_f32_32x32x16_bf16 v[224:239], v[72:75], v[100:103], v[224:239]
    s_add_u32 s31, s30, 28672
    s_add_u32 m0, s28, 0
    s_nop 0
    buffer_load_dwordx4 v11, s[8:11], s30 offen lds
    s_add_u32 m0, s28, 1024
    s_nop 0
    buffer_load_dwordx4 v11, s[8:11], s31 offen lds
    s_add_u32 m0, s28, 2048
    s_nop 0
    buffer_load_dwordx4 v11, s[12:15], s30 offen lds
    s_add_u32 m0, s28, 3072
    s_nop 0
    buffer_load_dwordx4 v11, s[12:15], s31 offen lds
    s_add_u32 s30, s30, 57344
    s_waitcnt lgkmcnt(0)
    v_mfma_f32_32x32x16_bf16 v[128:143], v[80:83], v[104:107], v[128:143]
    s_waitcnt vmcnt(8)
    ds_read_b64_tr_b16 v[64:65], v12 offset:8192
    ds_read_b64_tr_b16 v[66:67], v12 offset:8704
    v_mfma_f32_32x32x16_bf16 v[160:175], v[88:91], v[104:107], v[160:175]
    ds_read_b64_tr_b16 v[72:73], v12 offset:10240
    ds_read_b64_tr_b16 v[74:75], v12 offset:10752
    v_mfma_f32_32x32x16_bf16 v[192:207], v[80:83], v[108:111], v[192:207]
    ds_read_b128 v[96:99], v18 offset:10240
    ds_read_b128 v[100:103], v18 offset:43008
    v_mfma_f32_32x32x16_bf16 v[224:239], v[88:91], v[108:111], v[224:239]
    s_add_u32 s31, s30, 28672
    s_add_u32 m0, s28, 4096
    s_nop 0
    buffer_load_dwordx4 v11, s[8:11], s30 offen lds
    s_add_u32 m0, s28, 5120
    s_nop 0
    buffer_load_dwordx4 v11, s[8:11], s31 offen lds
    s_add_u32 m0, s28, 6144
    s_nop 0
    buffer_load_dwordx4 v11, s[12:15], s30 offen lds
    s_add_u32 m0, s28, 7168
    s_nop 0
    buffer_load_dwordx4 v11, s[12:15], s31 offen lds
    s_add_u32 s30, s30, 57344
    s_waitcnt lgkmcnt(0)
    v_mfma_f32_32x32x16_bf16 v[128:143], v[64:67], v[96:99], v[128:143]
    s_waitcnt vmcnt(8)
    ds_read_b64_tr_b16 v[80:81], v12 offset:12288
    ds_read_b64_tr_b16 v[82:83], v12 offset:12800
    v_mfma_f32_32x32x16_bf16 v[160:175], v[72:75], v[96:99], v[160:175]
    ds_read_b64_tr_b16 v[88:89], v12 offset:14336
    ds_read_b64_tr_b16 v[90:91], v12 offset:14848
    v_mfma_f32_32x32x16_bf16 v[192:207], v[64:67], v[100:103], v[192:207]
    ds_read_b128 v[104:107], v19 offset:11264
    ds_read_b128 v[108:111], v19 offset:44032
    v_mfma_f32_32x32x16_bf16 v[224:239], v[72:75], v[100:103], v[224:239]
    s_add_u32 s31, s30, 28672
    s_add_u32 m0, s28, 8192
    s_nop 0
    buffer_load_dwordx4 v11, s[8:11], s30 offen lds
    s_add_u32 m0, s28, 9216
    s_nop 0
    buffer_load_dwordx4 v11, s[8:11], s31 offen lds
    s_add_u32 m0, s28, 10240
    s_nop 0
    buffer_load_dwordx4 v11, s[12:15], s30 offen lds
    s_add_u32 m0, s28, 11264
    s_nop 0
    buffer_load_dwordx4 v11, s[12:15], s31 offen lds
    s_add_u32 s30, s30, 57344
    s_waitcnt lgkmcnt(0)
    v_mfma_f32_32x32x16_bf16 v[128:143], v[80:83], v[104:107], v[128:143]
    s_waitcnt vmcnt(8)
    ds_read_b64_tr_b16 v[64:65], v12 offset:0
    ds_read_b64_tr_b16 v[66:67], v12 offset:512
    v_mfma_f32_32x32x16_bf16 v[160:175], v[88:91], v[104:107], v[160:175]
    ds_read_b64_tr_b16 v[72:73], v12 offset:2048
    ds_read_b64_tr_b16 v[74:75], v12 offset:2560
    v_mfma_f32_32x32x16_bf16 v[192:207], v[80:83], v[108:111], v[192:207]
    ds_read_b128 v[96:99], v16 offset:12288
    ds_read_b128 v[100:103], v16 offset:45056
    v_mfma_f32_32x32x16_bf16 v[224:239], v[88:91], v[108:111], v[224:239]
    s_add_u32 s31, s30, 28672
    s_add_u32 m0, s28, 12288
    s_nop 0
    buffer_load_dwordx4 v11, s[8:11], s30 offen lds
    s_add_u32 m0, s28, 13312
    s_nop 0
    buffer_load_dwordx4 v11, s[8:11], s31 offen lds
    s_add_u32 m0, s28, 14336
    s_nop 0
    buffer_load_dwordx4 v11, s[12:15], s30 offen lds
    s_add_u32 m0, s28, 15360
    s_nop 0
    buffer_load_dwordx4 v11, s[12:15], s31 offen lds
    s_add_u32 s30, s30, 57344
    s_waitcnt lgkmcnt(0)
    v_mfma_f32_32x32x16_bf16 v[128:143], v[64:67], v[96:99], v[128:143]
    s_waitcnt vmcnt(8)
    ds_read_b64_tr_b16 v[80:81], v12 offset:4096
    ds_read_b64_tr_b16 v[82:83], v12 offset:4608
    v_mfma_f32_32x32x16_bf16 v[160:175], v[72:75], v[96:99], v[160:175]
    ds_read_b64_tr_b16 v[88:89], v12 offset:6144
    ds_read_b64_tr_b16 v[90:91], v12 offset:6656
    v_mfma_f32_32x32x16_bf16 v[192:207], v[64:67], v[100:103], v[192:207]
    ds_read_b128 v[104:107], v17 offset:13312
    ds_read_b128 v[108:111], v17 offset:46080
    v_mfma_f32_32x32x16_bf16 v[224:239], v[72:75], v[100:103], v[224:239]
    s_add_u32 s31, s30, 28672
    s_add_u32 m0, s28, 0
    s_nop 0
    buffer_load_dwordx4 v11, s[8:11], s30 offen lds
    s_add_u32 m0, s28, 1024
    s_nop 0
    buffer_load_dwordx4 v11, s[8:11], s31 offen lds
    s_add_u32 m0, s28, 2048
    s_nop 0
    buffer_load_dwordx4 v11, s[12:15], s30 offen lds
    s_add_u32 m0, s28, 3072
    s_nop 0
    buffer_load_dwordx4 v11, s[12:15], s31 offen lds
    s_add_u32 s30, s30, 57344
    s_waitcnt lgkmcnt(0)
    v_mfma_f32_32x32x16_bf16 v[128:143], v[80:83], v[104:107], v[128:143]
    s_waitcnt vmcnt(8)
    ds_read_b64_tr_b16 v[64:65], v12 offset:8192
    ds_read_b64_tr_b16 v[66:67], v12 offset:8704
    v_mfma_f32_32x32x16_bf16 v[160:175], v[88:91], v[104:107], v[160:175]
    ds_read_b64_tr_b16 v[72:73], v12 offset:10240
    ds_read_b64_tr_b16 v[74:75], v12 offset:10752
    v_mfma_f32_32x32x16_bf16 v[192:207], v[80:83], v[108:111], v[192:207]
    ds_read_b128 v[96:99], v18 offset:14336
    ds_read_b128 v[100:103], v18 offset:47104
    v_mfma_f32_32x32x16_bf16 v[224:239], v[88:91], v[108:111], v[224:239]
    s_add_u32 s31, s30, 28672
    s_add_u32 m0, s28, 4096
    s_nop 0
    buffer_load_dwordx4 v11, s[8:11], s30 offen lds
    s_add_u32 m0, s28, 5120
    s_nop 0
    buffer_load_dwordx4 v11, s[8:11], s31 offen lds
    s_add_u32 m0, s28, 6144
    s_nop 0
    buffer_load_dwordx4 v11, s[12:15], s30 offen lds
    s_add_u32 m0, s28, 7168
    s_nop 0
    buffer_load_dwordx4 v11, s[12:15], s31 offen lds
    s_add_u32 s30, s30, 57344
    s_waitcnt lgkmcnt(0)
    v_mfma_f32_32x32x16_bf16 v[128:143], v[64:67], v[96:99], v[128:143]
    s_waitcnt vmcnt(8)
    ds_read_b64_tr_b16 v[80:81], v12 offset:12288
    ds_read_b64_tr_b16 v[82:83], v12 offset:12800
    v_mfma_f32_32x32x16_bf16 v[160:175], v[72:75], v[96:99], v[160:175]
    ds_read_b64_tr_b16 v[88:89], v12 offset:14336
    ds_read_b64_tr_b16 v[90:91], v12 offset:14848
    v_mfma_f32_32x32x16_bf16 v[192:207], v[64:67], v[100:103], v[192:207]
    ds_read_b128 v[104:107], v19 offset:15360
    ds_read_b128 v[108:111], v19 offset:48128
    v_mfma_f32_32x32x16_bf16 v[224:239], v[72:75], v[100:103], v[224:239]
    s_add_u32 s31, s30, 28672
    s_add_u32 m0, s28, 8192
    s_nop 0
    buffer_load_dwordx4 v11, s[8:11], s30 offen lds
    s_add_u32 m0, s28, 9216
    s_nop 0
    buffer_load_dwordx4 v11, s[8:11], s31 offen lds
    s_add_u32 m0, s28, 10240
    s_nop 0
    buffer_load_dwordx4 v11, s[12:15], s30 offen lds
    s_add_u32 m0, s28, 11264
    s_nop 0
    buffer_load_dwordx4 v11, s[12:15], s31 offen lds
    s_add_u32 s30, s30, 57344
    s_waitcnt lgkmcnt(0)
    v_mfma_f32_32x32x16_bf16 v[128:143], v[80:83], v[104:107], v[128:143]
    s_waitcnt vmcnt(8)
    ds_read_b64_tr_b16 v[64:65], v12 offset:0
    ds_read_b64_tr_b16 v[66:67], v12 offset:512
    v_mfma_f32_32x32x16_bf16 v[160:175], v[88:91], v[104:107], v[160:175]
    ds_read_b64_tr_b16 v[72:73], v12 offset:2048
    ds_read_b64_tr_b16 v[74:75], v12 offset:2560
    v_mfma_f32_32x32x16_bf16 v[192:207], v[80:83], v[108:111], v[192:207]
    ds_read_b128 v[96:99], v16 offset:16384
    ds_read_b128 v[100:103], v16 offset:49152
    v_mfma_f32_32x32x16_bf16 v[224:239], v[88:91], v[108:111], v[224:239]
    s_add_u32 s31, s30, 28672
    s_add_u32 m0, s28, 12288
    s_nop 0
    buffer_load_dwordx4 v11, s[8:11], s30 offen lds
    s_add_u32 m0, s28, 13312
    s_nop 0
    buffer_load_dwordx4 v11, s[8:11], s31 offen lds
    s_add_u32 m0, s28, 14336
    s_nop 0
    buffer_load_dwordx4 v11, s[12:15], s30 offen lds
    s_add_u32 m0, s28, 15360
    s_nop 0
    buffer_load_dwordx4 v11, s[12:15], s31 offen lds
    s_add_u32 s30, s30, 57344
    s_waitcnt lgkmcnt(0)
    v_mfma_f32_32x32x16_bf16 v[128:143], v[64:67], v[96:99], v[128:143]
    s_waitcnt vmcnt(8)
    ds_read_b64_tr_b16 v[80:81], v12 offset:4096
    ds_read_b64_tr_b16 v[82:83], v12 offset:4608
    v_mfma_f32_32x32x16_bf16 v[160:175], v[72:75], v[96:99], v[160:175]
    ds_read_b64_tr_b16 v[88:89], v12 offset:6144
    ds_read_b64_tr_b16 v[90:91], v12 offset:6656
    v_mfma_f32_32x32x16_bf16 v[192:207], v[64:67], v[100:103], v[192:207]
    ds_read_b128 v[104:107], v17 offset:17408
    ds_read_b128 v[108:111], v17 offset:50176
    v_mfma_f32_32x32x16_bf16 v[224:239], v[72:75], v[100:103], v[224:239]
    s_add_u32 s31, s30, 28672
    s_add_u32 m0, s28, 0
    s_nop 0
    buffer_load_dwordx4 v11, s[8:11], s30 offen lds
    s_add_u32 m0, s28, 1024
    s_nop 0
    buffer_load_dwordx4 v11, s[8:11], s31 offen lds
    s_add_u32 m0, s28, 2048
    s_nop 0
    buffer_load_dwordx4 v11, s[12:15], s30 offen lds
    s_add_u32 m0, s28, 3072
    s_nop 0
    buffer_load_dwordx4 v11, s[12:15], s31 offen lds
    s_add_u32 s30, s30, 57344
    s_waitcnt lgkmcnt(0)
    v_mfma_f32_32x32x16_bf16 v[128:143], v[80:83], v[104:107], v[128:143]
    s_waitcnt vmcnt(8)
    ds_read_b64_tr_b16 v[64:65], v12 offset:8192
    ds_read_b64_tr_b16 v[66:67], v12 offset:8704
    v_mfma_f32_32x32x16_bf16 v[160:175], v[88:91], v[104:107], v[160:175]
    ds_read_b64_tr_b16 v[72:73], v12 offset:10240
    ds_read_b64_tr_b16 v[74:75], v12 offset:10752
    v_mfma_f32_32x32x16_bf16 v[192:207], v[80:83], v[108:111], v[192:207]
    ds_read_b128 v[96:99], v18 offset:18432
    ds_read_b128 v[100:103], v18 offset:51200
    v_mfma_f32_32x32x16_bf16 v[224:239], v[88:91], v[108:111], v[224:239]
    s_add_u32 s31, s30, 28672
    s_add_u32 m0, s28, 4096
    s_nop 0
    buffer_load_dwordx4 v11, s[8:11], s30 offen lds
    s_add_u32 m0, s28, 5120
    s_nop 0
    buffer_load_dwordx4 v11, s[8:11], s31 offen lds
    s_add_u32 m0, s28, 6144
    s_nop 0
    buffer_load_dwordx4 v11, s[12:15], s30 offen lds
    s_add_u32 m0, s28, 7168
    s_nop 0
    buffer_load_dwordx4 v11, s[12:15], s31 offen lds
    s_add_u32 s30, s30, 57344
    s_waitcnt lgkmcnt(0)
    v_mfma_f32_32x32x16_bf16 v[128:143], v[64:67], v[96:99], v[128:143]
    s_waitcnt vmcnt(8)
    ds_read_b64_tr_b16 v[80:81], v12 offset:12288
    ds_read_b64_tr_b16 v[82:83], v12 offset:12800
    v_mfma_f32_32x32x16_bf16 v[160:175], v[72:75], v[96:99], v[160:175]
    ds_read_b64_tr_b16 v[88:89], v12 offset:14336
    ds_read_b64_tr_b16 v[90:91], v12 offset:14848
    v_mfma_f32_32x32x16_bf16 v[192:207], v[64:67], v[100:103], v[192:207]
    ds_read_b128 v[104:107], v19 offset:19456
    ds_read_b128 v[108:111], v19 offset:52224
    v_mfma_f32_32x32x16_bf16 v[224:239], v[72:75], v[100:103], v[224:239]
    s_add_u32 s31, s30, 28672
    s_add_u32 m0, s28, 8192
    s_nop 0
    buffer_load_dwordx4 v11, s[8:11], s30 offen lds
    s_add_u32 m0, s28, 9216
    s_nop 0
    buffer_load_dwordx4 v11, s[8:11], s31 offen lds
    s_add_u32 m0, s28, 10240
    s_nop 0
    buffer_load_dwordx4 v11, s[12:15], s30 offen lds
    s_add_u32 m0, s28, 11264
    s_nop 0
    buffer_load_dwordx4 v11, s[12:15], s31 offen lds
    s_add_u32 s30, s30, 57344
    s_waitcnt lgkmcnt(0)
    v_mfma_f32_32x32x16_bf16 v[128:143], v[80:83], v[104:107], v[128:143]
    s_waitcnt vmcnt(8)
    ds_read_b64_tr_b16 v[64:65], v12 offset:0
    ds_read_b64_tr_b16 v[66:67], v12 offset:512
    v_mfma_f32_32x32x16_bf16 v[160:175], v[88:91], v[104:107], v[160:175]
    ds_read_b64_tr_b16 v[72:73], v12 offset:2048
    ds_read_b64_tr_b16 v[74:75], v12 offset:2560
    v_mfma_f32_32x32x16_bf16 v[192:207], v[80:83], v[108:111], v[192:207]
    ds_read_b128 v[96:99], v16 offset:20480
    ds_read_b128 v[100:103], v16 offset:53248
    v_mfma_f32_32x32x16_bf16 v[224:239], v[88:91], v[108:111], v[224:239]
    s_add_u32 s31, s30, 28672
    s_add_u32 m0, s28, 12288
    s_nop 0
    buffer_load_dwordx4 v11, s[8:11], s30 offen lds
    s_add_u32 m0, s28, 13312
    s_nop 0
    buffer_load_dwordx4 v11, s[8:11], s31 offen lds
    s_add_u32 m0, s28, 14336
    s_nop 0
    buffer_load_dwordx4 v11, s[12:15], s30 offen lds
    s_add_u32 m0, s28, 15360
    s_nop 0
    buffer_load_dwordx4 v11, s[12:15], s31 offen lds
    s_add_u32 s30, s30, 57344
    s_waitcnt lgkmcnt(0)
    v_mfma_f32_32x32x16_bf16 v[128:143], v[64:67], v[96:99], v[128:143]
    s_waitcnt vmcnt(8)
    ds_read_b64_tr_b16 v[80:81], v12 offset:4096
    ds_read_b64_tr_b16 v[82:83], v12 offset:4608
    v_mfma_f32_32x32x16_bf16 v[160:175], v[72:75], v[96:99], v[160:175]
    ds_read_b64_tr_b16 v[88:89], v12 offset:6144
    ds_read_b64_tr_b16 v[90:91], v12 offset:6656
    v_mfma_f32_32x32x16_bf16 v[192:207], v[64:67], v[100:103], v[192:207]
    ds_read_b128 v[104:107], v17 offset:21504
    ds_read_b128 v[108:111], v17 offset:54272
    v_mfma_f32_32x32x16_bf16 v[224:239], v[72:75], v[100:103], v[224:239]
    s_add_u32 s31, s30, 28672
    s_add_u32 m0, s28, 0
    s_nop 0
    buffer_load_dwordx4 v11, s[8:11], s30 offen lds
    s_add_u32 m0, s28, 1024
    s_nop 0
    buffer_load_dwordx4 v11, s[8:11], s31 offen lds
    s_add_u32 m0, s28, 2048
    s_nop 0
    buffer_load_dwordx4 v11, s[12:15], s30 offen lds
    s_add_u32 m0, s28, 3072
    s_nop 0
    buffer_load_dwordx4 v11, s[12:15], s31 offen lds
    s_add_u32 s30, s30, 57344
    s_waitcnt lgkmcnt(0)
    v_mfma_f32_32x32x16_bf16 v[128:143], v[80:83], v[104:107], v[128:143]
    s_waitcnt vmcnt(8)
    ds_read_b64_tr_b16 v[64:65], v12 offset:8192
    ds_read_b64_tr_b16 v[66:67], v12 offset:8704
    v_mfma_f32_32x32x16_bf16 v[160:175], v[88:91], v[104:107], v[160:175]
    ds_read_b64_tr_b16 v[72:73], v12 offset:10240
    ds_read_b64_tr_b16 v[74:75], v12 offset:10752
    v_mfma_f32_32x32x16_bf16 v[192:207], v[80:83], v[108:111], v[192:207]
    ds_read_b128 v[96:99], v18 offset:22528
    ds_read_b128 v[100:103], v18 offset:55296
    v_mfma_f32_32x32x16_bf16 v[224:239], v[88:91], v[108:111], v[224:239]
    s_add_u32 s31, s30, 28672
    s_add_u32 m0, s28, 4096
    s_nop 0
    buffer_load_dwordx4 v11, s[8:11], s30 offen lds
    s_add_u32 m0, s28, 5120
    s_nop 0
    buffer_load_dwordx4 v11, s[8:11], s31 offen lds
    s_add_u32 m0, s28, 6144
    s_nop 0
    buffer_load_dwordx4 v11, s[12:15], s30 offen lds
    s_add_u32 m0, s28, 7168
    s_nop 0
    buffer_load_dwordx4 v11, s[12:15], s31 offen lds
    s_add_u32 s30, s30, 57344
    s_waitcnt lgkmcnt(0)
    v_mfma_f32_32x32x16_bf16 v[128:143], v[64:67], v[96:99], v[128:143]
    s_waitcnt vmcnt(8)
    ds_read_b64_tr_b16 v[80:81], v12 offset:12288
    ds_read_b64_tr_b16 v[82:83], v12 offset:12800
    v_mfma_f32_32x32x16_bf16 v[160:175], v[72:75], v[96:99], v[160:175]
    ds_read_b64_tr_b16 v[88:89], v12 offset:14336
    ds_read_b64_tr_b16 v[90:91], v12 offset:14848
    v_mfma_f32_32x32x16_bf16 v[192:207], v[64:67], v[100:103], v[192:207]
    ds_read_b128 v[104:107], v19 offset:23552
    ds_read_b128 v[108:111], v19 offset:56320
    v_mfma_f32_32x32x16_bf16 v[224:239], v[72:75], v[100:103], v[224:239]
    s_add_u32 s31, s30, 28672
    s_add_u32 m0, s28, 8192
    s_nop 0
    buffer_load_dwordx4 v11, s[8:11], s30 offen lds
    s_add_u32 m0, s28, 9216
    s_nop 0
    buffer_load_dwordx4 v11, s[8:11], s31 offen lds
    s_add_u32 m0, s28, 10240
    s_nop 0
    buffer_load_dwordx4 v11, s[12:15], s30 offen lds
    s_add_u32 m0, s28, 11264
    s_nop 0
    buffer_load_dwordx4 v11, s[12:15], s31 offen lds
    s_add_u32 s30, s30, 57344
    s_waitcnt lgkmcnt(0)
    v_mfma_f32_32x32x16_bf16 v[128:143], v[80:83], v[104:107], v[128:143]
    s_waitcnt vmcnt(8)
    ds_read_b64_tr_b16 v[64:65], v12 offset:0
    ds_read_b64_tr_b16 v[66:67], v12 offset:512
    v_mfma_f32_32x32x16_bf16 v[160:175], v[88:91], v[104:107], v[160:175]
    ds_read_b64_tr_b16 v[72:73], v12 offset:2048
    ds_read_b64_tr_b16 v[74:75], v12 offset:2560
    v_mfma_f32_32x32x16_bf16 v[192:207], v[80:83], v[108:111], v[192:207]
    ds_read_b128 v[96:99], v16 offset:24576
    ds_read_b128 v[100:103], v16 offset:57344
    v_mfma_f32_32x32x16_bf16 v[224:239], v[88:91], v[108:111], v[224:239]
    s_add_u32 s31, s30, 28672
    s_add_u32 m0, s28, 12288
    s_nop 0
    buffer_load_dwordx4 v11, s[8:11], s30 offen lds
    s_add_u32 m0, s28, 13312
    s_nop 0
    buffer_load_dwordx4 v11, s[8:11], s31 offen lds
    s_add_u32 m0, s28, 14336
    s_nop 0
    buffer_load_dwordx4 v11, s[12:15], s30 offen lds
    s_add_u32 m0, s28, 15360
    s_nop 0
    buffer_load_dwordx4 v11, s[12:15], s31 offen lds
    s_add_u32 s30, s30, 57344
    s_waitcnt lgkmcnt(0)
    v_mfma_f32_32x32x16_bf16 v[128:143], v[64:67], v[96:99], v[128:143]
    s_waitcnt vmcnt(8)
    ds_read_b64_tr_b16 v[80:81], v12 offset:4096
    ds_read_b64_tr_b16 v[82:83], v12 offset:4608
    v_mfma_f32_32x32x16_bf16 v[160:175], v[72:75], v[96:99], v[160:175]
    ds_read_b64_tr_b16 v[88:89], v12 offset:6144
    ds_read_b64_tr_b16 v[90:91], v12 offset:6656
    v_mfma_f32_32x32x16_bf16 v[192:207], v[64:67], v[100:103], v[192:207]
    ds_read_b128 v[104:107], v17 offset:25600
    ds_read_b128 v[108:111], v17 offset:58368
    v_mfma_f32_32x32x16_bf16 v[224:239], v[72:75], v[100:103], v[224:239]
    s_add_u32 s31, s30, 28672
    s_add_u32 m0, s28, 0
    s_nop 0
    buffer_load_dwordx4 v11, s[8:11], s30 offen lds
    s_add_u32 m0, s28, 1024
    s_nop 0
    buffer_load_dwordx4 v11, s[8:11], s31 offen lds
    s_add_u32 m0, s28, 2048
    s_nop 0
    buffer_load_dwordx4 v11, s[12:15], s30 offen lds
    s_add_u32 m0, s28, 3072
    s_nop 0
    buffer_load_dwordx4 v11, s[12:15], s31 offen lds
    s_add_u32 s30, s30, 57344
    s_waitcnt lgkmcnt(0)
    v_mfma_f32_32x32x16_bf16 v[128:143], v[80:83], v[104:107], v[128:143]
    s_waitcnt vmcnt(8)
    ds_read_b64_tr_b16 v[64:65], v12 offset:8192
    ds_read_b64_tr_b16 v[66:67], v12 offset:8704
    v_mfma_f32_32x32x16_bf16 v[160:175], v[88:91], v[104:107], v[160:175]
    ds_read_b64_tr_b16 v[72:73], v12 offset:10240
    ds_read_b64_tr_b16 v[74:75], v12 offset:10752
    v_mfma_f32_32x32x16_bf16 v[192:207], v[80:83], v[108:111], v[192:207]
    ds_read_b128 v[96:99], v18 offset:26624
    ds_read_b128 v[100:103], v18 offset:59392
    v_mfma_f32_32x32x16_bf16 v[224:239], v[88:91], v[108:111], v[224:239]
    s_add_u32 s31, s30, 28672
    s_add_u32 m0, s28, 4096
    s_nop 0
    buffer_load_dwordx4 v11, s[8:11], s30 offen lds
    s_add_u32 m0, s28, 5120
    s_nop 0
    buffer_load_dwordx4 v11, s[8:11], s31 offen lds
    s_add_u32 m0, s28, 6144
    s_nop 0
    buffer_load_dwordx4 v11, s[12:15], s30 offen lds
    s_add_u32 m0, s28, 7168
    s_nop 0
    buffer_load_dwordx4 v11, s[12:15], s31 offen lds
    s_add_u32 s30, s30, 57344
    s_waitcnt lgkmcnt(0)
    v_mfma_f32_32x32x16_bf16 v[128:143], v[64:67], v[96:99], v[128:143]
    s_waitcnt vmcnt(8)
    ds_read_b64_tr_b16 v[80:81], v12 offset:12288
    ds_read_b64_tr_b16 v[82:83], v12 offset:12800
    v_mfma_f32_32x32x16_bf16 v[160:175], v[72:75], v[96:99], v[160:175]
    ds_read_b64_tr_b16 v[88:89], v12 offset:14336
    ds_read_b64_tr_b16 v[90:91], v12 offset:14848
    v_mfma_f32_32x32x16_bf16 v[192:207], v[64:67], v[100:103], v[192:207]
    ds_read_b128 v[104:107], v19 offset:27648
    ds_read_b128 v[108:111], v19 offset:60416
    v_mfma_f32_32x32x16_bf16 v[224:239], v[72:75], v[100:103], v[224:239]
    s_add_u32 s31, s30, 28672
    s_add_u32 m0, s28, 8192
    s_nop 0
    buffer_load_dwordx4 v11, s[8:11], s30 offen lds
    s_add_u32 m0, s28, 9216
    s_nop 0
    buffer_load_dwordx4 v11, s[8:11], s31 offen lds
    s_add_u32 m0, s28, 10240
    s_nop 0
    buffer_load_dwordx4 v11, s[12:15], s30 offen lds
    s_add_u32 m0, s28, 11264
    s_nop 0
    buffer_load_dwordx4 v11, s[12:15], s31 offen lds
    s_add_u32 s30, s30, 57344
    s_waitcnt lgkmcnt(0)
    v_mfma_f32_32x32x16_bf16 v[128:143], v[80:83], v[104:107], v[128:143]
    s_waitcnt vmcnt(8)
    ds_read_b64_tr_b16 v[64:65], v12 offset:0
    ds_read_b64_tr_b16 v[66:67], v12 offset:512
    v_mfma_f32_32x32x16_bf16 v[160:175], v[88:91], v[104:107], v[160:175]
    ds_read_b64_tr_b16 v[72:73], v12 offset:2048
    ds_read_b64_tr_b16 v[74:75], v12 offset:2560
    v_mfma_f32_32x32x16_bf16 v[192:207], v[80:83], v[108:111], v[192:207]
    ds_read_b128 v[96:99], v16 offset:28672
    ds_read_b128 v[100:103], v16 offset:61440
    v_mfma_f32_32x32x16_bf16 v[224:239], v[88:91], v[108:111], v[224:239]
    s_add_u32 s31, s30, 28672
    s_add_u32 m0, s28, 12288
    s_nop 0
    buffer_load_dwordx4 v11, s[8:11], s30 offen lds
    s_add_u32 m0, s28, 13312
    s_nop 0
    buffer_load_dwordx4 v11, s[8:11], s31 offen lds
    s_add_u32 m0, s28, 14336
    s_nop 0
    buffer_load_dwordx4 v11, s[12:15], s30 offen lds
    s_add_u32 m0, s28, 15360
    s_nop 0
    buffer_load_dwordx4 v11, s[12:15], s31 offen lds
    s_add_u32 s30, s30, 57344
    s_waitcnt lgkmcnt(0)
    v_mfma_f32_32x32x16_bf16 v[128:143], v[64:67], v[96:99], v[128:143]
    s_waitcnt vmcnt(8)
    ds_read_b64_tr_b16 v[80:81], v12 offset:4096
    ds_read_b64_tr_b16 v[82:83], v12 offset:4608
    v_mfma_f32_32x32x16_bf16 v[160:175], v[72:75], v[96:99], v[160:175]
    ds_read_b64_tr_b16 v[88:89], v12 offset:6144
    ds_read_b64_tr_b16 v[90:91], v12 offset:6656
    v_mfma_f32_32x32x16_bf16 v[192:207], v[64:67], v[100:103], v[192:207]
    ds_read_b128 v[104:107], v17 offset:29696
    ds_read_b128 v[108:111], v17 offset:62464
    v_mfma_f32_32x32x16_bf16 v[224:239], v[72:75], v[100:103], v[224:239]
    s_waitcnt lgkmcnt(0)
    v_mfma_f32_32x32x16_bf16 v[128:143], v[80:83], v[104:107], v[128:143]
    s_waitcnt vmcnt(4)
    ds_read_b64_tr_b16 v[64:65], v12 offset:8192
    ds_read_b64_tr_b16 v[66:67], v12 offset:8704
    v_mfma_f32_32x32x16_bf16 v[160:175], v[88:91], v[104:107], v[160:175]
    ds_read_b64_tr_b16 v[72:73], v12 offset:10240
    ds_read_b64_tr_b16 v[74:75], v12 offset:10752
    v_mfma_f32_32x32x16_bf16 v[192:207], v[80:83], v[108:111], v[192:207]
    ds_read_b128 v[96:99], v18 offset:30720
    ds_read_b128 v[100:103], v18 offset:63488
    v_mfma_f32_32x32x16_bf16 v[224:239], v[88:91], v[108:111], v[224:239]
    s_waitcnt lgkmcnt(0)
    v_mfma_f32_32x32x16_bf16 v[128:143], v[64:67], v[96:99], v[128:143]
    s_waitcnt vmcnt(0)
    ds_read_b64_tr_b16 v[80:81], v12 offset:12288
    ds_read_b64_tr_b16 v[82:83], v12 offset:12800
    v_mfma_f32_32x32x16_bf16 v[160:175], v[72:75], v[96:99], v[160:175]
    ds_read_b64_tr_b16 v[88:89], v12 offset:14336
    ds_read_b64_tr_b16 v[90:91], v12 offset:14848
    v_mfma_f32_32x32x16_bf16 v[192:207], v[64:67], v[100:103], v[192:207]
    ds_read_b128 v[104:107], v19 offset:31744
    ds_read_b128 v[108:111], v19 offset:64512
    v_mfma_f32_32x32x16_bf16 v[224:239], v[72:75], v[100:103], v[224:239]
    s_waitcnt lgkmcnt(0)
    v_mfma_f32_32x32x16_bf16 v[128:143], v[80:83], v[104:107], v[128:143]
    v_mfma_f32_32x32x16_bf16 v[160:175], v[88:91], v[104:107], v[160:175]
    v_mfma_f32_32x32x16_bf16 v[192:207], v[80:83], v[108:111], v[192:207]
    v_mfma_f32_32x32x16_bf16 v[224:239], v[88:91], v[108:111], v[224:239]
    s_mov_b32 s31, 0xbfb8aa3b
    s_mov_b32 s30, s31
    s_mov_b32 s31, 1.0
    s_setprio 2
    s_nop 4
    v_pk_mul_f32 v[128:129], v[128:129], s[30:31] op_sel_hi:[1,0]
    v_pk_mul_f32 v[130:131], v[130:131], s[30:31] op_sel_hi:[1,0]
    v_pk_mul_f32 v[132:133], v[132:133], s[30:31] op_sel_hi:[1,0]
    v_pk_mul_f32 v[134:135], v[134:135], s[30:31] op_sel_hi:[1,0]
    v_pk_mul_f32 v[136:137], v[136:137], s[30:31] op_sel_hi:[1,0]
    v_pk_mul_f32 v[138:139], v[138:139], s[30:31] op_sel_hi:[1,0]
    v_pk_mul_f32 v[140:141], v[140:141], s[30:31] op_sel_hi:[1,0]
    v_pk_mul_f32 v[142:143], v[142:143], s[30:31] op_sel_hi:[1,0]
    v_exp_f32 v128, v128
    v_exp_f32 v129, v129
    v_exp_f32 v130, v130
    v_exp_f32 v131, v131
    v_exp_f32 v132, v132
    v_exp_f32 v133, v133
    v_exp_f32 v134, v134
    v_exp_f32 v135, v135
    v_exp_f32 v136, v136
    v_exp_f32 v137, v137
    v_exp_f32 v138, v138
    v_exp_f32 v139, v139
    v_exp_f32 v140, v140
    v_exp_f32 v141, v141
    v_exp_f32 v142, v142
    v_exp_f32 v143, v143
    v_pk_add_f32 v[128:129], v[128:129], s[30:31] op_sel:[0,1] op_sel_hi:[1,1]
    v_pk_add_f32 v[130:131], v[130:131], s[30:31] op_sel:[0,1] op_sel_hi:[1,1]
    v_pk_add_f32 v[132:133], v[132:133], s[30:31] op_sel:[0,1] op_sel_hi:[1,1]
    v_pk_add_f32 v[134:135], v[134:135], s[30:31] op_sel:[0,1] op_sel_hi:[1,1]
    v_pk_add_f32 v[136:137], v[136:137], s[30:31] op_sel:[0,1] op_sel_hi:[1,1]
    v_pk_add_f32 v[138:139], v[138:139], s[30:31] op_sel:[0,1] op_sel_hi:[1,1]
    v_pk_add_f32 v[140:141], v[140:141], s[30:31] op_sel:[0,1] op_sel_hi:[1,1]
    v_pk_add_f32 v[142:143], v[142:143], s[30:31] op_sel:[0,1] op_sel_hi:[1,1]
    v_rcp_f32 v128, v128
    v_rcp_f32 v129, v129
    v_rcp_f32 v130, v130
    v_rcp_f32 v131, v131
    v_rcp_f32 v132, v132
    v_rcp_f32 v133, v133
    v_rcp_f32 v134, v134
    v_rcp_f32 v135, v135
    v_rcp_f32 v136, v136
    v_rcp_f32 v137, v137
    v_rcp_f32 v138, v138
    v_rcp_f32 v139, v139
    v_rcp_f32 v140, v140
    v_rcp_f32 v141, v141
    v_rcp_f32 v142, v142
    v_rcp_f32 v143, v143
    v_pk_mul_f32 v[128:129], v[128:129], v[160:161]
    v_pk_mul_f32 v[130:131], v[130:131], v[162:163]
    v_pk_mul_f32 v[132:133], v[132:133], v[164:165]
    v_pk_mul_f32 v[134:135], v[134:135], v[166:167]
    v_pk_mul_f32 v[136:137], v[136:137], v[168:169]
    v_pk_mul_f32 v[138:139], v[138:139], v[170:171]
    v_pk_mul_f32 v[140:141], v[140:141], v[172:173]
    v_pk_mul_f32 v[142:143], v[142:143], v[174:175]
    v_cvt_pk_bf16_f32 v64, v128, v129
    v_cvt_pk_bf16_f32 v65, v130, v131
    v_cvt_pk_bf16_f32 v66, v132, v133
    v_cvt_pk_bf16_f32 v67, v134, v135
    v_cvt_pk_bf16_f32 v68, v136, v137
    v_cvt_pk_bf16_f32 v69, v138, v139
    v_cvt_pk_bf16_f32 v70, v140, v141
    v_cvt_pk_bf16_f32 v71, v142, v143
    buffer_store_dwordx4 v[64:67], v20, s[40:43], s48 offen offset:0 sc1
    buffer_store_dwordx4 v[68:71], v20, s[40:43], s48 offen offset:1024 sc1
    v_pk_mul_f32 v[192:193], v[192:193], s[30:31] op_sel_hi:[1,0]
    v_pk_mul_f32 v[194:195], v[194:195], s[30:31] op_sel_hi:[1,0]
    v_pk_mul_f32 v[196:197], v[196:197], s[30:31] op_sel_hi:[1,0]
    v_pk_mul_f32 v[198:199], v[198:199], s[30:31] op_sel_hi:[1,0]
    v_pk_mul_f32 v[200:201], v[200:201], s[30:31] op_sel_hi:[1,0]
    v_pk_mul_f32 v[202:203], v[202:203], s[30:31] op_sel_hi:[1,0]
    v_pk_mul_f32 v[204:205], v[204:205], s[30:31] op_sel_hi:[1,0]
    v_pk_mul_f32 v[206:207], v[206:207], s[30:31] op_sel_hi:[1,0]
    v_exp_f32 v192, v192
    v_exp_f32 v193, v193
    v_exp_f32 v194, v194
    v_exp_f32 v195, v195
    v_exp_f32 v196, v196
    v_exp_f32 v197, v197
    v_exp_f32 v198, v198
    v_exp_f32 v199, v199
    v_exp_f32 v200, v200
    v_exp_f32 v201, v201
    v_exp_f32 v202, v202
    v_exp_f32 v203, v203
    v_exp_f32 v204, v204
    v_exp_f32 v205, v205
    v_exp_f32 v206, v206
    v_exp_f32 v207, v207
    v_pk_add_f32 v[192:193], v[192:193], s[30:31] op_sel:[0,1] op_sel_hi:[1,1]
    v_pk_add_f32 v[194:195], v[194:195], s[30:31] op_sel:[0,1] op_sel_hi:[1,1]
    v_pk_add_f32 v[196:197], v[196:197], s[30:31] op_sel:[0,1] op_sel_hi:[1,1]
    v_pk_add_f32 v[198:199], v[198:199], s[30:31] op_sel:[0,1] op_sel_hi:[1,1]
    v_pk_add_f32 v[200:201], v[200:201], s[30:31] op_sel:[0,1] op_sel_hi:[1,1]
    v_pk_add_f32 v[202:203], v[202:203], s[30:31] op_sel:[0,1] op_sel_hi:[1,1]
    v_pk_add_f32 v[204:205], v[204:205], s[30:31] op_sel:[0,1] op_sel_hi:[1,1]
    v_pk_add_f32 v[206:207], v[206:207], s[30:31] op_sel:[0,1] op_sel_hi:[1,1]
    v_rcp_f32 v192, v192
    v_rcp_f32 v193, v193
    v_rcp_f32 v194, v194
    v_rcp_f32 v195, v195
    v_rcp_f32 v196, v196
    v_rcp_f32 v197, v197
    v_rcp_f32 v198, v198
    v_rcp_f32 v199, v199
    v_rcp_f32 v200, v200
    v_rcp_f32 v201, v201
    v_rcp_f32 v202, v202
    v_rcp_f32 v203, v203
    v_rcp_f32 v204, v204
    v_rcp_f32 v205, v205
    v_rcp_f32 v206, v206
    v_rcp_f32 v207, v207
    v_pk_mul_f32 v[192:193], v[192:193], v[224:225]
    v_pk_mul_f32 v[194:195], v[194:195], v[226:227]
    v_pk_mul_f32 v[196:197], v[196:197], v[228:229]
    v_pk_mul_f32 v[198:199], v[198:199], v[230:231]
    v_pk_mul_f32 v[200:201], v[200:201], v[232:233]
    v_pk_mul_f32 v[202:203], v[202:203], v[234:235]
    v_pk_mul_f32 v[204:205], v[204:205], v[236:237]
    v_pk_mul_f32 v[206:207], v[206:207], v[238:239]
    v_cvt_pk_bf16_f32 v72, v192, v193
    v_cvt_pk_bf16_f32 v73, v194, v195
    v_cvt_pk_bf16_f32 v74, v196, v197
    v_cvt_pk_bf16_f32 v75, v198, v199
    v_cvt_pk_bf16_f32 v76, v200, v201
    v_cvt_pk_bf16_f32 v77, v202, v203
    v_cvt_pk_bf16_f32 v78, v204, v205
    v_cvt_pk_bf16_f32 v79, v206, v207
    buffer_store_dwordx4 v[72:75], v20, s[40:43], s48 offen offset:2048 sc1
    buffer_store_dwordx4 v[76:79], v20, s[40:43], s48 offen offset:3072 sc1
    s_setprio 1
Y_GDONE:
    s_mov_b64 exec, 1
    v_mov_b32 v2, 159760
    v_mov_b32 v3, 1
    ds_add_u32 v2, v3
    s_mov_b64 exec, -1
    s_load_dwordx2 s[4:5], s[0:1], 56
    s_mov_b32 s6, 2097152
    v_mov_b32 v2, 159800
Y_GNC:
    ds_read_b64 v[4:5], v2
    s_waitcnt lgkmcnt(0)
    v_readfirstlane_b32 s2, v4
    v_readfirstlane_b32 s3, v5
    s_cmp_lg_u32 s2, 0
    s_cbranch_scc1 Y_GNC_OK
    s_sleep 1
    s_branch Y_GNC
Y_GNC_OK:
    s_waitcnt vmcnt(0) lgkmcnt(0)
    s_mov_b32 s46, s73
    s_mov_b32 s47, 0
    s_lshl_b64 s[46:47], s[46:47], s49
    s_mov_b64 exec, s[46:47]
    v_mov_b32 v4, s2
    v_mov_b32 v5, s3
    buffer_store_dwordx2 v[4:5], v8, s[40:43], s99 offen sc1
    s_mov_b64 exec, -1
    s_mul_i32 s21, s19, 114688
    s_sub_u32 s47, s16, 4
    s_mul_i32 s22, s47, 28672
    s_add_u32 s21, s21, s22
    s_lshl_b32 s22, s18, 7
    s_add_u32 s21, s21, s22
    s_add_u32 s46, s32, s21
    s_addc_u32 s47, s33, 0
    s_load_dword s20, s[46:47], 0
    s_load_dword s20, s[46:47], 1024
    s_load_dword s20, s[46:47], 2048
    s_load_dword s20, s[46:47], 3072
    s_load_dword s20, s[46:47], 4096
    s_load_dword s20, s[46:47], 5120
    s_load_dword s20, s[46:47], 6144
    s_load_dword s20, s[46:47], 7168
    s_load_dword s20, s[46:47], 8192
    s_load_dword s20, s[46:47], 9216
    s_load_dword s20, s[46:47], 10240
    s_load_dword s20, s[46:47], 11264
    s_load_dword s20, s[46:47], 12288
    s_load_dword s20, s[46:47], 13312
    s_load_dword s20, s[46:47], 14336
    s_load_dword s20, s[46:47], 15360
    s_load_dword s20, s[46:47], 16384
    s_load_dword s20, s[46:47], 17408
    s_load_dword s20, s[46:47], 18432
    s_load_dword s20, s[46:47], 19456
    s_load_dword s20, s[46:47], 20480
    s_load_dword s20, s[46:47], 21504
    s_load_dword s20, s[46:47], 22528
    s_load_dword s20, s[46:47], 23552
    s_load_dword s20, s[46:47], 24576
    s_load_dword s20, s[46:47], 25600
    s_load_dword s20, s[46:47], 26624
    s_load_dword s20, s[46:47], 27648
    s_lshl_b32 s21, s19, 15
    s_sub_u32 s47, s16, 4
    s_lshl_b32 s22, s47, 13
    s_add_u32 s21, s21, s22
    s_lshl_b32 s22, s18, 7
    s_add_u32 s21, s21, s22
    s_add_u32 s46, s36, s21
    s_addc_u32 s47, s37, 0
    s_load_dword s20, s[46:47], 0
    s_load_dword s20, s[46:47], 1024
    s_load_dword s20, s[46:47], 2048
    s_load_dword s20, s[46:47], 3072
    s_load_dword s20, s[46:47], 4096
    s_load_dword s20, s[46:47], 5120
    s_load_dword s20, s[46:47], 6144
    s_load_dword s20, s[46:47], 7168
    s_cmp_eq_u32 s16, 7
    v_lshrrev_b32 v2, 3, v1
    v_mul_u32_u24 v10, 1024, v2
    v_bfe_u32 v2, v1, 4, 1
    v_lshlrev_b32 v2, 2, v2
    v_and_b32 v3, 7, v1
    v_xor_b32 v2, v2, v3
    v_lshl_add_u32 v10, v2, 4, v10
    v_lshrrev_b32 v2, 5, v1
    v_lshlrev_b32 v12, 9, v2
    v_bfe_u32 v2, v1, 2, 2
    v_lshl_add_u32 v12, v2, 7, v12
    v_bfe_u32 v2, v1, 3, 1
    v_lshl_add_u32 v12, v2, 6, v12
    v_bfe_u32 v2, v1, 4, 1
    v_lshl_add_u32 v12, v2, 5, v12
    v_and_b32 v2, 3, v1
    v_lshl_add_u32 v12, v2, 3, v12
    v_add_u32 v12, s28, v12
    v_xor_b32 v13, 64, v12
    s_sub_u32 s21, s16, 4
    s_lshr_b32 s76, s21, 1
    s_and_b32 s77, s21, 1
    s_lshl_b32 s22, s77, 6
    v_xor_b32 v12, s22, v12
    v_xor_b32 v13, s22, v13
    s_lshl_b32 s79, s21, 14
    s_sub_u32 s22, s79, s28
    v_add_u32 v22, s22, v12
    v_add_u32 v23, s22, v13
    s_mul_i32 s29, s21, 458752
    s_lshl_b32 s22, s18, 7
    s_add_u32 s29, s29, s22
    s_lshl_b32 s30, s17, 3
    s_lshl_b32 s22, s21, 1
    s_add_u32 s30, s30, s22
    s_mul_i32 s30, s30, 28672
    s_add_u32 s30, s30, 10485760
    s_lshl_b32 s22, s76, 11
    s_add_u32 s48, s30, s22
    s_xor_b32 s22, s22, 2048
    s_add_u32 s49, s30, s22
    s_add_u32 s31, s29, 0
    s_add_u32 m0, s28, 0
    s_nop 0
    buffer_load_dwordx4 v10, s[32:35], s31 offen lds
    s_add_u32 s31, s29, 8192
    s_add_u32 m0, s28, 1024
    s_nop 0
    buffer_load_dwordx4 v10, s[32:35], s31 offen lds
    s_add_u32 s31, s29, 16384
    s_add_u32 m0, s28, 2048
    s_nop 0
    buffer_load_dwordx4 v10, s[32:35], s31 offen lds
    s_add_u32 s31, s29, 24576
    s_add_u32 m0, s28, 3072
    s_nop 0
    buffer_load_dwordx4 v10, s[32:35], s31 offen lds
    s_add_u32 s31, s29, 32768
    s_add_u32 m0, s28, 4096
    s_nop 0
    buffer_load_dwordx4 v10, s[32:35], s31 offen lds
    s_add_u32 s31, s29, 40960
    s_add_u32 m0, s28, 5120
    s_nop 0
    buffer_load_dwordx4 v10, s[32:35], s31 offen lds
    s_add_u32 s31, s29, 49152
    s_add_u32 m0, s28, 6144
    s_nop 0
    buffer_load_dwordx4 v10, s[32:35], s31 offen lds
    s_add_u32 s31, s29, 57344
    s_add_u32 m0, s28, 7168
    s_nop 0
    buffer_load_dwordx4 v10, s[32:35], s31 offen lds
    s_mul_i32 s22, s21, 14
    s_mov_b64 s[96:97], 0
    s_mov_b32 s74, 0x3fff
    s_mov_b32 s75, 0
    s_lshl_b64 s[74:75], s[74:75], s22
    v_mov_b32 v2, 159760
Y_GS:
    ds_read_b32 v3, v2
    s_waitcnt lgkmcnt(0)
    v_readfirstlane_b32 s46, v3
    s_nop 0
    s_cmp_ge_u32 s46, 7
    s_cbranch_scc1 Y_GS_OK
    s_sleep 2
    s_branch Y_GS
Y_GS_OK:
    s_add_u32 s31, s29, 65536
    s_add_u32 m0, s79, 0
    s_nop 0
    buffer_load_dwordx4 v10, s[32:35], s31 offen lds
    s_add_u32 s31, s29, 73728
    s_add_u32 m0, s79, 1024
    s_nop 0
    buffer_load_dwordx4 v10, s[32:35], s31 offen lds
    s_add_u32 s31, s29, 81920
    s_add_u32 m0, s79, 2048
    s_nop 0
    buffer_load_dwordx4 v10, s[32:35], s31 offen lds
    s_add_u32 s31, s29, 90112
    s_add_u32 m0, s79, 3072
    s_nop 0
    buffer_load_dwordx4 v10, s[32:35], s31 offen lds
    s_add_u32 s31, s29, 98304
    s_add_u32 m0, s79, 4096
    s_nop 0
    buffer_load_dwordx4 v10, s[32:35], s31 offen lds
    s_add_u32 s31, s29, 106496
    s_add_u32 m0, s79, 5120
    s_nop 0
    buffer_load_dwordx4 v10, s[32:35], s31 offen lds
    s_add_u32 s31, s29, 114688
    s_add_u32 m0, s79, 6144
    s_nop 0
    buffer_load_dwordx4 v10, s[32:35], s31 offen lds
    s_add_u32 s31, s29, 122880
    s_add_u32 m0, s79, 7168
    s_nop 0
    buffer_load_dwordx4 v10, s[32:35], s31 offen lds
    s_add_u32 s31, s29, 131072
    s_add_u32 m0, s79, 8192
    s_nop 0
    buffer_load_dwordx4 v10, s[32:35], s31 offen lds
    s_add_u32 s31, s29, 139264
    s_add_u32 m0, s79, 9216
    s_nop 0
    buffer_load_dwordx4 v10, s[32:35], s31 offen lds
    s_add_u32 s31, s29, 147456
    s_add_u32 m0, s79, 10240
    s_nop 0
    buffer_load_dwordx4 v10, s[32:35], s31 offen lds
    s_add_u32 s31, s29, 155648
    s_add_u32 m0, s79, 11264
    s_nop 0
    buffer_load_dwordx4 v10, s[32:35], s31 offen lds
    s_add_u32 s31, s29, 163840
    s_add_u32 m0, s79, 12288
    s_nop 0
    buffer_load_dwordx4 v10, s[32:35], s31 offen lds
    s_add_u32 s31, s29, 172032
    s_add_u32 m0, s79, 13312
    s_nop 0
    buffer_load_dwordx4 v10, s[32:35], s31 offen lds
    s_mov_b32 s98, 0
Y_P1_C:
    s_and_b64 s[46:47], s[96:97], s[74:75]
    s_cmp_eq_u64 s[46:47], s[74:75]
    s_cbranch_scc1 Y_P1_D
    s_sleep 28
    s_mov_b64 exec, s[74:75]
    buffer_load_dwordx2 v[6:7], v8, s[40:43], s99 offen sc1
    s_waitcnt vmcnt(0)
    v_cmp_eq_u64 vcc, s[2:3], v[6:7]
    s_mov_b64 exec, -1
    s_or_b64 s[96:97], s[96:97], vcc
    s_add_u32 s98, s98, 1
    s_cmp_lt_u32 s98, 0x40000
    s_cbranch_scc1 Y_P1_C
Y_P1_D:
    s_add_u32 s31, s48, 0
    buffer_load_dwordx4 v[144:147], v20, s[40:43], s31 offen
    s_add_u32 s31, s49, 0
    buffer_load_dwordx4 v[148:151], v20, s[40:43], s31 offen
    s_add_u32 s31, s48, 1024
    buffer_load_dwordx4 v[152:155], v20, s[40:43], s31 offen
    s_add_u32 s31, s49, 1024
    buffer_load_dwordx4 v[156:159], v20, s[40:43], s31 offen
    s_add_u32 s31, s48, 4096
    buffer_load_dwordx4 v[160:163], v20, s[40:43], s31 offen
    s_add_u32 s31, s49, 4096
    buffer_load_dwordx4 v[164:167], v20, s[40:43], s31 offen
    s_add_u32 s31, s48, 5120
    buffer_load_dwordx4 v[168:171], v20, s[40:43], s31 offen
    s_add_u32 s31, s49, 5120
    buffer_load_dwordx4 v[172:175], v20, s[40:43], s31 offen
    s_add_u32 s31, s48, 8192
    buffer_load_dwordx4 v[176:179], v20, s[40:43], s31 offen
    s_add_u32 s31, s49, 8192
    buffer_load_dwordx4 v[180:183], v20, s[40:43], s31 offen
    s_add_u32 s31, s48, 9216
    buffer_load_dwordx4 v[184:187], v20, s[40:43], s31 offen
    s_add_u32 s31, s49, 9216
    buffer_load_dwordx4 v[188:191], v20, s[40:43], s31 offen
    s_add_u32 s31, s48, 12288
    buffer_load_dwordx4 v[192:195], v20, s[40:43], s31 offen
    s_add_u32 s31, s49, 12288
    buffer_load_dwordx4 v[196:199], v20, s[40:43], s31 offen
    s_setprio 0
    s_waitcnt vmcnt(34)
    ds_read_b64_tr_b16 v[128:129], v12 offset:0
    ds_read_b64_tr_b16 v[130:131], v12 offset:1024
    ds_read_b64_tr_b16 v[132:133], v13 offset:0
    ds_read_b64_tr_b16 v[134:135], v13 offset:1024
    s_waitcnt lgkmcnt(0)
    s_waitcnt vmcnt(12)
    v_mfma_f32_32x32x16_bf16 v[64:79], v[128:131], v[144:147], 0
    ds_read_b64_tr_b16 v[136:137], v12 offset:2048
    ds_read_b64_tr_b16 v[138:139], v12 offset:3072
    ds_read_b64_tr_b16 v[140:141], v13 offset:2048
    ds_read_b64_tr_b16 v[142:143], v13 offset:3072
    v_mfma_f32_32x32x16_bf16 v[80:95], v[132:135], v[144:147], 0
    s_add_u32 s31, s29, 180224
    s_add_u32 m0, s79, 14336
    s_nop 0
    buffer_load_dwordx4 v10, s[32:35], s31 offen lds
    s_add_u32 s31, s29, 188416
    s_add_u32 m0, s79, 15360
    s_nop 0
    buffer_load_dwordx4 v10, s[32:35], s31 offen lds
    v_mfma_f32_32x32x16_bf16 v[96:111], v[128:131], v[148:151], 0
    v_mfma_f32_32x32x16_bf16 v[112:127], v[132:135], v[148:151], 0
    s_add_u32 s31, s48, 13312
    buffer_load_dwordx4 v[200:203], v20, s[40:43], s31 offen
    s_add_u32 s31, s49, 13312
    buffer_load_dwordx4 v[204:207], v20, s[40:43], s31 offen
    s_waitcnt lgkmcnt(0)
    s_waitcnt vmcnt(14)
    v_mfma_f32_32x32x16_bf16 v[64:79], v[136:139], v[152:155], v[64:79]
    ds_read_b64_tr_b16 v[128:129], v12 offset:4096
    ds_read_b64_tr_b16 v[130:131], v12 offset:5120
    ds_read_b64_tr_b16 v[132:133], v13 offset:4096
    ds_read_b64_tr_b16 v[134:135], v13 offset:5120
    v_mfma_f32_32x32x16_bf16 v[80:95], v[140:143], v[152:155], v[80:95]
    s_add_u32 s31, s29, 196608
    s_add_u32 m0, s28, 0
    s_nop 0
    buffer_load_dwordx4 v10, s[32:35], s31 offen lds
    s_add_u32 s31, s29, 204800
    s_add_u32 m0, s28, 1024
    s_nop 0
    buffer_load_dwordx4 v10, s[32:35], s31 offen lds
    v_mfma_f32_32x32x16_bf16 v[96:111], v[136:139], v[156:159], v[96:111]
    v_mfma_f32_32x32x16_bf16 v[112:127], v[140:143], v[156:159], v[112:127]
    s_add_u32 s31, s48, 16384
    buffer_load_dwordx4 v[144:147], v20, s[40:43], s31 offen
    s_add_u32 s31, s49, 16384
    buffer_load_dwordx4 v[148:151], v20, s[40:43], s31 offen
    s_waitcnt lgkmcnt(0)
    s_waitcnt vmcnt(16)
    v_mfma_f32_32x32x16_bf16 v[64:79], v[128:131], v[160:163], v[64:79]
    ds_read_b64_tr_b16 v[136:137], v12 offset:6144
    ds_read_b64_tr_b16 v[138:139], v12 offset:7168
    ds_read_b64_tr_b16 v[140:141], v13 offset:6144
    ds_read_b64_tr_b16 v[142:143], v13 offset:7168
    v_mfma_f32_32x32x16_bf16 v[80:95], v[132:135], v[160:163], v[80:95]
    s_add_u32 s31, s29, 212992
    s_add_u32 m0, s28, 2048
    s_nop 0
    buffer_load_dwordx4 v10, s[32:35], s31 offen lds
    s_add_u32 s31, s29, 221184
    s_add_u32 m0, s28, 3072
    s_nop 0
    buffer_load_dwordx4 v10, s[32:35], s31 offen lds
    v_mfma_f32_32x32x16_bf16 v[96:111], v[128:131], v[164:167], v[96:111]
    v_mfma_f32_32x32x16_bf16 v[112:127], v[132:135], v[164:167], v[112:127]
    s_add_u32 s31, s48, 17408
    buffer_load_dwordx4 v[152:155], v20, s[40:43], s31 offen
    s_add_u32 s31, s49, 17408
    buffer_load_dwordx4 v[156:159], v20, s[40:43], s31 offen
    s_waitcnt lgkmcnt(0)
    s_waitcnt vmcnt(18)
    v_mfma_f32_32x32x16_bf16 v[64:79], v[136:139], v[168:171], v[64:79]
    ds_read_b64_tr_b16 v[128:129], v22 offset:0
    ds_read_b64_tr_b16 v[130:131], v22 offset:1024
    ds_read_b64_tr_b16 v[132:133], v23 offset:0
    ds_read_b64_tr_b16 v[134:135], v23 offset:1024
    v_mfma_f32_32x32x16_bf16 v[80:95], v[140:143], v[168:171], v[80:95]
    s_add_u32 s31, s29, 229376
    s_add_u32 m0, s28, 4096
    s_nop 0
    buffer_load_dwordx4 v10, s[32:35], s31 offen lds
    s_add_u32 s31, s29, 237568
    s_add_u32 m0, s28, 5120
    s_nop 0
    buffer_load_dwordx4 v10, s[32:35], s31 offen lds
    v_mfma_f32_32x32x16_bf16 v[96:111], v[136:139], v[172:175], v[96:111]
    v_mfma_f32_32x32x16_bf16 v[112:127], v[140:143], v[172:175], v[112:127]
    s_add_u32 s31, s48, 20480
    buffer_load_dwordx4 v[160:163], v20, s[40:43], s31 offen
    s_add_u32 s31, s49, 20480
    buffer_load_dwordx4 v[164:167], v20, s[40:43], s31 offen
    s_waitcnt lgkmcnt(0)
    s_waitcnt vmcnt(20)
    v_mfma_f32_32x32x16_bf16 v[64:79], v[128:131], v[176:179], v[64:79]
    ds_read_b64_tr_b16 v[136:137], v22 offset:2048
    ds_read_b64_tr_b16 v[138:139], v22 offset:3072
    ds_read_b64_tr_b16 v[140:141], v23 offset:2048
    ds_read_b64_tr_b16 v[142:143], v23 offset:3072
    v_mfma_f32_32x32x16_bf16 v[80:95], v[132:135], v[176:179], v[80:95]
    s_add_u32 s31, s29, 245760
    s_add_u32 m0, s28, 6144
    s_nop 0
    buffer_load_dwordx4 v10, s[32:35], s31 offen lds
    s_add_u32 s31, s29, 253952
    s_add_u32 m0, s28, 7168
    s_nop 0
    buffer_load_dwordx4 v10, s[32:35], s31 offen lds
    v_mfma_f32_32x32x16_bf16 v[96:111], v[128:131], v[180:183], v[96:111]
    v_mfma_f32_32x32x16_bf16 v[112:127], v[132:135], v[180:183], v[112:127]
    s_add_u32 s31, s48, 21504
    buffer_load_dwordx4 v[168:171], v20, s[40:43], s31 offen
    s_add_u32 s31, s49, 21504
    buffer_load_dwordx4 v[172:175], v20, s[40:43], s31 offen
    s_waitcnt lgkmcnt(0)
    s_waitcnt vmcnt(22)
    v_mfma_f32_32x32x16_bf16 v[64:79], v[136:139], v[184:187], v[64:79]
    ds_read_b64_tr_b16 v[128:129], v22 offset:4096
    ds_read_b64_tr_b16 v[130:131], v22 offset:5120
    ds_read_b64_tr_b16 v[132:133], v23 offset:4096
    ds_read_b64_tr_b16 v[134:135], v23 offset:5120
    v_mfma_f32_32x32x16_bf16 v[80:95], v[140:143], v[184:187], v[80:95]
    s_add_u32 s31, s29, 262144
    s_add_u32 m0, s79, 0
    s_nop 0
    buffer_load_dwordx4 v10, s[32:35], s31 offen lds
    s_add_u32 s31, s29, 270336
    s_add_u32 m0, s79, 1024
    s_nop 0
    buffer_load_dwordx4 v10, s[32:35], s31 offen lds
    v_mfma_f32_32x32x16_bf16 v[96:111], v[136:139], v[188:191], v[96:111]
    v_mfma_f32_32x32x16_bf16 v[112:127], v[140:143], v[188:191], v[112:127]
    s_add_u32 s31, s48, 24576
    buffer_load_dwordx4 v[176:179], v20, s[40:43], s31 offen
    s_add_u32 s31, s49, 24576
    buffer_load_dwordx4 v[180:183], v20, s[40:43], s31 offen
    s_waitcnt lgkmcnt(0)
    s_waitcnt vmcnt(24)
    v_mfma_f32_32x32x16_bf16 v[64:79], v[128:131], v[192:195], v[64:79]
    ds_read_b64_tr_b16 v[136:137], v22 offset:6144
    ds_read_b64_tr_b16 v[138:139], v22 offset:7168
    ds_read_b64_tr_b16 v[140:141], v23 offset:6144
    ds_read_b64_tr_b16 v[142:143], v23 offset:7168
    v_mfma_f32_32x32x16_bf16 v[80:95], v[132:135], v[192:195], v[80:95]
    s_add_u32 s31, s29, 278528
    s_add_u32 m0, s79, 2048
    s_nop 0
    buffer_load_dwordx4 v10, s[32:35], s31 offen lds
    s_add_u32 s31, s29, 286720
    s_add_u32 m0, s79, 3072
    s_nop 0
    buffer_load_dwordx4 v10, s[32:35], s31 offen lds
    v_mfma_f32_32x32x16_bf16 v[96:111], v[128:131], v[196:199], v[96:111]
    v_mfma_f32_32x32x16_bf16 v[112:127], v[132:135], v[196:199], v[112:127]
    s_add_u32 s31, s48, 25600
    buffer_load_dwordx4 v[184:187], v20, s[40:43], s31 offen
    s_add_u32 s31, s49, 25600
    buffer_load_dwordx4 v[188:191], v20, s[40:43], s31 offen
    s_waitcnt lgkmcnt(0)
    s_waitcnt vmcnt(24)
    v_mfma_f32_32x32x16_bf16 v[64:79], v[136:139], v[200:203], v[64:79]
    ds_read_b64_tr_b16 v[128:129], v22 offset:8192
    ds_read_b64_tr_b16 v[130:131], v22 offset:9216
    ds_read_b64_tr_b16 v[132:133], v23 offset:8192
    ds_read_b64_tr_b16 v[134:135], v23 offset:9216
    v_mfma_f32_32x32x16_bf16 v[80:95], v[140:143], v[200:203], v[80:95]
    s_add_u32 s31, s29, 294912
    s_add_u32 m0, s79, 4096
    s_nop 0
    buffer_load_dwordx4 v10, s[32:35], s31 offen lds
    s_add_u32 s31, s29, 303104
    s_add_u32 m0, s79, 5120
    s_nop 0
    buffer_load_dwordx4 v10, s[32:35], s31 offen lds
    v_mfma_f32_32x32x16_bf16 v[96:111], v[136:139], v[204:207], v[96:111]
    v_mfma_f32_32x32x16_bf16 v[112:127], v[140:143], v[204:207], v[112:127]
    s_add_u32 s31, s48, 28672
    buffer_load_dwordx4 v[192:195], v20, s[40:43], s31 offen
    s_add_u32 s31, s49, 28672
    buffer_load_dwordx4 v[196:199], v20, s[40:43], s31 offen
    s_waitcnt lgkmcnt(0)
    s_waitcnt vmcnt(24)
    v_mfma_f32_32x32x16_bf16 v[64:79], v[128:131], v[144:147], v[64:79]
    ds_read_b64_tr_b16 v[136:137], v22 offset:10240
    ds_read_b64_tr_b16 v[138:139], v22 offset:11264
    ds_read_b64_tr_b16 v[140:141], v23 offset:10240
    ds_read_b64_tr_b16 v[142:143], v23 offset:11264
    v_mfma_f32_32x32x16_bf16 v[80:95], v[132:135], v[144:147], v[80:95]
    s_add_u32 s31, s29, 311296
    s_add_u32 m0, s79, 6144
    s_nop 0
    buffer_load_dwordx4 v10, s[32:35], s31 offen lds
    s_add_u32 s31, s29, 319488
    s_add_u32 m0, s79, 7168
    s_nop 0
    buffer_load_dwordx4 v10, s[32:35], s31 offen lds
    v_mfma_f32_32x32x16_bf16 v[96:111], v[128:131], v[148:151], v[96:111]
    v_mfma_f32_32x32x16_bf16 v[112:127], v[132:135], v[148:151], v[112:127]
    s_add_u32 s31, s48, 29696
    buffer_load_dwordx4 v[200:203], v20, s[40:43], s31 offen
    s_add_u32 s31, s49, 29696
    buffer_load_dwordx4 v[204:207], v20, s[40:43], s31 offen
    s_waitcnt lgkmcnt(0)
    s_waitcnt vmcnt(24)
    v_mfma_f32_32x32x16_bf16 v[64:79], v[136:139], v[152:155], v[64:79]
    ds_read_b64_tr_b16 v[128:129], v22 offset:12288
    ds_read_b64_tr_b16 v[130:131], v22 offset:13312
    ds_read_b64_tr_b16 v[132:133], v23 offset:12288
    ds_read_b64_tr_b16 v[134:135], v23 offset:13312
    v_mfma_f32_32x32x16_bf16 v[80:95], v[140:143], v[152:155], v[80:95]
    s_add_u32 s31, s29, 327680
    s_add_u32 m0, s79, 8192
    s_nop 0
    buffer_load_dwordx4 v10, s[32:35], s31 offen lds
    s_add_u32 s31, s29, 335872
    s_add_u32 m0, s79, 9216
    s_nop 0
    buffer_load_dwordx4 v10, s[32:35], s31 offen lds
    v_mfma_f32_32x32x16_bf16 v[96:111], v[136:139], v[156:159], v[96:111]
    v_mfma_f32_32x32x16_bf16 v[112:127], v[140:143], v[156:159], v[112:127]
    s_add_u32 s31, s48, 32768
    buffer_load_dwordx4 v[144:147], v20, s[40:43], s31 offen
    s_add_u32 s31, s49, 32768
    buffer_load_dwordx4 v[148:151], v20, s[40:43], s31 offen
    s_waitcnt lgkmcnt(0)
    s_waitcnt vmcnt(24)
    v_mfma_f32_32x32x16_bf16 v[64:79], v[128:131], v[160:163], v[64:79]
    ds_read_b64_tr_b16 v[136:137], v22 offset:14336
    ds_read_b64_tr_b16 v[138:139], v22 offset:15360
    ds_read_b64_tr_b16 v[140:141], v23 offset:14336
    ds_read_b64_tr_b16 v[142:143], v23 offset:15360
    v_mfma_f32_32x32x16_bf16 v[80:95], v[132:135], v[160:163], v[80:95]
    s_add_u32 s31, s29, 344064
    s_add_u32 m0, s79, 10240
    s_nop 0
    buffer_load_dwordx4 v10, s[32:35], s31 offen lds
    s_add_u32 s31, s29, 352256
    s_add_u32 m0, s79, 11264
    s_nop 0
    buffer_load_dwordx4 v10, s[32:35], s31 offen lds
    v_mfma_f32_32x32x16_bf16 v[96:111], v[128:131], v[164:167], v[96:111]
    v_mfma_f32_32x32x16_bf16 v[112:127], v[132:135], v[164:167], v[112:127]
    s_add_u32 s31, s48, 33792
    buffer_load_dwordx4 v[152:155], v20, s[40:43], s31 offen
    s_add_u32 s31, s49, 33792
    buffer_load_dwordx4 v[156:159], v20, s[40:43], s31 offen
    s_waitcnt lgkmcnt(0)
    s_waitcnt vmcnt(24)
    v_mfma_f32_32x32x16_bf16 v[64:79], v[136:139], v[168:171], v[64:79]
    ds_read_b64_tr_b16 v[128:129], v12 offset:0
    ds_read_b64_tr_b16 v[130:131], v12 offset:1024
    ds_read_b64_tr_b16 v[132:133], v13 offset:0
    ds_read_b64_tr_b16 v[134:135], v13 offset:1024
    v_mfma_f32_32x32x16_bf16 v[80:95], v[140:143], v[168:171], v[80:95]
    s_add_u32 s31, s29, 360448
    s_add_u32 m0, s79, 12288
    s_nop 0
    buffer_load_dwordx4 v10, s[32:35], s31 offen lds
    s_add_u32 s31, s29, 368640
    s_add_u32 m0, s79, 13312
    s_nop 0
    buffer_load_dwordx4 v10, s[32:35], s31 offen lds
    v_mfma_f32_32x32x16_bf16 v[96:111], v[136:139], v[172:175], v[96:111]
    v_mfma_f32_32x32x16_bf16 v[112:127], v[140:143], v[172:175], v[112:127]
    s_add_u32 s31, s48, 36864
    buffer_load_dwordx4 v[160:163], v20, s[40:43], s31 offen
    s_add_u32 s31, s49, 36864
    buffer_load_dwordx4 v[164:167], v20, s[40:43], s31 offen
    s_waitcnt lgkmcnt(0)
    s_waitcnt vmcnt(24)
    v_mfma_f32_32x32x16_bf16 v[64:79], v[128:131], v[176:179], v[64:79]
    ds_read_b64_tr_b16 v[136:137], v12 offset:2048
    ds_read_b64_tr_b16 v[138:139], v12 offset:3072
    ds_read_b64_tr_b16 v[140:141], v13 offset:2048
    ds_read_b64_tr_b16 v[142:143], v13 offset:3072
    v_mfma_f32_32x32x16_bf16 v[80:95], v[132:135], v[176:179], v[80:95]
    s_add_u32 s31, s29, 376832
    s_add_u32 m0, s79, 14336
    s_nop 0
    buffer_load_dwordx4 v10, s[32:35], s31 offen lds
    s_add_u32 s31, s29, 385024
    s_add_u32 m0, s79, 15360
    s_nop 0
    buffer_load_dwordx4 v10, s[32:35], s31 offen lds
    v_mfma_f32_32x32x16_bf16 v[96:111], v[128:131], v[180:183], v[96:111]
    v_mfma_f32_32x32x16_bf16 v[112:127], v[132:135], v[180:183], v[112:127]
    s_add_u32 s31, s48, 37888
    buffer_load_dwordx4 v[168:171], v20, s[40:43], s31 offen
    s_add_u32 s31, s49, 37888
    buffer_load_dwordx4 v[172:175], v20, s[40:43], s31 offen
    s_waitcnt lgkmcnt(0)
    s_waitcnt vmcnt(24)
    v_mfma_f32_32x32x16_bf16 v[64:79], v[136:139], v[184:187], v[64:79]
    ds_read_b64_tr_b16 v[128:129], v12 offset:4096
    ds_read_b64_tr_b16 v[130:131], v12 offset:5120
    ds_read_b64_tr_b16 v[132:133], v13 offset:4096
    ds_read_b64_tr_b16 v[134:135], v13 offset:5120
    v_mfma_f32_32x32x16_bf16 v[80:95], v[140:143], v[184:187], v[80:95]
    s_add_u32 s31, s29, 393216
    s_add_u32 m0, s28, 0
    s_nop 0
    buffer_load_dwordx4 v10, s[32:35], s31 offen lds
    s_add_u32 s31, s29, 401408
    s_add_u32 m0, s28, 1024
    s_nop 0
    buffer_load_dwordx4 v10, s[32:35], s31 offen lds
    v_mfma_f32_32x32x16_bf16 v[96:111], v[136:139], v[188:191], v[96:111]
    v_mfma_f32_32x32x16_bf16 v[112:127], v[140:143], v[188:191], v[112:127]
    s_add_u32 s31, s48, 40960
    buffer_load_dwordx4 v[176:179], v20, s[40:43], s31 offen
    s_add_u32 s31, s49, 40960
    buffer_load_dwordx4 v[180:183], v20, s[40:43], s31 offen
    s_waitcnt lgkmcnt(0)
    s_waitcnt vmcnt(24)
    v_mfma_f32_32x32x16_bf16 v[64:79], v[128:131], v[192:195], v[64:79]
    ds_read_b64_tr_b16 v[136:137], v12 offset:6144
    ds_read_b64_tr_b16 v[138:139], v12 offset:7168
    ds_read_b64_tr_b16 v[140:141], v13 offset:6144
    ds_read_b64_tr_b16 v[142:143], v13 offset:7168
    v_mfma_f32_32x32x16_bf16 v[80:95], v[132:135], v[192:195], v[80:95]
    s_add_u32 s31, s29, 409600
    s_add_u32 m0, s28, 2048
    s_nop 0
    buffer_load_dwordx4 v10, s[32:35], s31 offen lds
    s_add_u32 s31, s29, 417792
    s_add_u32 m0, s28, 3072
    s_nop 0
    buffer_load_dwordx4 v10, s[32:35], s31 offen lds
    v_mfma_f32_32x32x16_bf16 v[96:111], v[128:131], v[196:199], v[96:111]
    v_mfma_f32_32x32x16_bf16 v[112:127], v[132:135], v[196:199], v[112:127]
    s_add_u32 s31, s48, 41984
    buffer_load_dwordx4 v[184:187], v20, s[40:43], s31 offen
    s_add_u32 s31, s49, 41984
    buffer_load_dwordx4 v[188:191], v20, s[40:43], s31 offen
    s_waitcnt lgkmcnt(0)
    s_waitcnt vmcnt(24)
    v_mfma_f32_32x32x16_bf16 v[64:79], v[136:139], v[200:203], v[64:79]
    ds_read_b64_tr_b16 v[128:129], v22 offset:0
    ds_read_b64_tr_b16 v[130:131], v22 offset:1024
    ds_read_b64_tr_b16 v[132:133], v23 offset:0
    ds_read_b64_tr_b16 v[134:135], v23 offset:1024
    v_mfma_f32_32x32x16_bf16 v[80:95], v[140:143], v[200:203], v[80:95]
    s_add_u32 s31, s29, 425984
    s_add_u32 m0, s28, 4096
    s_nop 0
    buffer_load_dwordx4 v10, s[32:35], s31 offen lds
    s_add_u32 s31, s29, 434176
    s_add_u32 m0, s28, 5120
    s_nop 0
    buffer_load_dwordx4 v10, s[32:35], s31 offen lds
    v_mfma_f32_32x32x16_bf16 v[96:111], v[136:139], v[204:207], v[96:111]
    v_mfma_f32_32x32x16_bf16 v[112:127], v[140:143], v[204:207], v[112:127]
    s_add_u32 s31, s48, 45056
    buffer_load_dwordx4 v[192:195], v20, s[40:43], s31 offen
    s_add_u32 s31, s49, 45056
    buffer_load_dwordx4 v[196:199], v20, s[40:43], s31 offen
    s_waitcnt lgkmcnt(0)
    s_waitcnt vmcnt(24)
    v_mfma_f32_32x32x16_bf16 v[64:79], v[128:131], v[144:147], v[64:79]
    ds_read_b64_tr_b16 v[136:137], v22 offset:2048
    ds_read_b64_tr_b16 v[138:139], v22 offset:3072
    ds_read_b64_tr_b16 v[140:141], v23 offset:2048
    ds_read_b64_tr_b16 v[142:143], v23 offset:3072
    v_mfma_f32_32x32x16_bf16 v[80:95], v[132:135], v[144:147], v[80:95]
    s_add_u32 s31, s29, 442368
    s_add_u32 m0, s28, 6144
    s_nop 0
    buffer_load_dwordx4 v10, s[32:35], s31 offen lds
    s_add_u32 s31, s29, 450560
    s_add_u32 m0, s28, 7168
    s_nop 0
    buffer_load_dwordx4 v10, s[32:35], s31 offen lds
    v_mfma_f32_32x32x16_bf16 v[96:111], v[128:131], v[148:151], v[96:111]
    v_mfma_f32_32x32x16_bf16 v[112:127], v[132:135], v[148:151], v[112:127]
    s_add_u32 s31, s48, 46080
    buffer_load_dwordx4 v[200:203], v20, s[40:43], s31 offen
    s_add_u32 s31, s49, 46080
    buffer_load_dwordx4 v[204:207], v20, s[40:43], s31 offen
    s_waitcnt lgkmcnt(0)
    s_waitcnt vmcnt(24)
    v_mfma_f32_32x32x16_bf16 v[64:79], v[136:139], v[152:155], v[64:79]
    ds_read_b64_tr_b16 v[128:129], v22 offset:4096
    ds_read_b64_tr_b16 v[130:131], v22 offset:5120
    ds_read_b64_tr_b16 v[132:133], v23 offset:4096
    ds_read_b64_tr_b16 v[134:135], v23 offset:5120
    v_mfma_f32_32x32x16_bf16 v[80:95], v[140:143], v[152:155], v[80:95]
    v_mfma_f32_32x32x16_bf16 v[96:111], v[136:139], v[156:159], v[96:111]
    v_mfma_f32_32x32x16_bf16 v[112:127], v[140:143], v[156:159], v[112:127]
    s_add_u32 s31, s48, 49152
    buffer_load_dwordx4 v[144:147], v20, s[40:43], s31 offen
    s_add_u32 s31, s49, 49152
    buffer_load_dwordx4 v[148:151], v20, s[40:43], s31 offen
    s_waitcnt lgkmcnt(0)
    s_waitcnt vmcnt(22)
    v_mfma_f32_32x32x16_bf16 v[64:79], v[128:131], v[160:163], v[64:79]
    ds_read_b64_tr_b16 v[136:137], v22 offset:6144
    ds_read_b64_tr_b16 v[138:139], v22 offset:7168
    ds_read_b64_tr_b16 v[140:141], v23 offset:6144
    ds_read_b64_tr_b16 v[142:143], v23 offset:7168
    v_mfma_f32_32x32x16_bf16 v[80:95], v[132:135], v[160:163], v[80:95]
    v_mfma_f32_32x32x16_bf16 v[96:111], v[128:131], v[164:167], v[96:111]
    v_mfma_f32_32x32x16_bf16 v[112:127], v[132:135], v[164:167], v[112:127]
    s_add_u32 s31, s48, 50176
    buffer_load_dwordx4 v[152:155], v20, s[40:43], s31 offen
    s_add_u32 s31, s49, 50176
    buffer_load_dwordx4 v[156:159], v20, s[40:43], s31 offen
    s_waitcnt lgkmcnt(0)
    s_waitcnt vmcnt(20)
    v_mfma_f32_32x32x16_bf16 v[64:79], v[136:139], v[168:171], v[64:79]
    ds_read_b64_tr_b16 v[128:129], v22 offset:8192
    ds_read_b64_tr_b16 v[130:131], v22 offset:9216
    ds_read_b64_tr_b16 v[132:133], v23 offset:8192
    ds_read_b64_tr_b16 v[134:135], v23 offset:9216
    v_mfma_f32_32x32x16_bf16 v[80:95], v[140:143], v[168:171], v[80:95]
    v_mfma_f32_32x32x16_bf16 v[96:111], v[136:139], v[172:175], v[96:111]
    v_mfma_f32_32x32x16_bf16 v[112:127], v[140:143], v[172:175], v[112:127]
    s_add_u32 s31, s48, 53248
    buffer_load_dwordx4 v[160:163], v20, s[40:43], s31 offen
    s_add_u32 s31, s49, 53248
    buffer_load_dwordx4 v[164:167], v20, s[40:43], s31 offen
    s_waitcnt lgkmcnt(0)
    s_waitcnt vmcnt(18)
    v_mfma_f32_32x32x16_bf16 v[64:79], v[128:131], v[176:179], v[64:79]
    ds_read_b64_tr_b16 v[136:137], v22 offset:10240
    ds_read_b64_tr_b16 v[138:139], v22 offset:11264
    ds_read_b64_tr_b16 v[140:141], v23 offset:10240
    ds_read_b64_tr_b16 v[142:143], v23 offset:11264
    v_mfma_f32_32x32x16_bf16 v[80:95], v[132:135], v[176:179], v[80:95]
    v_mfma_f32_32x32x16_bf16 v[96:111], v[128:131], v[180:183], v[96:111]
    v_mfma_f32_32x32x16_bf16 v[112:127], v[132:135], v[180:183], v[112:127]
    s_add_u32 s31, s48, 54272
    buffer_load_dwordx4 v[168:171], v20, s[40:43], s31 offen
    s_add_u32 s31, s49, 54272
    buffer_load_dwordx4 v[172:175], v20, s[40:43], s31 offen
    s_waitcnt lgkmcnt(0)
    s_waitcnt vmcnt(16)
    v_mfma_f32_32x32x16_bf16 v[64:79], v[136:139], v[184:187], v[64:79]
    ds_read_b64_tr_b16 v[128:129], v22 offset:12288
    ds_read_b64_tr_b16 v[130:131], v22 offset:13312
    ds_read_b64_tr_b16 v[132:133], v23 offset:12288
    ds_read_b64_tr_b16 v[134:135], v23 offset:13312
    v_mfma_f32_32x32x16_bf16 v[80:95], v[140:143], v[184:187], v[80:95]
    v_mfma_f32_32x32x16_bf16 v[96:111], v[136:139], v[188:191], v[96:111]
    v_mfma_f32_32x32x16_bf16 v[112:127], v[140:143], v[188:191], v[112:127]
    s_waitcnt lgkmcnt(0)
    s_waitcnt vmcnt(12)
    v_mfma_f32_32x32x16_bf16 v[64:79], v[128:131], v[192:195], v[64:79]
    ds_read_b64_tr_b16 v[136:137], v22 offset:14336
    ds_read_b64_tr_b16 v[138:139], v22 offset:15360
    ds_read_b64_tr_b16 v[140:141], v23 offset:14336
    ds_read_b64_tr_b16 v[142:143], v23 offset:15360
    v_mfma_f32_32x32x16_bf16 v[80:95], v[132:135], v[192:195], v[80:95]
    v_mfma_f32_32x32x16_bf16 v[96:111], v[128:131], v[196:199], v[96:111]
    v_mfma_f32_32x32x16_bf16 v[112:127], v[132:135], v[196:199], v[112:127]
    s_waitcnt lgkmcnt(0)
    s_waitcnt vmcnt(8)
    v_mfma_f32_32x32x16_bf16 v[64:79], v[136:139], v[200:203], v[64:79]
    ds_read_b64_tr_b16 v[128:129], v12 offset:0
    ds_read_b64_tr_b16 v[130:131], v12 offset:1024
    ds_read_b64_tr_b16 v[132:133], v13 offset:0
    ds_read_b64_tr_b16 v[134:135], v13 offset:1024
    v_mfma_f32_32x32x16_bf16 v[80:95], v[140:143], v[200:203], v[80:95]
    v_mfma_f32_32x32x16_bf16 v[96:111], v[136:139], v[204:207], v[96:111]
    v_mfma_f32_32x32x16_bf16 v[112:127], v[140:143], v[204:207], v[112:127]
    s_waitcnt lgkmcnt(0)
    s_waitcnt vmcnt(6)
    v_mfma_f32_32x32x16_bf16 v[64:79], v[128:131], v[144:147], v[64:79]
    ds_read_b64_tr_b16 v[136:137], v12 offset:2048
    ds_read_b64_tr_b16 v[138:139], v12 offset:3072
    ds_read_b64_tr_b16 v[140:141], v13 offset:2048
    ds_read_b64_tr_b16 v[142:143], v13 offset:3072
    v_mfma_f32_32x32x16_bf16 v[80:95], v[132:135], v[144:147], v[80:95]
    v_mfma_f32_32x32x16_bf16 v[96:111], v[128:131], v[148:151], v[96:111]
    v_mfma_f32_32x32x16_bf16 v[112:127], v[132:135], v[148:151], v[112:127]
    s_waitcnt lgkmcnt(0)
    s_waitcnt vmcnt(4)
    v_mfma_f32_32x32x16_bf16 v[64:79], v[136:139], v[152:155], v[64:79]
    ds_read_b64_tr_b16 v[128:129], v12 offset:4096
    ds_read_b64_tr_b16 v[130:131], v12 offset:5120
    ds_read_b64_tr_b16 v[132:133], v13 offset:4096
    ds_read_b64_tr_b16 v[134:135], v13 offset:5120
    v_mfma_f32_32x32x16_bf16 v[80:95], v[140:143], v[152:155], v[80:95]
    v_mfma_f32_32x32x16_bf16 v[96:111], v[136:139], v[156:159], v[96:111]
    v_mfma_f32_32x32x16_bf16 v[112:127], v[140:143], v[156:159], v[112:127]
    s_waitcnt lgkmcnt(0)
    s_waitcnt vmcnt(2)
    v_mfma_f32_32x32x16_bf16 v[64:79], v[128:131], v[160:163], v[64:79]
    ds_read_b64_tr_b16 v[136:137], v12 offset:6144
    ds_read_b64_tr_b16 v[138:139], v12 offset:7168
    ds_read_b64_tr_b16 v[140:141], v13 offset:6144
    ds_read_b64_tr_b16 v[142:143], v13 offset:7168
    v_mfma_f32_32x32x16_bf16 v[80:95], v[132:135], v[160:163], v[80:95]
    v_mfma_f32_32x32x16_bf16 v[96:111], v[128:131], v[164:167], v[96:111]
    v_mfma_f32_32x32x16_bf16 v[112:127], v[132:135], v[164:167], v[112:127]
    s_waitcnt lgkmcnt(0)
    s_waitcnt vmcnt(0)
    v_mfma_f32_32x32x16_bf16 v[64:79], v[136:139], v[168:171], v[64:79]
    v_mfma_f32_32x32x16_bf16 v[80:95], v[140:143], v[168:171], v[80:95]
    v_mfma_f32_32x32x16_bf16 v[96:111], v[136:139], v[172:175], v[96:111]
    v_mfma_f32_32x32x16_bf16 v[112:127], v[140:143], v[172:175], v[112:127]
    s_lshl_b32 s30, s77, 1
    s_add_u32 s30, s30, s76
    s_lshl_b32 s30, s30, 17
    s_lshl_b32 s31, s18, 7
    s_add_u32 s30, s30, s31
    s_add_u32 m0, s79, 0
    s_nop 0
    buffer_load_dwordx4 v10, s[36:39], s30 offen lds
    s_add_u32 s30, s30, 8192
    s_add_u32 m0, s79, 1024
    s_nop 0
    buffer_load_dwordx4 v10, s[36:39], s30 offen lds
    s_add_u32 s30, s30, 8192
    s_add_u32 m0, s79, 2048
    s_nop 0
    buffer_load_dwordx4 v10, s[36:39], s30 offen lds
    s_add_u32 s30, s30, 8192
    s_add_u32 m0, s79, 3072
    s_nop 0
    buffer_load_dwordx4 v10, s[36:39], s30 offen lds
    s_add_u32 s30, s30, 8192
    s_add_u32 m0, s79, 4096
    s_nop 0
    buffer_load_dwordx4 v10, s[36:39], s30 offen lds
    s_add_u32 s30, s30, 8192
    s_add_u32 m0, s79, 5120
    s_nop 0
    buffer_load_dwordx4 v10, s[36:39], s30 offen lds
    s_add_u32 s30, s30, 8192
    s_add_u32 m0, s79, 6144
    s_nop 0
    buffer_load_dwordx4 v10, s[36:39], s30 offen lds
    s_add_u32 s30, s30, 8192
    s_add_u32 m0, s79, 7168
    s_nop 0
    buffer_load_dwordx4 v10, s[36:39], s30 offen lds
    s_add_u32 s30, s30, 8192
    s_add_u32 m0, s79, 8192
    s_nop 0
    buffer_load_dwordx4 v10, s[36:39], s30 offen lds
    s_add_u32 s30, s30, 8192
    s_add_u32 m0, s79, 9216
    s_nop 0
    buffer_load_dwordx4 v10, s[36:39], s30 offen lds
    s_add_u32 s30, s30, 8192
    s_add_u32 m0, s79, 10240
    s_nop 0
    buffer_load_dwordx4 v10, s[36:39], s30 offen lds
    s_add_u32 s30, s30, 8192
    s_add_u32 m0, s79, 11264
    s_nop 0
    buffer_load_dwordx4 v10, s[36:39], s30 offen lds
    s_add_u32 s30, s30, 8192
    s_add_u32 m0, s79, 12288
    s_nop 0
    buffer_load_dwordx4 v10, s[36:39], s30 offen lds
    s_add_u32 s30, s30, 8192
    s_add_u32 m0, s79, 13312
    s_nop 0
    buffer_load_dwordx4 v10, s[36:39], s30 offen lds
    s_add_u32 s30, s30, 8192
    s_add_u32 m0, s79, 14336
    s_nop 0
    buffer_load_dwordx4 v10, s[36:39], s30 offen lds
    s_add_u32 s30, s30, 8192
    s_add_u32 m0, s79, 15360
    s_nop 0
    buffer_load_dwordx4 v10, s[36:39], s30 offen lds
    s_add_u32 s30, s30, 8192
    v_and_b32 v3, 31, v1
    v_lshlrev_b32 v3, 10, v3
    v_lshrrev_b32 v4, 5, v1
    v_lshl_add_u32 v3, v4, 4, v3
    s_lshl_b32 s78, s17, 16
    s_lshl_b32 s47, s76, 15
    s_add_u32 s78, s78, s47
    s_lshl_b32 s47, s18, 7
    s_add_u32 s78, s78, s47
    s_lshl_b32 s47, s77, 6
    s_add_u32 s78, s78, s47
    v_mov_b32 v22, v3
    buffer_load_dwordx4 v[24:27], v22, s[24:27], s78 offen offset:0
    buffer_load_dwordx4 v[28:31], v22, s[24:27], s78 offen offset:32
    s_xor_b32 s46, s21, 1
    s_mul_i32 s46, s46, 16384
    s_add_u32 s46, s46, 98304
    v_add_u32 v2, s46, v20
    ds_write_b128 v2, v[80:83] offset:0
    ds_write_b128 v2, v[84:87] offset:1024
    ds_write_b128 v2, v[88:91] offset:2048
    ds_write_b128 v2, v[92:95] offset:3072
    s_xor_b32 s46, s21, 2
    s_mul_i32 s46, s46, 16384
    s_add_u32 s46, s46, 102400
    v_add_u32 v2, s46, v20
    ds_write_b128 v2, v[96:99] offset:0
    ds_write_b128 v2, v[100:103] offset:1024
    ds_write_b128 v2, v[104:107] offset:2048
    ds_write_b128 v2, v[108:111] offset:3072
    s_xor_b32 s46, s21, 3
    s_lshl_b32 s46, s46, 12
    s_add_u32 s46, s46, 65536
    v_add_u32 v2, s46, v20
    ds_write_b128 v2, v[112:115] offset:0
    ds_write_b128 v2, v[116:119] offset:1024
    ds_write_b128 v2, v[120:123] offset:2048
    ds_write_b128 v2, v[124:127] offset:3072
    s_waitcnt vmcnt(0) lgkmcnt(0)
    s_mov_b64 exec, 1
    v_mov_b32 v2, 159768
    v_mov_b32 v3, 1
    ds_add_u32 v2, v3
    s_mov_b64 exec, -1
    v_mov_b32 v2, 159768
Y_GPP:
    ds_read_b32 v3, v2
    s_waitcnt lgkmcnt(0)
    v_readfirstlane_b32 s46, v3
    s_nop 0
    s_cmp_ge_u32 s46, 4
    s_cbranch_scc1 Y_GPP_OK
    s_sleep 1
    s_branch Y_GPP
Y_GPP_OK:
    s_mul_i32 s46, s21, 16384
    s_add_u32 s46, s46, 98304
    v_add_u32 v2, s46, v20
    s_lshl_b32 s46, s21, 12
    s_add_u32 s46, s46, 65536
    v_add_u32 v3, s46, v20
    ds_read_b128 v[80:83], v2 offset:0
    ds_read_b128 v[84:87], v2 offset:1024
    ds_read_b128 v[88:91], v2 offset:2048
    ds_read_b128 v[92:95], v2 offset:3072
    ds_read_b128 v[96:99], v2 offset:4096
    ds_read_b128 v[100:103], v2 offset:5120
    ds_read_b128 v[104:107], v2 offset:6144
    ds_read_b128 v[108:111], v2 offset:7168
    ds_read_b128 v[112:115], v3 offset:0
    ds_read_b128 v[116:119], v3 offset:1024
    ds_read_b128 v[120:123], v3 offset:2048
    ds_read_b128 v[124:127], v3 offset:3072
    s_waitcnt lgkmcnt(0)
    v_add_f32 v32, v64, v80
    v_add_f32 v96, v96, v112
    v_add_f32 v33, v65, v81
    v_add_f32 v97, v97, v113
    v_add_f32 v34, v66, v82
    v_add_f32 v98, v98, v114
    v_add_f32 v35, v67, v83
    v_add_f32 v99, v99, v115
    v_add_f32 v36, v68, v84
    v_add_f32 v100, v100, v116
    v_add_f32 v37, v69, v85
    v_add_f32 v101, v101, v117
    v_add_f32 v38, v70, v86
    v_add_f32 v102, v102, v118
    v_add_f32 v39, v71, v87
    v_add_f32 v103, v103, v119
    v_add_f32 v40, v72, v88
    v_add_f32 v104, v104, v120
    v_add_f32 v41, v73, v89
    v_add_f32 v105, v105, v121
    v_add_f32 v42, v74, v90
    v_add_f32 v106, v106, v122
    v_add_f32 v43, v75, v91
    v_add_f32 v107, v107, v123
    v_add_f32 v44, v76, v92
    v_add_f32 v108, v108, v124
    v_add_f32 v45, v77, v93
    v_add_f32 v109, v109, v125
    v_add_f32 v46, v78, v94
    v_add_f32 v110, v110, v126
    v_add_f32 v47, v79, v95
    v_add_f32 v111, v111, v127
    v_add_f32 v32, v32, v96
    v_mov_b32 v48, 0
    v_add_f32 v33, v33, v97
    v_mov_b32 v49, 0
    v_add_f32 v34, v34, v98
    v_mov_b32 v50, 0
    v_add_f32 v35, v35, v99
    v_mov_b32 v51, 0
    v_add_f32 v36, v36, v100
    v_mov_b32 v52, 0
    v_add_f32 v37, v37, v101
    v_mov_b32 v53, 0
    v_add_f32 v38, v38, v102
    v_mov_b32 v54, 0
    v_add_f32 v39, v39, v103
    v_mov_b32 v55, 0
    v_add_f32 v40, v40, v104
    v_mov_b32 v56, 0
    v_add_f32 v41, v41, v105
    v_mov_b32 v57, 0
    v_add_f32 v42, v42, v106
    v_mov_b32 v58, 0
    v_add_f32 v43, v43, v107
    v_mov_b32 v59, 0
    v_add_f32 v44, v44, v108
    v_mov_b32 v60, 0
    v_add_f32 v45, v45, v109
    v_mov_b32 v61, 0
    v_add_f32 v46, v46, v110
    v_mov_b32 v62, 0
    v_add_f32 v47, v47, v111
    v_mov_b32 v63, 0
    s_lshl_b32 s47, s77, 14
    s_add_u32 s47, s47, 0
    v_lshrrev_b32 v2, 5, v1
    v_lshlrev_b32 v12, 9, v2
    v_bfe_u32 v2, v1, 2, 2
    v_lshl_add_u32 v12, v2, 7, v12
    v_bfe_u32 v2, v1, 3, 1
    v_lshl_add_u32 v12, v2, 6, v12
    v_bfe_u32 v2, v1, 4, 1
    v_lshl_add_u32 v12, v2, 5, v12
    v_and_b32 v2, 3, v1
    v_lshl_add_u32 v12, v2, 3, v12
    v_add_u32 v12, s47, v12
    v_xor_b32 v13, 64, v12
    ds_read_b64_tr_b16 v[128:129], v12 offset:0
    ds_read_b64_tr_b16 v[130:131], v12 offset:1024
    ds_read_b64_tr_b16 v[132:133], v13 offset:0
    ds_read_b64_tr_b16 v[134:135], v13 offset:1024
    ds_read_b64_tr_b16 v[136:137], v12 offset:2048
    ds_read_b64_tr_b16 v[138:139], v12 offset:3072
    ds_read_b64_tr_b16 v[140:141], v13 offset:2048
    ds_read_b64_tr_b16 v[142:143], v13 offset:3072
    ds_read_b64_tr_b16 v[144:145], v12 offset:4096
    ds_read_b64_tr_b16 v[146:147], v12 offset:5120
    ds_read_b64_tr_b16 v[148:149], v13 offset:4096
    ds_read_b64_tr_b16 v[150:151], v13 offset:5120
    ds_read_b64_tr_b16 v[152:153], v12 offset:6144
    ds_read_b64_tr_b16 v[154:155], v12 offset:7168
    ds_read_b64_tr_b16 v[156:157], v13 offset:6144
    ds_read_b64_tr_b16 v[158:159], v13 offset:7168
    ds_read_b64_tr_b16 v[160:161], v12 offset:8192
    ds_read_b64_tr_b16 v[162:163], v12 offset:9216
    ds_read_b64_tr_b16 v[164:165], v13 offset:8192
    ds_read_b64_tr_b16 v[166:167], v13 offset:9216
    ds_read_b64_tr_b16 v[168:169], v12 offset:10240
    ds_read_b64_tr_b16 v[170:171], v12 offset:11264
    ds_read_b64_tr_b16 v[172:173], v13 offset:10240
    ds_read_b64_tr_b16 v[174:175], v13 offset:11264
    ds_read_b64_tr_b16 v[176:177], v12 offset:12288
    ds_read_b64_tr_b16 v[178:179], v12 offset:13312
    ds_read_b64_tr_b16 v[180:181], v13 offset:12288
    ds_read_b64_tr_b16 v[182:183], v13 offset:13312
    ds_read_b64_tr_b16 v[184:185], v12 offset:14336
    ds_read_b64_tr_b16 v[186:187], v12 offset:15360
    ds_read_b64_tr_b16 v[188:189], v13 offset:14336
    ds_read_b64_tr_b16 v[190:191], v13 offset:15360
    ds_read_b64_tr_b16 v[192:193], v12 offset:32768
    ds_read_b64_tr_b16 v[194:195], v12 offset:33792
    ds_read_b64_tr_b16 v[196:197], v13 offset:32768
    ds_read_b64_tr_b16 v[198:199], v13 offset:33792
    ds_read_b64_tr_b16 v[200:201], v12 offset:34816
    ds_read_b64_tr_b16 v[202:203], v12 offset:35840
    ds_read_b64_tr_b16 v[204:205], v13 offset:34816
    ds_read_b64_tr_b16 v[206:207], v13 offset:35840
    ds_read_b64_tr_b16 v[208:209], v12 offset:36864
    ds_read_b64_tr_b16 v[210:211], v12 offset:37888
    ds_read_b64_tr_b16 v[212:213], v13 offset:36864
    ds_read_b64_tr_b16 v[214:215], v13 offset:37888
    ds_read_b64_tr_b16 v[216:217], v12 offset:38912
    ds_read_b64_tr_b16 v[218:219], v12 offset:39936
    ds_read_b64_tr_b16 v[220:221], v13 offset:38912
    ds_read_b64_tr_b16 v[222:223], v13 offset:39936
    ds_read_b64_tr_b16 v[224:225], v12 offset:40960
    ds_read_b64_tr_b16 v[226:227], v12 offset:41984
    ds_read_b64_tr_b16 v[228:229], v13 offset:40960
    ds_read_b64_tr_b16 v[230:231], v13 offset:41984
    ds_read_b64_tr_b16 v[232:233], v12 offset:43008
    ds_read_b64_tr_b16 v[234:235], v12 offset:44032
    ds_read_b64_tr_b16 v[236:237], v13 offset:43008
    ds_read_b64_tr_b16 v[238:239], v13 offset:44032
    ds_read_b64_tr_b16 v[240:241], v12 offset:45056
    ds_read_b64_tr_b16 v[242:243], v12 offset:46080
    ds_read_b64_tr_b16 v[244:245], v13 offset:45056
    ds_read_b64_tr_b16 v[246:247], v13 offset:46080
    ds_read_b64_tr_b16 v[248:249], v12 offset:47104
    ds_read_b64_tr_b16 v[250:251], v12 offset:48128
    ds_read_b64_tr_b16 v[252:253], v13 offset:47104
    ds_read_b64_tr_b16 v[254:255], v13 offset:48128
    s_waitcnt lgkmcnt(0)
    v_mov_b32 v2, 159776
Y_GOC:
    ds_read_b32 v3, v2
    s_waitcnt lgkmcnt(0)
    v_readfirstlane_b32 s46, v3
    s_nop 0
    s_cmp_ge_u32 s46, 4
    s_cbranch_scc1 Y_GOC_OK
    s_sleep 2
    s_branch Y_GOC
Y_GOC_OK:
    s_lshl_b32 s75, s77, 2
    s_add_u32 s75, s75, 24
    s_lshl_b32 s75, 15, s75
    s_mov_b32 s74, 0
    s_mov_b64 s[96:97], 0
    s_mov_b32 s98, 0
Y_PO_C:
    s_and_b64 s[46:47], s[96:97], s[74:75]
    s_cmp_eq_u64 s[46:47], s[74:75]
    s_cbranch_scc1 Y_PO_D
    s_sleep 3
    s_mov_b64 exec, s[74:75]
    buffer_load_dwordx2 v[6:7], v8, s[40:43], s99 offen sc1
    s_waitcnt vmcnt(0)
    v_cmp_eq_u64 vcc, s[2:3], v[6:7]
    s_mov_b64 exec, -1
    s_or_b64 s[96:97], s[96:97], vcc
    s_add_u32 s98, s98, 1
    s_cmp_lt_u32 s98, 0x40000
    s_cbranch_scc1 Y_PO_C
Y_PO_D:
    s_lshl_b32 s46, s17, 1
    s_add_u32 s46, s46, s76
    s_lshl_b32 s46, s46, 15
    s_lshl_b32 s47, s77, 14
    s_add_u32 s46, s46, s47
    s_add_u32 s46, s46, 8388608
    buffer_load_dwordx4 v[64:67], v20, s[40:43], s46 offen offset:0
    buffer_load_dwordx4 v[68:71], v20, s[40:43], s46 offen offset:1024
    buffer_load_dwordx4 v[72:75], v20, s[40:43], s46 offen offset:2048
    buffer_load_dwordx4 v[76:79], v20, s[40:43], s46 offen offset:3072
    s_add_u32 s46, s46, 4096
    buffer_load_dwordx4 v[80:83], v20, s[40:43], s46 offen offset:0
    buffer_load_dwordx4 v[84:87], v20, s[40:43], s46 offen offset:1024
    buffer_load_dwordx4 v[88:91], v20, s[40:43], s46 offen offset:2048
    buffer_load_dwordx4 v[92:95], v20, s[40:43], s46 offen offset:3072
    s_add_u32 s46, s46, 4096
    buffer_load_dwordx4 v[96:99], v20, s[40:43], s46 offen offset:0
    buffer_load_dwordx4 v[100:103], v20, s[40:43], s46 offen offset:1024
    buffer_load_dwordx4 v[104:107], v20, s[40:43], s46 offen offset:2048
    buffer_load_dwordx4 v[108:111], v20, s[40:43], s46 offen offset:3072
    s_add_u32 s46, s46, 4096
    buffer_load_dwordx4 v[112:115], v20, s[40:43], s46 offen offset:0
    buffer_load_dwordx4 v[116:119], v20, s[40:43], s46 offen offset:1024
    buffer_load_dwordx4 v[120:123], v20, s[40:43], s46 offen offset:2048
    buffer_load_dwordx4 v[124:127], v20, s[40:43], s46 offen offset:3072
    s_cmp_eq_u32 s77, 0
    s_cbranch_scc0 Y_OK1
    s_waitcnt vmcnt(15)
    v_mfma_f32_32x32x16_bf16 v[48:63], v[132:135], v[64:67], v[48:63]
    v_mfma_f32_32x32x16_bf16 v[32:47], v[128:131], v[64:67], v[32:47]
    s_waitcnt vmcnt(14)
    v_mfma_f32_32x32x16_bf16 v[48:63], v[140:143], v[68:71], v[48:63]
    v_mfma_f32_32x32x16_bf16 v[32:47], v[136:139], v[68:71], v[32:47]
    s_waitcnt vmcnt(13)
    v_mfma_f32_32x32x16_bf16 v[48:63], v[148:151], v[72:75], v[48:63]
    v_mfma_f32_32x32x16_bf16 v[32:47], v[144:147], v[72:75], v[32:47]
    s_waitcnt vmcnt(12)
    v_mfma_f32_32x32x16_bf16 v[48:63], v[156:159], v[76:79], v[48:63]
    v_mfma_f32_32x32x16_bf16 v[32:47], v[152:155], v[76:79], v[32:47]
    s_waitcnt vmcnt(11)
    v_mfma_f32_32x32x16_bf16 v[48:63], v[164:167], v[80:83], v[48:63]
    v_mfma_f32_32x32x16_bf16 v[32:47], v[160:163], v[80:83], v[32:47]
    s_waitcnt vmcnt(10)
    v_mfma_f32_32x32x16_bf16 v[48:63], v[172:175], v[84:87], v[48:63]
    v_mfma_f32_32x32x16_bf16 v[32:47], v[168:171], v[84:87], v[32:47]
    s_waitcnt vmcnt(9)
    v_mfma_f32_32x32x16_bf16 v[48:63], v[180:183], v[88:91], v[48:63]
    v_mfma_f32_32x32x16_bf16 v[32:47], v[176:179], v[88:91], v[32:47]
    s_waitcnt vmcnt(8)
    v_mfma_f32_32x32x16_bf16 v[48:63], v[188:191], v[92:95], v[48:63]
    v_mfma_f32_32x32x16_bf16 v[32:47], v[184:187], v[92:95], v[32:47]
    s_waitcnt vmcnt(7)
    v_mfma_f32_32x32x16_bf16 v[48:63], v[196:199], v[96:99], v[48:63]
    v_mfma_f32_32x32x16_bf16 v[32:47], v[192:195], v[96:99], v[32:47]
    s_waitcnt vmcnt(6)
    v_mfma_f32_32x32x16_bf16 v[48:63], v[204:207], v[100:103], v[48:63]
    v_mfma_f32_32x32x16_bf16 v[32:47], v[200:203], v[100:103], v[32:47]
    s_waitcnt vmcnt(5)
    v_mfma_f32_32x32x16_bf16 v[48:63], v[212:215], v[104:107], v[48:63]
    v_mfma_f32_32x32x16_bf16 v[32:47], v[208:211], v[104:107], v[32:47]
    s_waitcnt vmcnt(4)
    v_mfma_f32_32x32x16_bf16 v[48:63], v[220:223], v[108:111], v[48:63]
    v_mfma_f32_32x32x16_bf16 v[32:47], v[216:219], v[108:111], v[32:47]
    s_waitcnt vmcnt(3)
    v_mfma_f32_32x32x16_bf16 v[48:63], v[228:231], v[112:115], v[48:63]
    v_mfma_f32_32x32x16_bf16 v[32:47], v[224:227], v[112:115], v[32:47]
    s_waitcnt vmcnt(2)
    v_mfma_f32_32x32x16_bf16 v[48:63], v[236:239], v[116:119], v[48:63]
    v_mfma_f32_32x32x16_bf16 v[32:47], v[232:235], v[116:119], v[32:47]
    s_waitcnt vmcnt(1)
    v_mfma_f32_32x32x16_bf16 v[48:63], v[244:247], v[120:123], v[48:63]
    v_mfma_f32_32x32x16_bf16 v[32:47], v[240:243], v[120:123], v[32:47]
    s_waitcnt vmcnt(0)
    v_mfma_f32_32x32x16_bf16 v[48:63], v[252:255], v[124:127], v[48:63]
    v_mfma_f32_32x32x16_bf16 v[32:47], v[248:251], v[124:127], v[32:47]
    s_branch Y_OK2
Y_OK1:
    s_waitcnt vmcnt(15)
    v_mfma_f32_32x32x16_bf16 v[48:63], v[128:131], v[64:67], v[48:63]
    v_mfma_f32_32x32x16_bf16 v[32:47], v[132:135], v[64:67], v[32:47]
    s_waitcnt vmcnt(14)
    v_mfma_f32_32x32x16_bf16 v[48:63], v[136:139], v[68:71], v[48:63]
    v_mfma_f32_32x32x16_bf16 v[32:47], v[140:143], v[68:71], v[32:47]
    s_waitcnt vmcnt(13)
    v_mfma_f32_32x32x16_bf16 v[48:63], v[144:147], v[72:75], v[48:63]
    v_mfma_f32_32x32x16_bf16 v[32:47], v[148:151], v[72:75], v[32:47]
    s_waitcnt vmcnt(12)
    v_mfma_f32_32x32x16_bf16 v[48:63], v[152:155], v[76:79], v[48:63]
    v_mfma_f32_32x32x16_bf16 v[32:47], v[156:159], v[76:79], v[32:47]
    s_waitcnt vmcnt(11)
    v_mfma_f32_32x32x16_bf16 v[48:63], v[160:163], v[80:83], v[48:63]
    v_mfma_f32_32x32x16_bf16 v[32:47], v[164:167], v[80:83], v[32:47]
    s_waitcnt vmcnt(10)
    v_mfma_f32_32x32x16_bf16 v[48:63], v[168:171], v[84:87], v[48:63]
    v_mfma_f32_32x32x16_bf16 v[32:47], v[172:175], v[84:87], v[32:47]
    s_waitcnt vmcnt(9)
    v_mfma_f32_32x32x16_bf16 v[48:63], v[176:179], v[88:91], v[48:63]
    v_mfma_f32_32x32x16_bf16 v[32:47], v[180:183], v[88:91], v[32:47]
    s_waitcnt vmcnt(8)
    v_mfma_f32_32x32x16_bf16 v[48:63], v[184:187], v[92:95], v[48:63]
    v_mfma_f32_32x32x16_bf16 v[32:47], v[188:191], v[92:95], v[32:47]
    s_waitcnt vmcnt(7)
    v_mfma_f32_32x32x16_bf16 v[48:63], v[192:195], v[96:99], v[48:63]
    v_mfma_f32_32x32x16_bf16 v[32:47], v[196:199], v[96:99], v[32:47]
    s_waitcnt vmcnt(6)
    v_mfma_f32_32x32x16_bf16 v[48:63], v[200:203], v[100:103], v[48:63]
    v_mfma_f32_32x32x16_bf16 v[32:47], v[204:207], v[100:103], v[32:47]
    s_waitcnt vmcnt(5)
    v_mfma_f32_32x32x16_bf16 v[48:63], v[208:211], v[104:107], v[48:63]
    v_mfma_f32_32x32x16_bf16 v[32:47], v[212:215], v[104:107], v[32:47]
    s_waitcnt vmcnt(4)
    v_mfma_f32_32x32x16_bf16 v[48:63], v[216:219], v[108:111], v[48:63]
    v_mfma_f32_32x32x16_bf16 v[32:47], v[220:223], v[108:111], v[32:47]
    s_waitcnt vmcnt(3)
    v_mfma_f32_32x32x16_bf16 v[48:63], v[224:227], v[112:115], v[48:63]
    v_mfma_f32_32x32x16_bf16 v[32:47], v[228:231], v[112:115], v[32:47]
    s_waitcnt vmcnt(2)
    v_mfma_f32_32x32x16_bf16 v[48:63], v[232:235], v[116:119], v[48:63]
    v_mfma_f32_32x32x16_bf16 v[32:47], v[236:239], v[116:119], v[32:47]
    s_waitcnt vmcnt(1)
    v_mfma_f32_32x32x16_bf16 v[48:63], v[240:243], v[120:123], v[48:63]
    v_mfma_f32_32x32x16_bf16 v[32:47], v[244:247], v[120:123], v[32:47]
    s_waitcnt vmcnt(0)
    v_mfma_f32_32x32x16_bf16 v[48:63], v[248:251], v[124:127], v[48:63]
    v_mfma_f32_32x32x16_bf16 v[32:47], v[252:255], v[124:127], v[32:47]
Y_OK2:
    s_sub_u32 s21, s16, 4
    s_mul_i32 s46, s21, 16384
    s_add_u32 s46, s46, 90112
    v_add_u32 v2, s46, v20
    s_nop 7
    ds_write_b128 v2, v[48:51] offset:0
    ds_write_b128 v2, v[52:55] offset:1024
    ds_write_b128 v2, v[56:59] offset:2048
    ds_write_b128 v2, v[60:63] offset:3072
    s_waitcnt lgkmcnt(0)
    s_lshl_b32 s47, s76, 2
    s_add_u32 s47, s47, 159792
    s_mov_b64 exec, 1
    v_mov_b32 v4, s47
    v_mov_b32 v5, 1
    ds_add_u32 v4, v5
    s_mov_b64 exec, -1
    v_mov_b32 v4, s47
Y_XS:
    ds_read_b32 v5, v4
    s_waitcnt lgkmcnt(0)
    v_readfirstlane_b32 s46, v5
    s_nop 0
    s_cmp_ge_u32 s46, 2
    s_cbranch_scc0 Y_XS
    s_xor_b32 s21, s21, 1
    s_mul_i32 s46, s21, 16384
    s_add_u32 s46, s46, 90112
    v_add_u32 v2, s46, v20
    ds_read_b128 v[48:51], v2 offset:0
    ds_read_b128 v[52:55], v2 offset:1024
    ds_read_b128 v[56:59], v2 offset:2048
    ds_read_b128 v[60:63], v2 offset:3072
    s_waitcnt lgkmcnt(0)
    v_add_f32 v32, v32, v48
    v_add_f32 v33, v33, v49
    v_add_f32 v34, v34, v50
    v_add_f32 v35, v35, v51
    v_add_f32 v36, v36, v52
    v_add_f32 v37, v37, v53
    v_add_f32 v38, v38, v54
    v_add_f32 v39, v39, v55
    v_add_f32 v40, v40, v56
    v_add_f32 v41, v41, v57
    v_add_f32 v42, v42, v58
    v_add_f32 v43, v43, v59
    v_add_f32 v44, v44, v60
    v_add_f32 v45, v45, v61
    v_add_f32 v46, v46, v62
    v_add_f32 v47, v47, v63
    v_permlane32_swap_b32 v32, v36
    v_permlane32_swap_b32 v33, v37
    v_permlane32_swap_b32 v34, v38
    v_permlane32_swap_b32 v35, v39
    v_permlane32_swap_b32 v40, v44
    v_permlane32_swap_b32 v41, v45
    v_permlane32_swap_b32 v42, v46
    v_permlane32_swap_b32 v43, v47
    v_lshlrev_b32 v4, 16, v24
    v_and_b32 v5, 0xffff0000, v24
    v_add_f32 v32, v32, v4
    v_add_f32 v33, v33, v5
    v_lshlrev_b32 v4, 16, v25
    v_and_b32 v5, 0xffff0000, v25
    v_add_f32 v34, v34, v4
    v_add_f32 v35, v35, v5
    v_lshlrev_b32 v4, 16, v26
    v_and_b32 v5, 0xffff0000, v26
    v_add_f32 v36, v36, v4
    v_add_f32 v37, v37, v5
    v_lshlrev_b32 v4, 16, v27
    v_and_b32 v5, 0xffff0000, v27
    v_add_f32 v38, v38, v4
    v_add_f32 v39, v39, v5
    v_cvt_pk_bf16_f32 v48, v32, v33
    v_cvt_pk_bf16_f32 v49, v34, v35
    v_cvt_pk_bf16_f32 v50, v36, v37
    v_cvt_pk_bf16_f32 v51, v38, v39
    buffer_store_dwordx4 v[48:51], v22, s[4:7], s78 offen offset:0
    v_lshlrev_b32 v4, 16, v28
    v_and_b32 v5, 0xffff0000, v28
    v_add_f32 v40, v40, v4
    v_add_f32 v41, v41, v5
    v_lshlrev_b32 v4, 16, v29
    v_and_b32 v5, 0xffff0000, v29
    v_add_f32 v42, v42, v4
    v_add_f32 v43, v43, v5
    v_lshlrev_b32 v4, 16, v30
    v_and_b32 v5, 0xffff0000, v30
    v_add_f32 v44, v44, v4
    v_add_f32 v45, v45, v5
    v_lshlrev_b32 v4, 16, v31
    v_and_b32 v5, 0xffff0000, v31
    v_add_f32 v46, v46, v4
    v_add_f32 v47, v47, v5
    v_cvt_pk_bf16_f32 v52, v40, v41
    v_cvt_pk_bf16_f32 v53, v42, v43
    v_cvt_pk_bf16_f32 v54, v44, v45
    v_cvt_pk_bf16_f32 v55, v46, v47
    buffer_store_dwordx4 v[52:55], v22, s[4:7], s78 offen offset:32
Y_END:
    s_endpgm
.section .rodata,"a"
.p2align 6
.amdhsa_kernel parallel_sum__softmax_full_mha__glu_gated_glu__prompt_kernel
  .amdhsa_next_free_vgpr 256
  .amdhsa_next_free_sgpr 100
  .amdhsa_accum_offset 256
  .amdhsa_group_segment_fixed_size 0
  .amdhsa_kernarg_size 80
  .amdhsa_user_sgpr_count 2
  .amdhsa_user_sgpr_kernarg_segment_ptr 1
  .amdhsa_system_sgpr_workgroup_id_x 1
.end_amdhsa_kernel
```
